```python
import torch

def _softmax(x, axis=-1):
    return torch.softmax(x, dim=axis)
def _gelu(x):
    return torch.nn.functional.gelu(x, approximate="tanh")
def _silu(x):
    return torch.nn.functional.silu(x)
def _sigmoid(x):
    return torch.sigmoid(x)
def _layernorm(x, axis=-1, eps=1e-5):
    m = x.mean(dim=axis, keepdim=True)
    v = x.var(dim=axis, keepdim=True, unbiased=False)
    return (x - m) / torch.sqrt(v + eps)
def _scatter_add(tgt, idx, src, axis=0):
    return tgt.clone().index_add_(axis, idx, src)
def _segment_sum(src, seg, n):
    out = torch.zeros((n,) + src.shape[1:], dtype=src.dtype)
    return out.index_add_(0, seg, src)
def _pad(x, pw):
    flat = tuple(v for pair in reversed(pw) for v in pair)
    return torch.nn.functional.pad(x, flat)

kernel_name = 'interleave_layers__linear_attn_block__dense_activation_gelu__prompt'

def setup_inputs():

    _w = (lambda a: (lambda t: t.to(torch.bfloat16) if t.is_floating_point() else t)(torch.as_tensor(a)))
    def _A_setup():
        B, S, D = 1, 2048, 640
        return {
            "x": _w((lambda *s: torch.randn(*s, dtype=torch.bfloat16) * 0.05)(B, S, D)),
            "wqkv": _w((lambda *s: torch.randn(*s, dtype=torch.bfloat16) * 0.05)(D, 3 * D)),
            "wo": _w((lambda *s: torch.randn(*s, dtype=torch.bfloat16) * 0.05)(D, D)),
        }
    _A_in = _A_setup()

    def _B_setup():
        B, S, D, F = 1, 2048, 640, 1728
        return {
            "x": _w((lambda *s: torch.randn(*s, dtype=torch.bfloat16) * 0.05)(B, S, D)),
            "w1": _w((lambda *s: torch.randn(*s, dtype=torch.bfloat16) * 0.8)(D, F) * (D ** -0.5)),
            "b1": _w((lambda *s: torch.randn(*s, dtype=torch.bfloat16) * 0.8)(F) * 0.01),
            "w2": _w((lambda *s: torch.randn(*s, dtype=torch.bfloat16) * 0.8)(F, D) * (F ** -0.5)),
            "b2": _w((lambda *s: torch.randn(*s, dtype=torch.bfloat16) * 0.8)(D) * 0.01),
        }
    _B_in = _B_setup()

    return {
        "A_x": _A_in["x"],
        "A_wqkv": _A_in["wqkv"],
        "A_wo": _A_in["wo"],
        "B_x": _B_in["x"],
        "B_w1": _B_in["w1"],
        "B_b1": _B_in["b1"],
        "B_w2": _B_in["w2"],
        "B_b2": _B_in["b2"],
    }

def reference(A_x, A_wqkv, A_wo, B_x, B_w1, B_b1, B_w2, B_b2):
    def _A_ref(x, wqkv, wo):
        B, S, D = x.shape
        H = 32; Dh = D // H
        qkv = (lambda x, *d: x.permute(*d))((x @ wqkv).reshape(B, S, 3, H, Dh), 2, 0, 3, 1, 4)
        q, k, v = qkv[0], qkv[1], qkv[2]
        phi = lambda t: torch.where(t > 0, t + 1, torch.exp(t)) + 1e-6
        pq, pk = phi(q), phi(k)
        kv = torch.einsum("bhsd,bhse->bhde", pk, v)
        z = torch.einsum("bhsd->bhd", pk)
        num = torch.einsum("bhqd,bhde->bhqe", pq, kv)
        den = torch.einsum("bhqd,bhd->bhq", pq, z)[..., None] + 1e-6
        o = num / den
        return (lambda x, *d: x.permute(*d))(o, 0, 2, 1, 3).reshape(B, S, D) @ wo

    def _B_ref(x, w1, b1, w2, b2):
        h = torch.einsum("bsd,df->bsf", x, w1) + b1
        h = _gelu(h)
        return torch.einsum("bsf,fd->bsd", h, w2) + b2

    x = A_x
    x = x + _A_ref(_layernorm(x, axis=-1), A_wqkv, A_wo)
    x = x + _B_ref(_layernorm(x, axis=-1), B_w1, B_b1, B_w2, B_b2)
    x = x + _A_ref(_layernorm(x, axis=-1), A_wqkv, A_wo)
    x = x + _B_ref(_layernorm(x, axis=-1), B_w1, B_b1, B_w2, B_b2)
    return x
```

```asm
; @launch kernel=k0_prep_kernel grid=(201,1,1) block=(256,1,1) lds=24576
; @launch kernel=k1_l0_kernel grid=(192,1,1) block=(256,1,1) lds=151552
; @launch kernel=k2_l0_kernel grid=(256,1,1) block=(256,1,1) lds=143360
; @launch kernel=k3_l0_kernel grid=(216,1,1) block=(256,1,1) lds=126976
; @launch kernel=k4_l0_kernel grid=(256,1,1) block=(256,1,1) lds=147456
; @launch kernel=k1_l1_kernel grid=(192,1,1) block=(256,1,1) lds=151552
; @launch kernel=k2_l1_kernel grid=(256,1,1) block=(256,1,1) lds=143360
; @launch kernel=k3_l1_kernel grid=(216,1,1) block=(256,1,1) lds=126976
; @launch kernel=k4_l1_kernel grid=(256,1,1) block=(256,1,1) lds=147456
.amdgcn_target "amdgcn-amd-amdhsa--gfx950"
.text
.globl k0_prep_kernel
.p2align 8
.type k0_prep_kernel,@function
k0_prep_kernel:
    s_load_dwordx16 s[4:19], s[0:1], 0
    s_load_dwordx4 s[20:23], s[0:1], 64
    s_load_dwordx2 s[24:25], s[0:1], 80
    s_cmp_ge_u32 s2, 201
    s_cbranch_scc1 K0_end
    s_waitcnt lgkmcnt(0)
    s_cmp_ge_u32 s2, 185
    s_cbranch_scc1 K0_zero
    s_cmp_ge_u32 s2, 128
    s_cbranch_scc1 K0_colsum
    s_mov_b32 s28, s4
    s_mov_b32 s29, s5
    s_mov_b32 s30, 2621440
    s_mov_b32 s31, 0x00020000
    s_add_u32 s32, s24, 21495808
    s_addc_u32 s33, s25, 0
    s_mov_b32 s34, 131072
    s_mov_b32 s35, 0x00020000
    v_lshrrev_b32 v1, 4, v0
    s_lshl_b32 s3, s2, 4
    v_add_u32 v1, s3, v1
    v_and_b32 v2, 15, v0
    v_mul_u32_u24 v3, 1280, v1
    v_mul_u32_u24 v4, 80, v2
    v_add_u32 v3, v3, v4
    buffer_load_dwordx4 v[8:11], v3, s[28:31], 0 offen offset:0
    buffer_load_dwordx4 v[12:15], v3, s[28:31], 0 offen offset:16
    buffer_load_dwordx4 v[16:19], v3, s[28:31], 0 offen offset:32
    buffer_load_dwordx4 v[20:23], v3, s[28:31], 0 offen offset:48
    buffer_load_dwordx4 v[24:27], v3, s[28:31], 0 offen offset:64
    s_waitcnt vmcnt(0)
    v_lshlrev_b32 v32, 16, v8
    v_and_b32 v33, 0xffff0000, v8
    v_lshlrev_b32 v34, 16, v9
    v_and_b32 v35, 0xffff0000, v9
    v_lshlrev_b32 v36, 16, v10
    v_and_b32 v37, 0xffff0000, v10
    v_lshlrev_b32 v38, 16, v11
    v_and_b32 v39, 0xffff0000, v11
    v_lshlrev_b32 v40, 16, v12
    v_and_b32 v41, 0xffff0000, v12
    v_lshlrev_b32 v42, 16, v13
    v_and_b32 v43, 0xffff0000, v13
    v_lshlrev_b32 v44, 16, v14
    v_and_b32 v45, 0xffff0000, v14
    v_lshlrev_b32 v46, 16, v15
    v_and_b32 v47, 0xffff0000, v15
    v_lshlrev_b32 v48, 16, v16
    v_and_b32 v49, 0xffff0000, v16
    v_lshlrev_b32 v50, 16, v17
    v_and_b32 v51, 0xffff0000, v17
    v_lshlrev_b32 v52, 16, v18
    v_and_b32 v53, 0xffff0000, v18
    v_lshlrev_b32 v54, 16, v19
    v_and_b32 v55, 0xffff0000, v19
    v_lshlrev_b32 v56, 16, v20
    v_and_b32 v57, 0xffff0000, v20
    v_lshlrev_b32 v58, 16, v21
    v_and_b32 v59, 0xffff0000, v21
    v_lshlrev_b32 v60, 16, v22
    v_and_b32 v61, 0xffff0000, v22
    v_lshlrev_b32 v62, 16, v23
    v_and_b32 v63, 0xffff0000, v23
    v_lshlrev_b32 v64, 16, v24
    v_and_b32 v65, 0xffff0000, v24
    v_lshlrev_b32 v66, 16, v25
    v_and_b32 v67, 0xffff0000, v25
    v_lshlrev_b32 v68, 16, v26
    v_and_b32 v69, 0xffff0000, v26
    v_lshlrev_b32 v70, 16, v27
    v_and_b32 v71, 0xffff0000, v27
    v_add_f32 v5, v32, v33
    v_add_f32 v5, v5, v34
    v_add_f32 v5, v5, v35
    v_add_f32 v5, v5, v36
    v_add_f32 v5, v5, v37
    v_add_f32 v5, v5, v38
    v_add_f32 v5, v5, v39
    v_add_f32 v5, v5, v40
    v_add_f32 v5, v5, v41
    v_add_f32 v5, v5, v42
    v_add_f32 v5, v5, v43
    v_add_f32 v5, v5, v44
    v_add_f32 v5, v5, v45
    v_add_f32 v5, v5, v46
    v_add_f32 v5, v5, v47
    v_add_f32 v5, v5, v48
    v_add_f32 v5, v5, v49
    v_add_f32 v5, v5, v50
    v_add_f32 v5, v5, v51
    v_add_f32 v5, v5, v52
    v_add_f32 v5, v5, v53
    v_add_f32 v5, v5, v54
    v_add_f32 v5, v5, v55
    v_add_f32 v5, v5, v56
    v_add_f32 v5, v5, v57
    v_add_f32 v5, v5, v58
    v_add_f32 v5, v5, v59
    v_add_f32 v5, v5, v60
    v_add_f32 v5, v5, v61
    v_add_f32 v5, v5, v62
    v_add_f32 v5, v5, v63
    v_add_f32 v5, v5, v64
    v_add_f32 v5, v5, v65
    v_add_f32 v5, v5, v66
    v_add_f32 v5, v5, v67
    v_add_f32 v5, v5, v68
    v_add_f32 v5, v5, v69
    v_add_f32 v5, v5, v70
    v_add_f32 v5, v5, v71
    s_nop 1
    v_add_f32_dpp v6, v5, v5 quad_perm:[1,0,3,2] row_mask:0xf bank_mask:0xf
    v_mul_f32 v7, 1011666125, v6
    v_mov_b32 v8, 0
    v_sub_f32 v9, v32, v7
    v_fma_f32 v8, v9, v9, v8
    v_sub_f32 v9, v33, v7
    v_fma_f32 v8, v9, v9, v8
    v_sub_f32 v9, v34, v7
    v_fma_f32 v8, v9, v9, v8
    v_sub_f32 v9, v35, v7
    v_fma_f32 v8, v9, v9, v8
    v_sub_f32 v9, v36, v7
    v_fma_f32 v8, v9, v9, v8
    v_sub_f32 v9, v37, v7
    v_fma_f32 v8, v9, v9, v8
    v_sub_f32 v9, v38, v7
    v_fma_f32 v8, v9, v9, v8
    v_sub_f32 v9, v39, v7
    v_fma_f32 v8, v9, v9, v8
    v_sub_f32 v9, v40, v7
    v_fma_f32 v8, v9, v9, v8
    v_sub_f32 v9, v41, v7
    v_fma_f32 v8, v9, v9, v8
    v_sub_f32 v9, v42, v7
    v_fma_f32 v8, v9, v9, v8
    v_sub_f32 v9, v43, v7
    v_fma_f32 v8, v9, v9, v8
    v_sub_f32 v9, v44, v7
    v_fma_f32 v8, v9, v9, v8
    v_sub_f32 v9, v45, v7
    v_fma_f32 v8, v9, v9, v8
    v_sub_f32 v9, v46, v7
    v_fma_f32 v8, v9, v9, v8
    v_sub_f32 v9, v47, v7
    v_fma_f32 v8, v9, v9, v8
    v_sub_f32 v9, v48, v7
    v_fma_f32 v8, v9, v9, v8
    v_sub_f32 v9, v49, v7
    v_fma_f32 v8, v9, v9, v8
    v_sub_f32 v9, v50, v7
    v_fma_f32 v8, v9, v9, v8
    v_sub_f32 v9, v51, v7
    v_fma_f32 v8, v9, v9, v8
    v_sub_f32 v9, v52, v7
    v_fma_f32 v8, v9, v9, v8
    v_sub_f32 v9, v53, v7
    v_fma_f32 v8, v9, v9, v8
    v_sub_f32 v9, v54, v7
    v_fma_f32 v8, v9, v9, v8
    v_sub_f32 v9, v55, v7
    v_fma_f32 v8, v9, v9, v8
    v_sub_f32 v9, v56, v7
    v_fma_f32 v8, v9, v9, v8
    v_sub_f32 v9, v57, v7
    v_fma_f32 v8, v9, v9, v8
    v_sub_f32 v9, v58, v7
    v_fma_f32 v8, v9, v9, v8
    v_sub_f32 v9, v59, v7
    v_fma_f32 v8, v9, v9, v8
    v_sub_f32 v9, v60, v7
    v_fma_f32 v8, v9, v9, v8
    v_sub_f32 v9, v61, v7
    v_fma_f32 v8, v9, v9, v8
    v_sub_f32 v9, v62, v7
    v_fma_f32 v8, v9, v9, v8
    v_sub_f32 v9, v63, v7
    v_fma_f32 v8, v9, v9, v8
    v_sub_f32 v9, v64, v7
    v_fma_f32 v8, v9, v9, v8
    v_sub_f32 v9, v65, v7
    v_fma_f32 v8, v9, v9, v8
    v_sub_f32 v9, v66, v7
    v_fma_f32 v8, v9, v9, v8
    v_sub_f32 v9, v67, v7
    v_fma_f32 v8, v9, v9, v8
    v_sub_f32 v9, v68, v7
    v_fma_f32 v8, v9, v9, v8
    v_sub_f32 v9, v69, v7
    v_fma_f32 v8, v9, v9, v8
    v_sub_f32 v9, v70, v7
    v_fma_f32 v8, v9, v9, v8
    v_sub_f32 v9, v71, v7
    v_fma_f32 v8, v9, v9, v8
    s_nop 1
    v_add_f32_dpp v7, v8, v8 quad_perm:[1,0,3,2] row_mask:0xf bank_mask:0xf
    v_lshlrev_b32 v10, 6, v1
    v_lshrrev_b32 v11, 1, v2
    v_lshlrev_b32 v11, 3, v11
    v_add_u32 v10, v10, v11
    v_and_b32 v11, 1, v2
    v_cmp_eq_u32 vcc, 0, v11
    s_and_saveexec_b64 s[40:41], vcc
    buffer_store_dwordx2 v[6:7], v10, s[32:35], 0 offen
    s_mov_b64 exec, s[40:41]
    s_endpgm
K0_colsum:
    s_sub_u32 s3, s2, 128
    s_cmp_ge_u32 s3, 30
    s_cbranch_scc1 K0_cs_w1
    s_mov_b32 s28, s6
    s_mov_b32 s29, s7
    s_mov_b32 s30, 2457600
    s_mov_b32 s31, 0x00020000
    s_add_u32 s32, s24, 21233664
    s_addc_u32 s33, s25, 0
    s_mov_b32 s34, 7680
    s_mov_b32 s35, 0x00020000
    s_movk_i32 s42, 3840
    s_branch K0_cs_go
K0_cs_w1:
    s_sub_u32 s3, s3, 30
    s_mov_b32 s28, s12
    s_mov_b32 s29, s13
    s_mov_b32 s30, 2211840
    s_mov_b32 s31, 0x00020000
    s_add_u32 s32, s24, 21250048
    s_addc_u32 s33, s25, 0
    s_mov_b32 s34, 6912
    s_mov_b32 s35, 0x00020000
    s_movk_i32 s42, 3456
K0_cs_go:
    v_and_b32 v1, 7, v0
    v_lshrrev_b32 v2, 3, v0
    v_mul_lo_u32 v3, s42, v2
    v_lshlrev_b32 v4, 4, v1
    v_add_u32 v3, v3, v4
    s_lshl_b32 s43, s3, 7
    s_lshl_b32 s44, s42, 5
    buffer_load_dwordx4 v[8:11], v3, s[28:31], s43 offen
    s_add_u32 s43, s43, s44
    buffer_load_dwordx4 v[12:15], v3, s[28:31], s43 offen
    s_add_u32 s43, s43, s44
    buffer_load_dwordx4 v[16:19], v3, s[28:31], s43 offen
    s_add_u32 s43, s43, s44
    buffer_load_dwordx4 v[20:23], v3, s[28:31], s43 offen
    s_add_u32 s43, s43, s44
    buffer_load_dwordx4 v[24:27], v3, s[28:31], s43 offen
    s_add_u32 s43, s43, s44
    buffer_load_dwordx4 v[28:31], v3, s[28:31], s43 offen
    s_add_u32 s43, s43, s44
    buffer_load_dwordx4 v[32:35], v3, s[28:31], s43 offen
    s_add_u32 s43, s43, s44
    buffer_load_dwordx4 v[36:39], v3, s[28:31], s43 offen
    s_add_u32 s43, s43, s44
    buffer_load_dwordx4 v[40:43], v3, s[28:31], s43 offen
    s_add_u32 s43, s43, s44
    buffer_load_dwordx4 v[44:47], v3, s[28:31], s43 offen
    s_add_u32 s43, s43, s44
    buffer_load_dwordx4 v[48:51], v3, s[28:31], s43 offen
    s_add_u32 s43, s43, s44
    buffer_load_dwordx4 v[52:55], v3, s[28:31], s43 offen
    s_add_u32 s43, s43, s44
    buffer_load_dwordx4 v[56:59], v3, s[28:31], s43 offen
    s_add_u32 s43, s43, s44
    buffer_load_dwordx4 v[60:63], v3, s[28:31], s43 offen
    s_add_u32 s43, s43, s44
    buffer_load_dwordx4 v[64:67], v3, s[28:31], s43 offen
    s_add_u32 s43, s43, s44
    buffer_load_dwordx4 v[68:71], v3, s[28:31], s43 offen
    s_add_u32 s43, s43, s44
    buffer_load_dwordx4 v[72:75], v3, s[28:31], s43 offen
    s_add_u32 s43, s43, s44
    buffer_load_dwordx4 v[76:79], v3, s[28:31], s43 offen
    s_add_u32 s43, s43, s44
    buffer_load_dwordx4 v[80:83], v3, s[28:31], s43 offen
    s_add_u32 s43, s43, s44
    buffer_load_dwordx4 v[84:87], v3, s[28:31], s43 offen
    s_waitcnt vmcnt(0)
    v_mov_b32 v100, 0
    v_mov_b32 v101, 0
    v_mov_b32 v102, 0
    v_mov_b32 v103, 0
    v_mov_b32 v104, 0
    v_mov_b32 v105, 0
    v_mov_b32 v106, 0
    v_mov_b32 v107, 0
    v_lshlrev_b32 v96, 16, v8
    v_and_b32 v97, 0xffff0000, v8
    v_add_f32 v100, v100, v96
    v_add_f32 v101, v101, v97
    v_lshlrev_b32 v96, 16, v9
    v_and_b32 v97, 0xffff0000, v9
    v_add_f32 v102, v102, v96
    v_add_f32 v103, v103, v97
    v_lshlrev_b32 v96, 16, v10
    v_and_b32 v97, 0xffff0000, v10
    v_add_f32 v104, v104, v96
    v_add_f32 v105, v105, v97
    v_lshlrev_b32 v96, 16, v11
    v_and_b32 v97, 0xffff0000, v11
    v_add_f32 v106, v106, v96
    v_add_f32 v107, v107, v97
    v_lshlrev_b32 v96, 16, v12
    v_and_b32 v97, 0xffff0000, v12
    v_add_f32 v100, v100, v96
    v_add_f32 v101, v101, v97
    v_lshlrev_b32 v96, 16, v13
    v_and_b32 v97, 0xffff0000, v13
    v_add_f32 v102, v102, v96
    v_add_f32 v103, v103, v97
    v_lshlrev_b32 v96, 16, v14
    v_and_b32 v97, 0xffff0000, v14
    v_add_f32 v104, v104, v96
    v_add_f32 v105, v105, v97
    v_lshlrev_b32 v96, 16, v15
    v_and_b32 v97, 0xffff0000, v15
    v_add_f32 v106, v106, v96
    v_add_f32 v107, v107, v97
    v_lshlrev_b32 v96, 16, v16
    v_and_b32 v97, 0xffff0000, v16
    v_add_f32 v100, v100, v96
    v_add_f32 v101, v101, v97
    v_lshlrev_b32 v96, 16, v17
    v_and_b32 v97, 0xffff0000, v17
    v_add_f32 v102, v102, v96
    v_add_f32 v103, v103, v97
    v_lshlrev_b32 v96, 16, v18
    v_and_b32 v97, 0xffff0000, v18
    v_add_f32 v104, v104, v96
    v_add_f32 v105, v105, v97
    v_lshlrev_b32 v96, 16, v19
    v_and_b32 v97, 0xffff0000, v19
    v_add_f32 v106, v106, v96
    v_add_f32 v107, v107, v97
    v_lshlrev_b32 v96, 16, v20
    v_and_b32 v97, 0xffff0000, v20
    v_add_f32 v100, v100, v96
    v_add_f32 v101, v101, v97
    v_lshlrev_b32 v96, 16, v21
    v_and_b32 v97, 0xffff0000, v21
    v_add_f32 v102, v102, v96
    v_add_f32 v103, v103, v97
    v_lshlrev_b32 v96, 16, v22
    v_and_b32 v97, 0xffff0000, v22
    v_add_f32 v104, v104, v96
    v_add_f32 v105, v105, v97
    v_lshlrev_b32 v96, 16, v23
    v_and_b32 v97, 0xffff0000, v23
    v_add_f32 v106, v106, v96
    v_add_f32 v107, v107, v97
    v_lshlrev_b32 v96, 16, v24
    v_and_b32 v97, 0xffff0000, v24
    v_add_f32 v100, v100, v96
    v_add_f32 v101, v101, v97
    v_lshlrev_b32 v96, 16, v25
    v_and_b32 v97, 0xffff0000, v25
    v_add_f32 v102, v102, v96
    v_add_f32 v103, v103, v97
    v_lshlrev_b32 v96, 16, v26
    v_and_b32 v97, 0xffff0000, v26
    v_add_f32 v104, v104, v96
    v_add_f32 v105, v105, v97
    v_lshlrev_b32 v96, 16, v27
    v_and_b32 v97, 0xffff0000, v27
    v_add_f32 v106, v106, v96
    v_add_f32 v107, v107, v97
    v_lshlrev_b32 v96, 16, v28
    v_and_b32 v97, 0xffff0000, v28
    v_add_f32 v100, v100, v96
    v_add_f32 v101, v101, v97
    v_lshlrev_b32 v96, 16, v29
    v_and_b32 v97, 0xffff0000, v29
    v_add_f32 v102, v102, v96
    v_add_f32 v103, v103, v97
    v_lshlrev_b32 v96, 16, v30
    v_and_b32 v97, 0xffff0000, v30
    v_add_f32 v104, v104, v96
    v_add_f32 v105, v105, v97
    v_lshlrev_b32 v96, 16, v31
    v_and_b32 v97, 0xffff0000, v31
    v_add_f32 v106, v106, v96
    v_add_f32 v107, v107, v97
    v_lshlrev_b32 v96, 16, v32
    v_and_b32 v97, 0xffff0000, v32
    v_add_f32 v100, v100, v96
    v_add_f32 v101, v101, v97
    v_lshlrev_b32 v96, 16, v33
    v_and_b32 v97, 0xffff0000, v33
    v_add_f32 v102, v102, v96
    v_add_f32 v103, v103, v97
    v_lshlrev_b32 v96, 16, v34
    v_and_b32 v97, 0xffff0000, v34
    v_add_f32 v104, v104, v96
    v_add_f32 v105, v105, v97
    v_lshlrev_b32 v96, 16, v35
    v_and_b32 v97, 0xffff0000, v35
    v_add_f32 v106, v106, v96
    v_add_f32 v107, v107, v97
    v_lshlrev_b32 v96, 16, v36
    v_and_b32 v97, 0xffff0000, v36
    v_add_f32 v100, v100, v96
    v_add_f32 v101, v101, v97
    v_lshlrev_b32 v96, 16, v37
    v_and_b32 v97, 0xffff0000, v37
    v_add_f32 v102, v102, v96
    v_add_f32 v103, v103, v97
    v_lshlrev_b32 v96, 16, v38
    v_and_b32 v97, 0xffff0000, v38
    v_add_f32 v104, v104, v96
    v_add_f32 v105, v105, v97
    v_lshlrev_b32 v96, 16, v39
    v_and_b32 v97, 0xffff0000, v39
    v_add_f32 v106, v106, v96
    v_add_f32 v107, v107, v97
    v_lshlrev_b32 v96, 16, v40
    v_and_b32 v97, 0xffff0000, v40
    v_add_f32 v100, v100, v96
    v_add_f32 v101, v101, v97
    v_lshlrev_b32 v96, 16, v41
    v_and_b32 v97, 0xffff0000, v41
    v_add_f32 v102, v102, v96
    v_add_f32 v103, v103, v97
    v_lshlrev_b32 v96, 16, v42
    v_and_b32 v97, 0xffff0000, v42
    v_add_f32 v104, v104, v96
    v_add_f32 v105, v105, v97
    v_lshlrev_b32 v96, 16, v43
    v_and_b32 v97, 0xffff0000, v43
    v_add_f32 v106, v106, v96
    v_add_f32 v107, v107, v97
    v_lshlrev_b32 v96, 16, v44
    v_and_b32 v97, 0xffff0000, v44
    v_add_f32 v100, v100, v96
    v_add_f32 v101, v101, v97
    v_lshlrev_b32 v96, 16, v45
    v_and_b32 v97, 0xffff0000, v45
    v_add_f32 v102, v102, v96
    v_add_f32 v103, v103, v97
    v_lshlrev_b32 v96, 16, v46
    v_and_b32 v97, 0xffff0000, v46
    v_add_f32 v104, v104, v96
    v_add_f32 v105, v105, v97
    v_lshlrev_b32 v96, 16, v47
    v_and_b32 v97, 0xffff0000, v47
    v_add_f32 v106, v106, v96
    v_add_f32 v107, v107, v97
    v_lshlrev_b32 v96, 16, v48
    v_and_b32 v97, 0xffff0000, v48
    v_add_f32 v100, v100, v96
    v_add_f32 v101, v101, v97
    v_lshlrev_b32 v96, 16, v49
    v_and_b32 v97, 0xffff0000, v49
    v_add_f32 v102, v102, v96
    v_add_f32 v103, v103, v97
    v_lshlrev_b32 v96, 16, v50
    v_and_b32 v97, 0xffff0000, v50
    v_add_f32 v104, v104, v96
    v_add_f32 v105, v105, v97
    v_lshlrev_b32 v96, 16, v51
    v_and_b32 v97, 0xffff0000, v51
    v_add_f32 v106, v106, v96
    v_add_f32 v107, v107, v97
    v_lshlrev_b32 v96, 16, v52
    v_and_b32 v97, 0xffff0000, v52
    v_add_f32 v100, v100, v96
    v_add_f32 v101, v101, v97
    v_lshlrev_b32 v96, 16, v53
    v_and_b32 v97, 0xffff0000, v53
    v_add_f32 v102, v102, v96
    v_add_f32 v103, v103, v97
    v_lshlrev_b32 v96, 16, v54
    v_and_b32 v97, 0xffff0000, v54
    v_add_f32 v104, v104, v96
    v_add_f32 v105, v105, v97
    v_lshlrev_b32 v96, 16, v55
    v_and_b32 v97, 0xffff0000, v55
    v_add_f32 v106, v106, v96
    v_add_f32 v107, v107, v97
    v_lshlrev_b32 v96, 16, v56
    v_and_b32 v97, 0xffff0000, v56
    v_add_f32 v100, v100, v96
    v_add_f32 v101, v101, v97
    v_lshlrev_b32 v96, 16, v57
    v_and_b32 v97, 0xffff0000, v57
    v_add_f32 v102, v102, v96
    v_add_f32 v103, v103, v97
    v_lshlrev_b32 v96, 16, v58
    v_and_b32 v97, 0xffff0000, v58
    v_add_f32 v104, v104, v96
    v_add_f32 v105, v105, v97
    v_lshlrev_b32 v96, 16, v59
    v_and_b32 v97, 0xffff0000, v59
    v_add_f32 v106, v106, v96
    v_add_f32 v107, v107, v97
    v_lshlrev_b32 v96, 16, v60
    v_and_b32 v97, 0xffff0000, v60
    v_add_f32 v100, v100, v96
    v_add_f32 v101, v101, v97
    v_lshlrev_b32 v96, 16, v61
    v_and_b32 v97, 0xffff0000, v61
    v_add_f32 v102, v102, v96
    v_add_f32 v103, v103, v97
    v_lshlrev_b32 v96, 16, v62
    v_and_b32 v97, 0xffff0000, v62
    v_add_f32 v104, v104, v96
    v_add_f32 v105, v105, v97
    v_lshlrev_b32 v96, 16, v63
    v_and_b32 v97, 0xffff0000, v63
    v_add_f32 v106, v106, v96
    v_add_f32 v107, v107, v97
    v_lshlrev_b32 v96, 16, v64
    v_and_b32 v97, 0xffff0000, v64
    v_add_f32 v100, v100, v96
    v_add_f32 v101, v101, v97
    v_lshlrev_b32 v96, 16, v65
    v_and_b32 v97, 0xffff0000, v65
    v_add_f32 v102, v102, v96
    v_add_f32 v103, v103, v97
    v_lshlrev_b32 v96, 16, v66
    v_and_b32 v97, 0xffff0000, v66
    v_add_f32 v104, v104, v96
    v_add_f32 v105, v105, v97
    v_lshlrev_b32 v96, 16, v67
    v_and_b32 v97, 0xffff0000, v67
    v_add_f32 v106, v106, v96
    v_add_f32 v107, v107, v97
    v_lshlrev_b32 v96, 16, v68
    v_and_b32 v97, 0xffff0000, v68
    v_add_f32 v100, v100, v96
    v_add_f32 v101, v101, v97
    v_lshlrev_b32 v96, 16, v69
    v_and_b32 v97, 0xffff0000, v69
    v_add_f32 v102, v102, v96
    v_add_f32 v103, v103, v97
    v_lshlrev_b32 v96, 16, v70
    v_and_b32 v97, 0xffff0000, v70
    v_add_f32 v104, v104, v96
    v_add_f32 v105, v105, v97
    v_lshlrev_b32 v96, 16, v71
    v_and_b32 v97, 0xffff0000, v71
    v_add_f32 v106, v106, v96
    v_add_f32 v107, v107, v97
    v_lshlrev_b32 v96, 16, v72
    v_and_b32 v97, 0xffff0000, v72
    v_add_f32 v100, v100, v96
    v_add_f32 v101, v101, v97
    v_lshlrev_b32 v96, 16, v73
    v_and_b32 v97, 0xffff0000, v73
    v_add_f32 v102, v102, v96
    v_add_f32 v103, v103, v97
    v_lshlrev_b32 v96, 16, v74
    v_and_b32 v97, 0xffff0000, v74
    v_add_f32 v104, v104, v96
    v_add_f32 v105, v105, v97
    v_lshlrev_b32 v96, 16, v75
    v_and_b32 v97, 0xffff0000, v75
    v_add_f32 v106, v106, v96
    v_add_f32 v107, v107, v97
    v_lshlrev_b32 v96, 16, v76
    v_and_b32 v97, 0xffff0000, v76
    v_add_f32 v100, v100, v96
    v_add_f32 v101, v101, v97
    v_lshlrev_b32 v96, 16, v77
    v_and_b32 v97, 0xffff0000, v77
    v_add_f32 v102, v102, v96
    v_add_f32 v103, v103, v97
    v_lshlrev_b32 v96, 16, v78
    v_and_b32 v97, 0xffff0000, v78
    v_add_f32 v104, v104, v96
    v_add_f32 v105, v105, v97
    v_lshlrev_b32 v96, 16, v79
    v_and_b32 v97, 0xffff0000, v79
    v_add_f32 v106, v106, v96
    v_add_f32 v107, v107, v97
    v_lshlrev_b32 v96, 16, v80
    v_and_b32 v97, 0xffff0000, v80
    v_add_f32 v100, v100, v96
    v_add_f32 v101, v101, v97
    v_lshlrev_b32 v96, 16, v81
    v_and_b32 v97, 0xffff0000, v81
    v_add_f32 v102, v102, v96
    v_add_f32 v103, v103, v97
    v_lshlrev_b32 v96, 16, v82
    v_and_b32 v97, 0xffff0000, v82
    v_add_f32 v104, v104, v96
    v_add_f32 v105, v105, v97
    v_lshlrev_b32 v96, 16, v83
    v_and_b32 v97, 0xffff0000, v83
    v_add_f32 v106, v106, v96
    v_add_f32 v107, v107, v97
    v_lshlrev_b32 v96, 16, v84
    v_and_b32 v97, 0xffff0000, v84
    v_add_f32 v100, v100, v96
    v_add_f32 v101, v101, v97
    v_lshlrev_b32 v96, 16, v85
    v_and_b32 v97, 0xffff0000, v85
    v_add_f32 v102, v102, v96
    v_add_f32 v103, v103, v97
    v_lshlrev_b32 v96, 16, v86
    v_and_b32 v97, 0xffff0000, v86
    v_add_f32 v104, v104, v96
    v_add_f32 v105, v105, v97
    v_lshlrev_b32 v96, 16, v87
    v_and_b32 v97, 0xffff0000, v87
    v_add_f32 v106, v106, v96
    v_add_f32 v107, v107, v97
    v_lshlrev_b32 v4, 8, v2
    v_lshlrev_b32 v5, 5, v1
    v_add_u32 v4, v4, v5
    ds_write_b128 v4, v[100:103]
    ds_write_b128 v4, v[104:107] offset:16
    s_waitcnt lgkmcnt(0)
    s_barrier
    v_cmp_gt_u32 vcc, 64, v0
    s_and_saveexec_b64 s[40:41], vcc
    s_cbranch_execz K0_cs_done
    v_lshlrev_b32 v4, 2, v0
    ds_read_b32 v8, v4 offset:0
    ds_read_b32 v9, v4 offset:256
    ds_read_b32 v10, v4 offset:512
    ds_read_b32 v11, v4 offset:768
    ds_read_b32 v12, v4 offset:1024
    ds_read_b32 v13, v4 offset:1280
    ds_read_b32 v14, v4 offset:1536
    ds_read_b32 v15, v4 offset:1792
    ds_read_b32 v16, v4 offset:2048
    ds_read_b32 v17, v4 offset:2304
    ds_read_b32 v18, v4 offset:2560
    ds_read_b32 v19, v4 offset:2816
    ds_read_b32 v20, v4 offset:3072
    ds_read_b32 v21, v4 offset:3328
    ds_read_b32 v22, v4 offset:3584
    ds_read_b32 v23, v4 offset:3840
    ds_read_b32 v24, v4 offset:4096
    ds_read_b32 v25, v4 offset:4352
    ds_read_b32 v26, v4 offset:4608
    ds_read_b32 v27, v4 offset:4864
    ds_read_b32 v28, v4 offset:5120
    ds_read_b32 v29, v4 offset:5376
    ds_read_b32 v30, v4 offset:5632
    ds_read_b32 v31, v4 offset:5888
    ds_read_b32 v32, v4 offset:6144
    ds_read_b32 v33, v4 offset:6400
    ds_read_b32 v34, v4 offset:6656
    ds_read_b32 v35, v4 offset:6912
    ds_read_b32 v36, v4 offset:7168
    ds_read_b32 v37, v4 offset:7424
    ds_read_b32 v38, v4 offset:7680
    ds_read_b32 v39, v4 offset:7936
    s_waitcnt lgkmcnt(0)
    v_add_f32 v8, v8, v9
    v_add_f32 v8, v8, v10
    v_add_f32 v8, v8, v11
    v_add_f32 v8, v8, v12
    v_add_f32 v8, v8, v13
    v_add_f32 v8, v8, v14
    v_add_f32 v8, v8, v15
    v_add_f32 v8, v8, v16
    v_add_f32 v8, v8, v17
    v_add_f32 v8, v8, v18
    v_add_f32 v8, v8, v19
    v_add_f32 v8, v8, v20
    v_add_f32 v8, v8, v21
    v_add_f32 v8, v8, v22
    v_add_f32 v8, v8, v23
    v_add_f32 v8, v8, v24
    v_add_f32 v8, v8, v25
    v_add_f32 v8, v8, v26
    v_add_f32 v8, v8, v27
    v_add_f32 v8, v8, v28
    v_add_f32 v8, v8, v29
    v_add_f32 v8, v8, v30
    v_add_f32 v8, v8, v31
    v_add_f32 v8, v8, v32
    v_add_f32 v8, v8, v33
    v_add_f32 v8, v8, v34
    v_add_f32 v8, v8, v35
    v_add_f32 v8, v8, v36
    v_add_f32 v8, v8, v37
    v_add_f32 v8, v8, v38
    v_add_f32 v8, v8, v39
    s_lshl_b32 s43, s3, 8
    buffer_store_dword v8, v4, s[32:35], s43 offen
K0_cs_done:
    s_mov_b64 exec, s[40:41]
    s_endpgm
K0_zero:
    s_add_u32 s32, s24, 20971520
    s_addc_u32 s33, s25, 0
    s_mov_b32 s34, 262144
    s_mov_b32 s35, 0x00020000
    s_sub_u32 s3, s2, 185
    s_lshl_b32 s3, s3, 14
    v_lshlrev_b32 v1, 4, v0
    v_mov_b32 v4, 0
    v_mov_b32 v5, 0
    v_mov_b32 v6, 0
    v_mov_b32 v7, 0
    buffer_store_dwordx4 v[4:7], v1, s[32:35], s3 offen
    s_add_u32 s3, s3, 4096
    buffer_store_dwordx4 v[4:7], v1, s[32:35], s3 offen
    s_add_u32 s3, s3, 4096
    buffer_store_dwordx4 v[4:7], v1, s[32:35], s3 offen
    s_add_u32 s3, s3, 4096
    buffer_store_dwordx4 v[4:7], v1, s[32:35], s3 offen
K0_end:
    s_endpgm
.globl k1_l0_kernel
.p2align 8
.type k1_l0_kernel,@function
k1_l0_kernel:
    s_mov_b32 s101, 0
    s_branch K1_body
.globl k1_l1_kernel
.p2align 8
.type k1_l1_kernel,@function
k1_l1_kernel:
    s_mov_b32 s101, 1
    s_branch K1_body
.p2align 8
K1_body:
    s_load_dwordx16 s[4:19], s[0:1], 0
    s_load_dwordx4 s[20:23], s[0:1], 64
    s_load_dwordx2 s[24:25], s[0:1], 80
    s_cmp_ge_u32 s2, 192
    s_cbranch_scc1 K1_end
    s_mov_b32 s99, 0x3c4ccccd
    s_mov_b32 s100, 0x42a00000
    v_lshrrev_b32 v1, 6, v0
    s_nop 0
    v_readfirstlane_b32 s26, v1
    s_waitcnt lgkmcnt(0)
    s_add_u32 s40, s24, 3145728
    s_addc_u32 s41, s25, 0
    s_cmp_eq_u32 s101, 0
    s_cselect_b32 s40, s4, s40
    s_cselect_b32 s41, s5, s41
    s_mov_b32 s28, s40
    s_mov_b32 s29, s41
    s_mov_b32 s30, 2621440
    s_mov_b32 s31, 0x00020000
    s_mov_b32 s32, s6
    s_mov_b32 s33, s7
    s_mov_b32 s34, 2457600
    s_mov_b32 s35, 0x00020000
    s_mul_i32 s42, s101, 262144
    s_add_u32 s42, s42, 21495808
    s_add_u32 s36, s24, s42
    s_addc_u32 s37, s25, 0
    s_mov_b32 s38, 131072
    s_mov_b32 s39, 0x00020000
    s_add_u32 s44, s24, 21233664
    s_addc_u32 s45, s25, 0
    s_mov_b32 s46, 7680
    s_mov_b32 s47, 0x00020000
    s_add_u32 s48, s24, 9437184
    s_addc_u32 s49, s25, 0
    s_mov_b32 s50, 2621440
    s_mov_b32 s51, 0x00020000
    s_and_b32 s52, s2, 15
    s_lshr_b32 s53, s2, 4
    s_lshl_b32 s54, s52, 7
    v_add_u32 v1, s54, v0
    v_lshlrev_b32 v1, 6, v1
    v_cmp_gt_u32 vcc, 128, v0
    s_and_saveexec_b64 s[56:57], vcc
    buffer_load_dwordx4 v[180:183], v1, s[36:39], 0 offen offset:0
    buffer_load_dwordx4 v[184:187], v1, s[36:39], 0 offen offset:16
    buffer_load_dwordx4 v[188:191], v1, s[36:39], 0 offen offset:32
    buffer_load_dwordx4 v[192:195], v1, s[36:39], 0 offen offset:48
    s_mov_b64 exec, s[56:57]
    s_cmp_ge_u32 s53, 8
    s_cbranch_scc1 K1_csq
    s_mul_i32 s55, s53, 320
    s_add_u32 s55, s55, 2560
    v_lshlrev_b32 v2, 4, v0
    v_cmp_le_u32 vcc, 20, v0
    s_nop 1
    v_mov_b32 v3, 2240
    v_cndmask_b32 v3, 0, v3, vcc
    v_add_u32 v2, v2, v3
    s_branch K1_csgo
K1_csq:
    s_sub_u32 s55, s53, 8
    s_mul_i32 s55, s55, 640
    v_lshlrev_b32 v2, 4, v0
K1_csgo:
    v_cmp_gt_u32 vcc, 40, v0
    s_and_saveexec_b64 s[56:57], vcc
    buffer_load_dwordx4 v[196:199], v2, s[44:47], s55 offen
    s_mov_b64 exec, s[56:57]
    v_and_b32 v1, 63, v0
    v_lshrrev_b32 v2, 3, v1
    v_and_b32 v3, 7, v1
    s_lshl_b32 s58, s26, 5
    v_add_u32 v4, s58, v2
    v_add_u32 v4, 0, v4
    v_lshrrev_b32 v5, 1, v4
    v_and_b32 v5, 7, v5
    v_xor_b32 v5, v5, v3
    v_lshlrev_b32 v5, 4, v5
    v_mul_u32_u24 v4, 1280, v4
    v_add_u32 v10, v4, v5
    v_add_u32 v4, s58, v2
    v_add_u32 v4, 8, v4
    v_lshrrev_b32 v5, 1, v4
    v_and_b32 v5, 7, v5
    v_xor_b32 v5, v5, v3
    v_lshlrev_b32 v5, 4, v5
    v_mul_u32_u24 v4, 1280, v4
    v_add_u32 v11, v4, v5
    v_add_u32 v4, s58, v2
    v_add_u32 v4, 16, v4
    v_lshrrev_b32 v5, 1, v4
    v_and_b32 v5, 7, v5
    v_xor_b32 v5, v5, v3
    v_lshlrev_b32 v5, 4, v5
    v_mul_u32_u24 v4, 1280, v4
    v_add_u32 v12, v4, v5
    v_add_u32 v4, s58, v2
    v_add_u32 v4, 24, v4
    v_lshrrev_b32 v5, 1, v4
    v_and_b32 v5, 7, v5
    v_xor_b32 v5, v5, v3
    v_lshlrev_b32 v5, 4, v5
    v_mul_u32_u24 v4, 1280, v4
    v_add_u32 v13, v4, v5
    s_mul_i32 s58, s26, 320
    s_cmp_ge_u32 s53, 8
    s_cselect_b32 s59, 0, 1120
    v_add_u32 v4, s58, v1
    v_add_u32 v4, 0, v4
    v_mov_b32 v7, 1639
    v_mul_u32_u24 v5, v7, v4
    v_lshrrev_b32 v5, 15, v5
    v_mul_u32_u24 v7, 20, v5
    v_sub_u32 v6, v4, v7
    v_mul_u32_u24 v5, 3840, v5
    v_lshlrev_b32 v7, 4, v6
    v_add_u32 v5, v5, v7
    v_cmp_le_u32 vcc, 10, v6
    v_mov_b32 v7, s59
    s_nop 0
    v_cndmask_b32 v7, 0, v7, vcc
    v_add_u32 v14, v5, v7
    v_add_u32 v4, s58, v1
    v_add_u32 v4, 64, v4
    v_mov_b32 v7, 1639
    v_mul_u32_u24 v5, v7, v4
    v_lshrrev_b32 v5, 15, v5
    v_mul_u32_u24 v7, 20, v5
    v_sub_u32 v6, v4, v7
    v_mul_u32_u24 v5, 3840, v5
    v_lshlrev_b32 v7, 4, v6
    v_add_u32 v5, v5, v7
    v_cmp_le_u32 vcc, 10, v6
    v_mov_b32 v7, s59
    s_nop 0
    v_cndmask_b32 v7, 0, v7, vcc
    v_add_u32 v15, v5, v7
    v_add_u32 v4, s58, v1
    v_add_u32 v4, 128, v4
    v_mov_b32 v7, 1639
    v_mul_u32_u24 v5, v7, v4
    v_lshrrev_b32 v5, 15, v5
    v_mul_u32_u24 v7, 20, v5
    v_sub_u32 v6, v4, v7
    v_mul_u32_u24 v5, 3840, v5
    v_lshlrev_b32 v7, 4, v6
    v_add_u32 v5, v5, v7
    v_cmp_le_u32 vcc, 10, v6
    v_mov_b32 v7, s59
    s_nop 0
    v_cndmask_b32 v7, 0, v7, vcc
    v_add_u32 v16, v5, v7
    v_add_u32 v4, s58, v1
    v_add_u32 v4, 192, v4
    v_mov_b32 v7, 1639
    v_mul_u32_u24 v5, v7, v4
    v_lshrrev_b32 v5, 15, v5
    v_mul_u32_u24 v7, 20, v5
    v_sub_u32 v6, v4, v7
    v_mul_u32_u24 v5, 3840, v5
    v_lshlrev_b32 v7, 4, v6
    v_add_u32 v5, v5, v7
    v_cmp_le_u32 vcc, 10, v6
    v_mov_b32 v7, s59
    s_nop 0
    v_cndmask_b32 v7, 0, v7, vcc
    v_add_u32 v17, v5, v7
    v_add_u32 v4, s58, v1
    v_add_u32 v4, 256, v4
    v_mov_b32 v7, 1639
    v_mul_u32_u24 v5, v7, v4
    v_lshrrev_b32 v5, 15, v5
    v_mul_u32_u24 v7, 20, v5
    v_sub_u32 v6, v4, v7
    v_mul_u32_u24 v5, 3840, v5
    v_lshlrev_b32 v7, 4, v6
    v_add_u32 v5, v5, v7
    v_cmp_le_u32 vcc, 10, v6
    v_mov_b32 v7, s59
    s_nop 0
    v_cndmask_b32 v7, 0, v7, vcc
    v_add_u32 v18, v5, v7
    s_mul_i32 s60, s52, 163840
    s_mul_i32 s61, s53, 160
    s_add_u32 s61, s61, 1280
    s_sub_u32 s62, s53, 8
    s_mul_i32 s62, s62, 320
    s_cmp_ge_u32 s53, 8
    s_cselect_b32 s61, s62, s61
    s_lshl_b32 s62, s26, 12
    s_mul_i32 s63, s26, 5120
    v_and_b32 v2, 31, v1
    s_lshl_b32 s58, s26, 5
    v_add_u32 v2, s58, v2
    v_lshrrev_b32 v3, 5, v1
    v_lshrrev_b32 v4, 1, v2
    v_and_b32 v4, 7, v4
    v_add_u32 v5, 0, v3
    v_xor_b32 v5, v5, v4
    v_lshlrev_b32 v5, 4, v5
    v_lshlrev_b32 v6, 7, v2
    v_add_u32 v20, v5, v6
    v_add_u32 v5, 2, v3
    v_xor_b32 v5, v5, v4
    v_lshlrev_b32 v5, 4, v5
    v_lshlrev_b32 v6, 7, v2
    v_add_u32 v21, v5, v6
    v_add_u32 v5, 4, v3
    v_xor_b32 v5, v5, v4
    v_lshlrev_b32 v5, 4, v5
    v_lshlrev_b32 v6, 7, v2
    v_add_u32 v22, v5, v6
    v_add_u32 v5, 6, v3
    v_xor_b32 v5, v5, v4
    v_lshlrev_b32 v5, 4, v5
    v_lshlrev_b32 v6, 7, v2
    v_add_u32 v23, v5, v6
    v_and_b32 v4, 15, v1
    v_lshrrev_b32 v5, 2, v4
    v_and_b32 v6, 3, v4
    v_lshlrev_b32 v7, 3, v3
    v_add_u32 v5, v5, v7
    v_mul_u32_u24 v5, 320, v5
    v_lshrrev_b32 v7, 4, v1
    v_and_b32 v7, 1, v7
    v_lshlrev_b32 v7, 5, v7
    v_add_u32 v5, v5, v7
    v_lshlrev_b32 v6, 3, v6
    v_add_u32 v5, v5, v6
    v_add_u32 v24, 69632, v5
    v_add_u32 v25, 110592, v5
    s_cmp_ge_u32 s53, 8
    s_cbranch_scc1 K1_qpath
    v_mov_b32 v100, 0
    v_mov_b32 v101, 0
    v_mov_b32 v102, 0
    v_mov_b32 v103, 0
    v_mov_b32 v104, 0
    v_mov_b32 v105, 0
    v_mov_b32 v106, 0
    v_mov_b32 v107, 0
    v_mov_b32 v108, 0
    v_mov_b32 v109, 0
    v_mov_b32 v110, 0
    v_mov_b32 v111, 0
    v_mov_b32 v112, 0
    v_mov_b32 v113, 0
    v_mov_b32 v114, 0
    v_mov_b32 v115, 0
    v_mov_b32 v116, 0
    v_mov_b32 v117, 0
    v_mov_b32 v118, 0
    v_mov_b32 v119, 0
    v_mov_b32 v120, 0
    v_mov_b32 v121, 0
    v_mov_b32 v122, 0
    v_mov_b32 v123, 0
    v_mov_b32 v124, 0
    v_mov_b32 v125, 0
    v_mov_b32 v126, 0
    v_mov_b32 v127, 0
    v_mov_b32 v128, 0
    v_mov_b32 v129, 0
    v_mov_b32 v130, 0
    v_mov_b32 v131, 0
    v_mov_b32 v132, 0
    v_mov_b32 v133, 0
    v_mov_b32 v134, 0
    v_mov_b32 v135, 0
    v_mov_b32 v136, 0
    v_mov_b32 v137, 0
    v_mov_b32 v138, 0
    v_mov_b32 v139, 0
    v_mov_b32 v140, 0
    v_mov_b32 v141, 0
    v_mov_b32 v142, 0
    v_mov_b32 v143, 0
    v_mov_b32 v144, 0
    v_mov_b32 v145, 0
    v_mov_b32 v146, 0
    v_mov_b32 v147, 0
    v_mov_b32 v148, 0
    v_mov_b32 v149, 0
    v_mov_b32 v150, 0
    v_mov_b32 v151, 0
    v_mov_b32 v152, 0
    v_mov_b32 v153, 0
    v_mov_b32 v154, 0
    v_mov_b32 v155, 0
    v_mov_b32 v156, 0
    v_mov_b32 v157, 0
    v_mov_b32 v158, 0
    v_mov_b32 v159, 0
    v_mov_b32 v160, 0
    v_mov_b32 v161, 0
    v_mov_b32 v162, 0
    v_mov_b32 v163, 0
    v_mov_b32 v164, 0
    v_mov_b32 v165, 0
    v_mov_b32 v166, 0
    v_mov_b32 v167, 0
    v_mov_b32 v168, 0
    v_mov_b32 v169, 0
    v_mov_b32 v170, 0
    v_mov_b32 v171, 0
    v_mov_b32 v172, 0
    v_mov_b32 v173, 0
    v_mov_b32 v174, 0
    v_mov_b32 v175, 0
    v_mov_b32 v176, 0
    v_mov_b32 v177, 0
    v_mov_b32 v178, 0
    v_mov_b32 v179, 0
    s_add_u32 m0, s62, 4096
    s_nop 0
    buffer_load_dwordx4 v10, s[28:31], s60 offen lds
    s_add_u32 m0, s62, 5120
    s_nop 0
    buffer_load_dwordx4 v11, s[28:31], s60 offen lds
    s_add_u32 m0, s62, 6144
    s_nop 0
    buffer_load_dwordx4 v12, s[28:31], s60 offen lds
    s_add_u32 m0, s62, 7168
    s_nop 0
    buffer_load_dwordx4 v13, s[28:31], s60 offen lds
    s_add_u32 s60, s60, 128
    s_add_u32 m0, s63, 69632
    s_nop 0
    buffer_load_dwordx4 v14, s[32:35], s61 offen lds
    s_add_u32 m0, s63, 70656
    s_nop 0
    buffer_load_dwordx4 v15, s[32:35], s61 offen lds
    s_add_u32 m0, s63, 71680
    s_nop 0
    buffer_load_dwordx4 v16, s[32:35], s61 offen lds
    s_add_u32 m0, s63, 72704
    s_nop 0
    buffer_load_dwordx4 v17, s[32:35], s61 offen lds
    s_add_u32 m0, s63, 73728
    s_nop 0
    buffer_load_dwordx4 v18, s[32:35], s61 offen lds
    s_add_u32 s61, s61, 245760
    s_add_u32 m0, s62, 20480
    s_nop 0
    buffer_load_dwordx4 v10, s[28:31], s60 offen lds
    s_add_u32 m0, s62, 21504
    s_nop 0
    buffer_load_dwordx4 v11, s[28:31], s60 offen lds
    s_add_u32 m0, s62, 22528
    s_nop 0
    buffer_load_dwordx4 v12, s[28:31], s60 offen lds
    s_add_u32 m0, s62, 23552
    s_nop 0
    buffer_load_dwordx4 v13, s[28:31], s60 offen lds
    s_add_u32 s60, s60, 128
    s_add_u32 m0, s63, 90112
    s_nop 0
    buffer_load_dwordx4 v14, s[32:35], s61 offen lds
    s_add_u32 m0, s63, 91136
    s_nop 0
    buffer_load_dwordx4 v15, s[32:35], s61 offen lds
    s_add_u32 m0, s63, 92160
    s_nop 0
    buffer_load_dwordx4 v16, s[32:35], s61 offen lds
    s_add_u32 m0, s63, 93184
    s_nop 0
    buffer_load_dwordx4 v17, s[32:35], s61 offen lds
    s_add_u32 m0, s63, 94208
    s_nop 0
    buffer_load_dwordx4 v18, s[32:35], s61 offen lds
    s_add_u32 s61, s61, 245760
    s_add_u32 m0, s62, 36864
    s_nop 0
    buffer_load_dwordx4 v10, s[28:31], s60 offen lds
    s_add_u32 m0, s62, 37888
    s_nop 0
    buffer_load_dwordx4 v11, s[28:31], s60 offen lds
    s_add_u32 m0, s62, 38912
    s_nop 0
    buffer_load_dwordx4 v12, s[28:31], s60 offen lds
    s_add_u32 m0, s62, 39936
    s_nop 0
    buffer_load_dwordx4 v13, s[28:31], s60 offen lds
    s_add_u32 s60, s60, 128
    s_add_u32 m0, s63, 110592
    s_nop 0
    buffer_load_dwordx4 v14, s[32:35], s61 offen lds
    s_add_u32 m0, s63, 111616
    s_nop 0
    buffer_load_dwordx4 v15, s[32:35], s61 offen lds
    s_add_u32 m0, s63, 112640
    s_nop 0
    buffer_load_dwordx4 v16, s[32:35], s61 offen lds
    s_add_u32 m0, s63, 113664
    s_nop 0
    buffer_load_dwordx4 v17, s[32:35], s61 offen lds
    s_add_u32 m0, s63, 114688
    s_nop 0
    buffer_load_dwordx4 v18, s[32:35], s61 offen lds
    s_add_u32 s61, s61, 245760
    s_waitcnt vmcnt(18)
    s_barrier
    v_cmp_gt_u32 vcc, 128, v0
    s_and_saveexec_b64 s[56:57], vcc
    v_add_f32 v202, v180, v182
    v_add_f32 v202, v202, v184
    v_add_f32 v202, v202, v186
    v_add_f32 v202, v202, v188
    v_add_f32 v202, v202, v190
    v_add_f32 v202, v202, v192
    v_add_f32 v202, v202, v194
    v_mul_f32 v202, 986500301, v202
    v_add_f32 v203, v181, v183
    v_add_f32 v203, v203, v185
    v_add_f32 v203, v203, v187
    v_add_f32 v203, v203, v189
    v_add_f32 v203, v203, v191
    v_add_f32 v203, v203, v193
    v_add_f32 v203, v203, v195
    v_fma_f32 v204, v180, s99, -v202
    v_mul_f32 v205, v204, v204
    v_fma_f32 v203, v205, s100, v203
    v_fma_f32 v204, v182, s99, -v202
    v_mul_f32 v205, v204, v204
    v_fma_f32 v203, v205, s100, v203
    v_fma_f32 v204, v184, s99, -v202
    v_mul_f32 v205, v204, v204
    v_fma_f32 v203, v205, s100, v203
    v_fma_f32 v204, v186, s99, -v202
    v_mul_f32 v205, v204, v204
    v_fma_f32 v203, v205, s100, v203
    v_fma_f32 v204, v188, s99, -v202
    v_mul_f32 v205, v204, v204
    v_fma_f32 v203, v205, s100, v203
    v_fma_f32 v204, v190, s99, -v202
    v_mul_f32 v205, v204, v204
    v_fma_f32 v203, v205, s100, v203
    v_fma_f32 v204, v192, s99, -v202
    v_mul_f32 v205, v204, v204
    v_fma_f32 v203, v205, s100, v203
    v_fma_f32 v204, v194, s99, -v202
    v_mul_f32 v205, v204, v204
    v_fma_f32 v203, v205, s100, v203
    v_mul_f32 v203, 986500301, v203
    v_add_f32 v203, 925353388, v203
    v_rsq_f32 v200, v203
    s_nop 0
    v_mul_f32 v201, v200, v202
    v_sub_f32 v201, 0, v201
    v_lshlrev_b32 v202, 3, v0
    ds_write_b64 v202, v[200:201] offset:0
    s_mov_b64 exec, s[56:57]
    v_cmp_gt_u32 vcc, 40, v0
    s_and_saveexec_b64 s[56:57], vcc
    v_lshlrev_b32 v202, 4, v0
    ds_write_b128 v202, v[196:199] offset:1024
    s_mov_b64 exec, s[56:57]
    ds_read_b128 v[40:43], v20 offset:4096
    ds_read_b64_tr_b16 v[44:45], v24 offset:0
    ds_read_b64_tr_b16 v[46:47], v24 offset:1280
    ds_read_b64_tr_b16 v[48:49], v24 offset:64
    ds_read_b64_tr_b16 v[50:51], v24 offset:1344
    ds_read_b64_tr_b16 v[52:53], v24 offset:128
    ds_read_b64_tr_b16 v[54:55], v24 offset:1408
    ds_read_b64_tr_b16 v[56:57], v24 offset:192
    ds_read_b64_tr_b16 v[58:59], v24 offset:1472
    ds_read_b64_tr_b16 v[60:61], v24 offset:256
    ds_read_b64_tr_b16 v[62:63], v24 offset:1536
    s_waitcnt lgkmcnt(0)
    v_mfma_f32_32x32x16_bf16 v[100:115], v[40:43], v[44:47], v[100:115]
    ds_read_b128 v[64:67], v21 offset:4096
    ds_read_b64_tr_b16 v[68:69], v24 offset:5120
    ds_read_b64_tr_b16 v[70:71], v24 offset:6400
    v_mfma_f32_32x32x16_bf16 v[116:131], v[40:43], v[48:51], v[116:131]
    ds_read_b64_tr_b16 v[72:73], v24 offset:5184
    ds_read_b64_tr_b16 v[74:75], v24 offset:6464
    ds_read_b64_tr_b16 v[76:77], v24 offset:5248
    s_add_u32 m0, s62, 53248
    s_nop 0
    buffer_load_dwordx4 v10, s[28:31], s60 offen lds
    v_mfma_f32_32x32x16_bf16 v[132:147], v[40:43], v[52:55], v[132:147]
    ds_read_b64_tr_b16 v[78:79], v24 offset:6528
    ds_read_b64_tr_b16 v[80:81], v24 offset:5312
    ds_read_b64_tr_b16 v[82:83], v24 offset:6592
    s_add_u32 m0, s62, 54272
    s_nop 0
    buffer_load_dwordx4 v11, s[28:31], s60 offen lds
    v_mfma_f32_32x32x16_bf16 v[148:163], v[40:43], v[56:59], v[148:163]
    ds_read_b64_tr_b16 v[84:85], v24 offset:5376
    ds_read_b64_tr_b16 v[86:87], v24 offset:6656
    s_add_u32 m0, s62, 55296
    s_nop 0
    buffer_load_dwordx4 v12, s[28:31], s60 offen lds
    v_mfma_f32_32x32x16_bf16 v[164:179], v[40:43], v[60:63], v[164:179]
    s_waitcnt lgkmcnt(0)
    v_mfma_f32_32x32x16_bf16 v[100:115], v[64:67], v[68:71], v[100:115]
    ds_read_b128 v[40:43], v22 offset:4096
    ds_read_b64_tr_b16 v[44:45], v24 offset:10240
    ds_read_b64_tr_b16 v[46:47], v24 offset:11520
    v_mfma_f32_32x32x16_bf16 v[116:131], v[64:67], v[72:75], v[116:131]
    ds_read_b64_tr_b16 v[48:49], v24 offset:10304
    ds_read_b64_tr_b16 v[50:51], v24 offset:11584
    ds_read_b64_tr_b16 v[52:53], v24 offset:10368
    s_add_u32 m0, s62, 56320
    s_nop 0
    buffer_load_dwordx4 v13, s[28:31], s60 offen lds
    s_add_u32 s60, s60, 128
    v_mfma_f32_32x32x16_bf16 v[132:147], v[64:67], v[76:79], v[132:147]
    ds_read_b64_tr_b16 v[54:55], v24 offset:11648
    ds_read_b64_tr_b16 v[56:57], v24 offset:10432
    ds_read_b64_tr_b16 v[58:59], v24 offset:11712
    v_mfma_f32_32x32x16_bf16 v[148:163], v[64:67], v[80:83], v[148:163]
    ds_read_b64_tr_b16 v[60:61], v24 offset:10496
    ds_read_b64_tr_b16 v[62:63], v24 offset:11776
    s_add_u32 m0, s63, 131072
    s_nop 0
    buffer_load_dwordx4 v14, s[32:35], s61 offen lds
    v_mfma_f32_32x32x16_bf16 v[164:179], v[64:67], v[84:87], v[164:179]
    s_waitcnt lgkmcnt(0)
    v_mfma_f32_32x32x16_bf16 v[100:115], v[40:43], v[44:47], v[100:115]
    ds_read_b128 v[64:67], v23 offset:4096
    ds_read_b64_tr_b16 v[68:69], v24 offset:15360
    ds_read_b64_tr_b16 v[70:71], v24 offset:16640
    v_mfma_f32_32x32x16_bf16 v[116:131], v[40:43], v[48:51], v[116:131]
    ds_read_b64_tr_b16 v[72:73], v24 offset:15424
    ds_read_b64_tr_b16 v[74:75], v24 offset:16704
    ds_read_b64_tr_b16 v[76:77], v24 offset:15488
    s_add_u32 m0, s63, 132096
    s_nop 0
    buffer_load_dwordx4 v15, s[32:35], s61 offen lds
    v_mfma_f32_32x32x16_bf16 v[132:147], v[40:43], v[52:55], v[132:147]
    ds_read_b64_tr_b16 v[78:79], v24 offset:16768
    ds_read_b64_tr_b16 v[80:81], v24 offset:15552
    ds_read_b64_tr_b16 v[82:83], v24 offset:16832
    v_mfma_f32_32x32x16_bf16 v[148:163], v[40:43], v[56:59], v[148:163]
    ds_read_b64_tr_b16 v[84:85], v24 offset:15616
    ds_read_b64_tr_b16 v[86:87], v24 offset:16896
    s_add_u32 m0, s63, 133120
    s_nop 0
    buffer_load_dwordx4 v16, s[32:35], s61 offen lds
    v_mfma_f32_32x32x16_bf16 v[164:179], v[40:43], v[60:63], v[164:179]
    s_waitcnt lgkmcnt(0)
    s_add_u32 m0, s63, 134144
    s_nop 0
    buffer_load_dwordx4 v17, s[32:35], s61 offen lds
    s_add_u32 m0, s63, 135168
    s_nop 0
    buffer_load_dwordx4 v18, s[32:35], s61 offen lds
    s_add_u32 s61, s61, 245760
    s_waitcnt vmcnt(18)
    s_barrier
    v_mfma_f32_32x32x16_bf16 v[100:115], v[64:67], v[68:71], v[100:115]
    ds_read_b128 v[40:43], v20 offset:20480
    ds_read_b64_tr_b16 v[44:45], v24 offset:20480
    ds_read_b64_tr_b16 v[46:47], v24 offset:21760
    v_mfma_f32_32x32x16_bf16 v[116:131], v[64:67], v[72:75], v[116:131]
    ds_read_b64_tr_b16 v[48:49], v24 offset:20544
    ds_read_b64_tr_b16 v[50:51], v24 offset:21824
    ds_read_b64_tr_b16 v[52:53], v24 offset:20608
    s_add_u32 m0, s62, 4096
    s_nop 0
    buffer_load_dwordx4 v10, s[28:31], s60 offen lds
    s_add_u32 m0, s62, 5120
    s_nop 0
    buffer_load_dwordx4 v11, s[28:31], s60 offen lds
    s_add_u32 m0, s62, 6144
    s_nop 0
    buffer_load_dwordx4 v12, s[28:31], s60 offen lds
    v_mfma_f32_32x32x16_bf16 v[132:147], v[64:67], v[76:79], v[132:147]
    ds_read_b64_tr_b16 v[54:55], v24 offset:21888
    ds_read_b64_tr_b16 v[56:57], v24 offset:20672
    ds_read_b64_tr_b16 v[58:59], v24 offset:21952
    s_add_u32 m0, s62, 7168
    s_nop 0
    buffer_load_dwordx4 v13, s[28:31], s60 offen lds
    s_add_u32 s60, s60, 128
    s_add_u32 m0, s63, 69632
    s_nop 0
    buffer_load_dwordx4 v14, s[32:35], s61 offen lds
    v_mfma_f32_32x32x16_bf16 v[148:163], v[64:67], v[80:83], v[148:163]
    ds_read_b64_tr_b16 v[60:61], v24 offset:20736
    ds_read_b64_tr_b16 v[62:63], v24 offset:22016
    s_add_u32 m0, s63, 70656
    s_nop 0
    buffer_load_dwordx4 v15, s[32:35], s61 offen lds
    s_add_u32 m0, s63, 71680
    s_nop 0
    buffer_load_dwordx4 v16, s[32:35], s61 offen lds
    v_mfma_f32_32x32x16_bf16 v[164:179], v[64:67], v[84:87], v[164:179]
    s_add_u32 m0, s63, 72704
    s_nop 0
    buffer_load_dwordx4 v17, s[32:35], s61 offen lds
    s_add_u32 m0, s63, 73728
    s_nop 0
    buffer_load_dwordx4 v18, s[32:35], s61 offen lds
    s_add_u32 s61, s61, 245760
    s_waitcnt lgkmcnt(0)
    v_mfma_f32_32x32x16_bf16 v[100:115], v[40:43], v[44:47], v[100:115]
    ds_read_b128 v[64:67], v21 offset:20480
    ds_read_b64_tr_b16 v[68:69], v24 offset:25600
    ds_read_b64_tr_b16 v[70:71], v24 offset:26880
    v_mfma_f32_32x32x16_bf16 v[116:131], v[40:43], v[48:51], v[116:131]
    ds_read_b64_tr_b16 v[72:73], v24 offset:25664
    ds_read_b64_tr_b16 v[74:75], v24 offset:26944
    ds_read_b64_tr_b16 v[76:77], v24 offset:25728
    v_mfma_f32_32x32x16_bf16 v[132:147], v[40:43], v[52:55], v[132:147]
    ds_read_b64_tr_b16 v[78:79], v24 offset:27008
    ds_read_b64_tr_b16 v[80:81], v24 offset:25792
    ds_read_b64_tr_b16 v[82:83], v24 offset:27072
    v_mfma_f32_32x32x16_bf16 v[148:163], v[40:43], v[56:59], v[148:163]
    ds_read_b64_tr_b16 v[84:85], v24 offset:25856
    ds_read_b64_tr_b16 v[86:87], v24 offset:27136
    v_mfma_f32_32x32x16_bf16 v[164:179], v[40:43], v[60:63], v[164:179]
    s_waitcnt lgkmcnt(0)
    v_mfma_f32_32x32x16_bf16 v[100:115], v[64:67], v[68:71], v[100:115]
    ds_read_b128 v[40:43], v22 offset:20480
    ds_read_b64_tr_b16 v[44:45], v24 offset:30720
    ds_read_b64_tr_b16 v[46:47], v24 offset:32000
    v_mfma_f32_32x32x16_bf16 v[116:131], v[64:67], v[72:75], v[116:131]
    ds_read_b64_tr_b16 v[48:49], v24 offset:30784
    ds_read_b64_tr_b16 v[50:51], v24 offset:32064
    ds_read_b64_tr_b16 v[52:53], v24 offset:30848
    v_mfma_f32_32x32x16_bf16 v[132:147], v[64:67], v[76:79], v[132:147]
    ds_read_b64_tr_b16 v[54:55], v24 offset:32128
    ds_read_b64_tr_b16 v[56:57], v24 offset:30912
    ds_read_b64_tr_b16 v[58:59], v24 offset:32192
    v_mfma_f32_32x32x16_bf16 v[148:163], v[64:67], v[80:83], v[148:163]
    ds_read_b64_tr_b16 v[60:61], v24 offset:30976
    ds_read_b64_tr_b16 v[62:63], v24 offset:32256
    v_mfma_f32_32x32x16_bf16 v[164:179], v[64:67], v[84:87], v[164:179]
    s_waitcnt lgkmcnt(0)
    v_mfma_f32_32x32x16_bf16 v[100:115], v[40:43], v[44:47], v[100:115]
    ds_read_b128 v[64:67], v23 offset:20480
    ds_read_b64_tr_b16 v[68:69], v24 offset:35840
    ds_read_b64_tr_b16 v[70:71], v24 offset:37120
    v_mfma_f32_32x32x16_bf16 v[116:131], v[40:43], v[48:51], v[116:131]
    ds_read_b64_tr_b16 v[72:73], v24 offset:35904
    ds_read_b64_tr_b16 v[74:75], v24 offset:37184
    ds_read_b64_tr_b16 v[76:77], v24 offset:35968
    v_mfma_f32_32x32x16_bf16 v[132:147], v[40:43], v[52:55], v[132:147]
    ds_read_b64_tr_b16 v[78:79], v24 offset:37248
    ds_read_b64_tr_b16 v[80:81], v24 offset:36032
    ds_read_b64_tr_b16 v[82:83], v24 offset:37312
    v_mfma_f32_32x32x16_bf16 v[148:163], v[40:43], v[56:59], v[148:163]
    ds_read_b64_tr_b16 v[84:85], v24 offset:36096
    ds_read_b64_tr_b16 v[86:87], v24 offset:37376
    v_mfma_f32_32x32x16_bf16 v[164:179], v[40:43], v[60:63], v[164:179]
    s_waitcnt lgkmcnt(0)
    s_waitcnt vmcnt(18)
    s_barrier
    v_mfma_f32_32x32x16_bf16 v[100:115], v[64:67], v[68:71], v[100:115]
    ds_read_b128 v[40:43], v20 offset:36864
    ds_read_b64_tr_b16 v[44:45], v24 offset:40960
    ds_read_b64_tr_b16 v[46:47], v24 offset:42240
    v_mfma_f32_32x32x16_bf16 v[116:131], v[64:67], v[72:75], v[116:131]
    ds_read_b64_tr_b16 v[48:49], v24 offset:41024
    ds_read_b64_tr_b16 v[50:51], v24 offset:42304
    ds_read_b64_tr_b16 v[52:53], v24 offset:41088
    s_add_u32 m0, s62, 20480
    s_nop 0
    buffer_load_dwordx4 v10, s[28:31], s60 offen lds
    s_add_u32 m0, s62, 21504
    s_nop 0
    buffer_load_dwordx4 v11, s[28:31], s60 offen lds
    s_add_u32 m0, s62, 22528
    s_nop 0
    buffer_load_dwordx4 v12, s[28:31], s60 offen lds
    v_mfma_f32_32x32x16_bf16 v[132:147], v[64:67], v[76:79], v[132:147]
    ds_read_b64_tr_b16 v[54:55], v24 offset:42368
    ds_read_b64_tr_b16 v[56:57], v24 offset:41152
    ds_read_b64_tr_b16 v[58:59], v24 offset:42432
    s_add_u32 m0, s62, 23552
    s_nop 0
    buffer_load_dwordx4 v13, s[28:31], s60 offen lds
    s_add_u32 s60, s60, 128
    s_add_u32 m0, s63, 90112
    s_nop 0
    buffer_load_dwordx4 v14, s[32:35], s61 offen lds
    v_mfma_f32_32x32x16_bf16 v[148:163], v[64:67], v[80:83], v[148:163]
    ds_read_b64_tr_b16 v[60:61], v24 offset:41216
    ds_read_b64_tr_b16 v[62:63], v24 offset:42496
    s_add_u32 m0, s63, 91136
    s_nop 0
    buffer_load_dwordx4 v15, s[32:35], s61 offen lds
    s_add_u32 m0, s63, 92160
    s_nop 0
    buffer_load_dwordx4 v16, s[32:35], s61 offen lds
    v_mfma_f32_32x32x16_bf16 v[164:179], v[64:67], v[84:87], v[164:179]
    s_add_u32 m0, s63, 93184
    s_nop 0
    buffer_load_dwordx4 v17, s[32:35], s61 offen lds
    s_add_u32 m0, s63, 94208
    s_nop 0
    buffer_load_dwordx4 v18, s[32:35], s61 offen lds
    s_add_u32 s61, s61, 245760
    s_waitcnt lgkmcnt(0)
    v_mfma_f32_32x32x16_bf16 v[100:115], v[40:43], v[44:47], v[100:115]
    ds_read_b128 v[64:67], v21 offset:36864
    ds_read_b64_tr_b16 v[68:69], v24 offset:46080
    ds_read_b64_tr_b16 v[70:71], v24 offset:47360
    v_mfma_f32_32x32x16_bf16 v[116:131], v[40:43], v[48:51], v[116:131]
    ds_read_b64_tr_b16 v[72:73], v24 offset:46144
    ds_read_b64_tr_b16 v[74:75], v24 offset:47424
    ds_read_b64_tr_b16 v[76:77], v24 offset:46208
    v_mfma_f32_32x32x16_bf16 v[132:147], v[40:43], v[52:55], v[132:147]
    ds_read_b64_tr_b16 v[78:79], v24 offset:47488
    ds_read_b64_tr_b16 v[80:81], v24 offset:46272
    ds_read_b64_tr_b16 v[82:83], v24 offset:47552
    v_mfma_f32_32x32x16_bf16 v[148:163], v[40:43], v[56:59], v[148:163]
    ds_read_b64_tr_b16 v[84:85], v24 offset:46336
    ds_read_b64_tr_b16 v[86:87], v24 offset:47616
    v_mfma_f32_32x32x16_bf16 v[164:179], v[40:43], v[60:63], v[164:179]
    s_waitcnt lgkmcnt(0)
    v_mfma_f32_32x32x16_bf16 v[100:115], v[64:67], v[68:71], v[100:115]
    ds_read_b128 v[40:43], v22 offset:36864
    ds_read_b64_tr_b16 v[44:45], v24 offset:51200
    ds_read_b64_tr_b16 v[46:47], v24 offset:52480
    v_mfma_f32_32x32x16_bf16 v[116:131], v[64:67], v[72:75], v[116:131]
    ds_read_b64_tr_b16 v[48:49], v24 offset:51264
    ds_read_b64_tr_b16 v[50:51], v24 offset:52544
    ds_read_b64_tr_b16 v[52:53], v24 offset:51328
    v_mfma_f32_32x32x16_bf16 v[132:147], v[64:67], v[76:79], v[132:147]
    ds_read_b64_tr_b16 v[54:55], v24 offset:52608
    ds_read_b64_tr_b16 v[56:57], v24 offset:51392
    ds_read_b64_tr_b16 v[58:59], v24 offset:52672
    v_mfma_f32_32x32x16_bf16 v[148:163], v[64:67], v[80:83], v[148:163]
    ds_read_b64_tr_b16 v[60:61], v24 offset:51456
    ds_read_b64_tr_b16 v[62:63], v24 offset:52736
    v_mfma_f32_32x32x16_bf16 v[164:179], v[64:67], v[84:87], v[164:179]
    s_waitcnt lgkmcnt(0)
    v_mfma_f32_32x32x16_bf16 v[100:115], v[40:43], v[44:47], v[100:115]
    ds_read_b128 v[64:67], v23 offset:36864
    ds_read_b64_tr_b16 v[68:69], v24 offset:56320
    ds_read_b64_tr_b16 v[70:71], v24 offset:57600
    v_mfma_f32_32x32x16_bf16 v[116:131], v[40:43], v[48:51], v[116:131]
    ds_read_b64_tr_b16 v[72:73], v24 offset:56384
    ds_read_b64_tr_b16 v[74:75], v24 offset:57664
    ds_read_b64_tr_b16 v[76:77], v24 offset:56448
    v_mfma_f32_32x32x16_bf16 v[132:147], v[40:43], v[52:55], v[132:147]
    ds_read_b64_tr_b16 v[78:79], v24 offset:57728
    ds_read_b64_tr_b16 v[80:81], v24 offset:56512
    ds_read_b64_tr_b16 v[82:83], v24 offset:57792
    v_mfma_f32_32x32x16_bf16 v[148:163], v[40:43], v[56:59], v[148:163]
    ds_read_b64_tr_b16 v[84:85], v24 offset:56576
    ds_read_b64_tr_b16 v[86:87], v24 offset:57856
    v_mfma_f32_32x32x16_bf16 v[164:179], v[40:43], v[60:63], v[164:179]
    s_waitcnt lgkmcnt(0)
    s_waitcnt vmcnt(18)
    s_barrier
    v_mfma_f32_32x32x16_bf16 v[100:115], v[64:67], v[68:71], v[100:115]
    ds_read_b128 v[40:43], v20 offset:53248
    ds_read_b64_tr_b16 v[44:45], v24 offset:61440
    ds_read_b64_tr_b16 v[46:47], v24 offset:62720
    v_mfma_f32_32x32x16_bf16 v[116:131], v[64:67], v[72:75], v[116:131]
    ds_read_b64_tr_b16 v[48:49], v24 offset:61504
    ds_read_b64_tr_b16 v[50:51], v24 offset:62784
    ds_read_b64_tr_b16 v[52:53], v24 offset:61568
    s_add_u32 m0, s62, 36864
    s_nop 0
    buffer_load_dwordx4 v10, s[28:31], s60 offen lds
    s_add_u32 m0, s62, 37888
    s_nop 0
    buffer_load_dwordx4 v11, s[28:31], s60 offen lds
    s_add_u32 m0, s62, 38912
    s_nop 0
    buffer_load_dwordx4 v12, s[28:31], s60 offen lds
    v_mfma_f32_32x32x16_bf16 v[132:147], v[64:67], v[76:79], v[132:147]
    ds_read_b64_tr_b16 v[54:55], v24 offset:62848
    ds_read_b64_tr_b16 v[56:57], v24 offset:61632
    ds_read_b64_tr_b16 v[58:59], v24 offset:62912
    s_add_u32 m0, s62, 39936
    s_nop 0
    buffer_load_dwordx4 v13, s[28:31], s60 offen lds
    s_add_u32 s60, s60, 128
    s_add_u32 m0, s63, 110592
    s_nop 0
    buffer_load_dwordx4 v14, s[32:35], s61 offen lds
    v_mfma_f32_32x32x16_bf16 v[148:163], v[64:67], v[80:83], v[148:163]
    ds_read_b64_tr_b16 v[60:61], v24 offset:61696
    ds_read_b64_tr_b16 v[62:63], v24 offset:62976
    s_add_u32 m0, s63, 111616
    s_nop 0
    buffer_load_dwordx4 v15, s[32:35], s61 offen lds
    s_add_u32 m0, s63, 112640
    s_nop 0
    buffer_load_dwordx4 v16, s[32:35], s61 offen lds
    v_mfma_f32_32x32x16_bf16 v[164:179], v[64:67], v[84:87], v[164:179]
    s_add_u32 m0, s63, 113664
    s_nop 0
    buffer_load_dwordx4 v17, s[32:35], s61 offen lds
    s_add_u32 m0, s63, 114688
    s_nop 0
    buffer_load_dwordx4 v18, s[32:35], s61 offen lds
    s_add_u32 s61, s61, 245760
    s_waitcnt lgkmcnt(0)
    v_mfma_f32_32x32x16_bf16 v[100:115], v[40:43], v[44:47], v[100:115]
    ds_read_b128 v[64:67], v21 offset:53248
    ds_read_b64_tr_b16 v[68:69], v25 offset:25600
    ds_read_b64_tr_b16 v[70:71], v25 offset:26880
    v_mfma_f32_32x32x16_bf16 v[116:131], v[40:43], v[48:51], v[116:131]
    ds_read_b64_tr_b16 v[72:73], v25 offset:25664
    ds_read_b64_tr_b16 v[74:75], v25 offset:26944
    ds_read_b64_tr_b16 v[76:77], v25 offset:25728
    v_mfma_f32_32x32x16_bf16 v[132:147], v[40:43], v[52:55], v[132:147]
    ds_read_b64_tr_b16 v[78:79], v25 offset:27008
    ds_read_b64_tr_b16 v[80:81], v25 offset:25792
    ds_read_b64_tr_b16 v[82:83], v25 offset:27072
    v_mfma_f32_32x32x16_bf16 v[148:163], v[40:43], v[56:59], v[148:163]
    ds_read_b64_tr_b16 v[84:85], v25 offset:25856
    ds_read_b64_tr_b16 v[86:87], v25 offset:27136
    v_mfma_f32_32x32x16_bf16 v[164:179], v[40:43], v[60:63], v[164:179]
    s_waitcnt lgkmcnt(0)
    v_mfma_f32_32x32x16_bf16 v[100:115], v[64:67], v[68:71], v[100:115]
    ds_read_b128 v[40:43], v22 offset:53248
    ds_read_b64_tr_b16 v[44:45], v25 offset:30720
    ds_read_b64_tr_b16 v[46:47], v25 offset:32000
    v_mfma_f32_32x32x16_bf16 v[116:131], v[64:67], v[72:75], v[116:131]
    ds_read_b64_tr_b16 v[48:49], v25 offset:30784
    ds_read_b64_tr_b16 v[50:51], v25 offset:32064
    ds_read_b64_tr_b16 v[52:53], v25 offset:30848
    v_mfma_f32_32x32x16_bf16 v[132:147], v[64:67], v[76:79], v[132:147]
    ds_read_b64_tr_b16 v[54:55], v25 offset:32128
    ds_read_b64_tr_b16 v[56:57], v25 offset:30912
    ds_read_b64_tr_b16 v[58:59], v25 offset:32192
    v_mfma_f32_32x32x16_bf16 v[148:163], v[64:67], v[80:83], v[148:163]
    ds_read_b64_tr_b16 v[60:61], v25 offset:30976
    ds_read_b64_tr_b16 v[62:63], v25 offset:32256
    v_mfma_f32_32x32x16_bf16 v[164:179], v[64:67], v[84:87], v[164:179]
    s_waitcnt lgkmcnt(0)
    v_mfma_f32_32x32x16_bf16 v[100:115], v[40:43], v[44:47], v[100:115]
    ds_read_b128 v[64:67], v23 offset:53248
    ds_read_b64_tr_b16 v[68:69], v25 offset:35840
    ds_read_b64_tr_b16 v[70:71], v25 offset:37120
    v_mfma_f32_32x32x16_bf16 v[116:131], v[40:43], v[48:51], v[116:131]
    ds_read_b64_tr_b16 v[72:73], v25 offset:35904
    ds_read_b64_tr_b16 v[74:75], v25 offset:37184
    ds_read_b64_tr_b16 v[76:77], v25 offset:35968
    v_mfma_f32_32x32x16_bf16 v[132:147], v[40:43], v[52:55], v[132:147]
    ds_read_b64_tr_b16 v[78:79], v25 offset:37248
    ds_read_b64_tr_b16 v[80:81], v25 offset:36032
    ds_read_b64_tr_b16 v[82:83], v25 offset:37312
    v_mfma_f32_32x32x16_bf16 v[148:163], v[40:43], v[56:59], v[148:163]
    ds_read_b64_tr_b16 v[84:85], v25 offset:36096
    ds_read_b64_tr_b16 v[86:87], v25 offset:37376
    v_mfma_f32_32x32x16_bf16 v[164:179], v[40:43], v[60:63], v[164:179]
    s_waitcnt lgkmcnt(0)
    s_waitcnt vmcnt(18)
    s_barrier
    v_mfma_f32_32x32x16_bf16 v[100:115], v[64:67], v[68:71], v[100:115]
    ds_read_b128 v[40:43], v20 offset:4096
    ds_read_b64_tr_b16 v[44:45], v24 offset:0
    ds_read_b64_tr_b16 v[46:47], v24 offset:1280
    v_mfma_f32_32x32x16_bf16 v[116:131], v[64:67], v[72:75], v[116:131]
    ds_read_b64_tr_b16 v[48:49], v24 offset:64
    ds_read_b64_tr_b16 v[50:51], v24 offset:1344
    ds_read_b64_tr_b16 v[52:53], v24 offset:128
    s_add_u32 m0, s62, 53248
    s_nop 0
    buffer_load_dwordx4 v10, s[28:31], s60 offen lds
    s_add_u32 m0, s62, 54272
    s_nop 0
    buffer_load_dwordx4 v11, s[28:31], s60 offen lds
    s_add_u32 m0, s62, 55296
    s_nop 0
    buffer_load_dwordx4 v12, s[28:31], s60 offen lds
    v_mfma_f32_32x32x16_bf16 v[132:147], v[64:67], v[76:79], v[132:147]
    ds_read_b64_tr_b16 v[54:55], v24 offset:1408
    ds_read_b64_tr_b16 v[56:57], v24 offset:192
    ds_read_b64_tr_b16 v[58:59], v24 offset:1472
    s_add_u32 m0, s62, 56320
    s_nop 0
    buffer_load_dwordx4 v13, s[28:31], s60 offen lds
    s_add_u32 s60, s60, 128
    s_add_u32 m0, s63, 131072
    s_nop 0
    buffer_load_dwordx4 v14, s[32:35], s61 offen lds
    v_mfma_f32_32x32x16_bf16 v[148:163], v[64:67], v[80:83], v[148:163]
    ds_read_b64_tr_b16 v[60:61], v24 offset:256
    ds_read_b64_tr_b16 v[62:63], v24 offset:1536
    s_add_u32 m0, s63, 132096
    s_nop 0
    buffer_load_dwordx4 v15, s[32:35], s61 offen lds
    s_add_u32 m0, s63, 133120
    s_nop 0
    buffer_load_dwordx4 v16, s[32:35], s61 offen lds
    v_mfma_f32_32x32x16_bf16 v[164:179], v[64:67], v[84:87], v[164:179]
    s_add_u32 m0, s63, 134144
    s_nop 0
    buffer_load_dwordx4 v17, s[32:35], s61 offen lds
    s_add_u32 m0, s63, 135168
    s_nop 0
    buffer_load_dwordx4 v18, s[32:35], s61 offen lds
    s_add_u32 s61, s61, 245760
    s_waitcnt lgkmcnt(0)
    v_mfma_f32_32x32x16_bf16 v[100:115], v[40:43], v[44:47], v[100:115]
    ds_read_b128 v[64:67], v21 offset:4096
    ds_read_b64_tr_b16 v[68:69], v24 offset:5120
    ds_read_b64_tr_b16 v[70:71], v24 offset:6400
    v_mfma_f32_32x32x16_bf16 v[116:131], v[40:43], v[48:51], v[116:131]
    ds_read_b64_tr_b16 v[72:73], v24 offset:5184
    ds_read_b64_tr_b16 v[74:75], v24 offset:6464
    ds_read_b64_tr_b16 v[76:77], v24 offset:5248
    v_mfma_f32_32x32x16_bf16 v[132:147], v[40:43], v[52:55], v[132:147]
    ds_read_b64_tr_b16 v[78:79], v24 offset:6528
    ds_read_b64_tr_b16 v[80:81], v24 offset:5312
    ds_read_b64_tr_b16 v[82:83], v24 offset:6592
    v_mfma_f32_32x32x16_bf16 v[148:163], v[40:43], v[56:59], v[148:163]
    ds_read_b64_tr_b16 v[84:85], v24 offset:5376
    ds_read_b64_tr_b16 v[86:87], v24 offset:6656
    v_mfma_f32_32x32x16_bf16 v[164:179], v[40:43], v[60:63], v[164:179]
    s_waitcnt lgkmcnt(0)
    v_mfma_f32_32x32x16_bf16 v[100:115], v[64:67], v[68:71], v[100:115]
    ds_read_b128 v[40:43], v22 offset:4096
    ds_read_b64_tr_b16 v[44:45], v24 offset:10240
    ds_read_b64_tr_b16 v[46:47], v24 offset:11520
    v_mfma_f32_32x32x16_bf16 v[116:131], v[64:67], v[72:75], v[116:131]
    ds_read_b64_tr_b16 v[48:49], v24 offset:10304
    ds_read_b64_tr_b16 v[50:51], v24 offset:11584
    ds_read_b64_tr_b16 v[52:53], v24 offset:10368
    v_mfma_f32_32x32x16_bf16 v[132:147], v[64:67], v[76:79], v[132:147]
    ds_read_b64_tr_b16 v[54:55], v24 offset:11648
    ds_read_b64_tr_b16 v[56:57], v24 offset:10432
    ds_read_b64_tr_b16 v[58:59], v24 offset:11712
    v_mfma_f32_32x32x16_bf16 v[148:163], v[64:67], v[80:83], v[148:163]
    ds_read_b64_tr_b16 v[60:61], v24 offset:10496
    ds_read_b64_tr_b16 v[62:63], v24 offset:11776
    v_mfma_f32_32x32x16_bf16 v[164:179], v[64:67], v[84:87], v[164:179]
    s_waitcnt lgkmcnt(0)
    v_mfma_f32_32x32x16_bf16 v[100:115], v[40:43], v[44:47], v[100:115]
    ds_read_b128 v[64:67], v23 offset:4096
    ds_read_b64_tr_b16 v[68:69], v24 offset:15360
    ds_read_b64_tr_b16 v[70:71], v24 offset:16640
    v_mfma_f32_32x32x16_bf16 v[116:131], v[40:43], v[48:51], v[116:131]
    ds_read_b64_tr_b16 v[72:73], v24 offset:15424
    ds_read_b64_tr_b16 v[74:75], v24 offset:16704
    ds_read_b64_tr_b16 v[76:77], v24 offset:15488
    v_mfma_f32_32x32x16_bf16 v[132:147], v[40:43], v[52:55], v[132:147]
    ds_read_b64_tr_b16 v[78:79], v24 offset:16768
    ds_read_b64_tr_b16 v[80:81], v24 offset:15552
    ds_read_b64_tr_b16 v[82:83], v24 offset:16832
    v_mfma_f32_32x32x16_bf16 v[148:163], v[40:43], v[56:59], v[148:163]
    ds_read_b64_tr_b16 v[84:85], v24 offset:15616
    ds_read_b64_tr_b16 v[86:87], v24 offset:16896
    v_mfma_f32_32x32x16_bf16 v[164:179], v[40:43], v[60:63], v[164:179]
    s_waitcnt lgkmcnt(0)
    s_waitcnt vmcnt(18)
    s_barrier
    v_mfma_f32_32x32x16_bf16 v[100:115], v[64:67], v[68:71], v[100:115]
    ds_read_b128 v[40:43], v20 offset:20480
    ds_read_b64_tr_b16 v[44:45], v24 offset:20480
    ds_read_b64_tr_b16 v[46:47], v24 offset:21760
    v_mfma_f32_32x32x16_bf16 v[116:131], v[64:67], v[72:75], v[116:131]
    ds_read_b64_tr_b16 v[48:49], v24 offset:20544
    ds_read_b64_tr_b16 v[50:51], v24 offset:21824
    ds_read_b64_tr_b16 v[52:53], v24 offset:20608
    s_add_u32 m0, s62, 4096
    s_nop 0
    buffer_load_dwordx4 v10, s[28:31], s60 offen lds
    s_add_u32 m0, s62, 5120
    s_nop 0
    buffer_load_dwordx4 v11, s[28:31], s60 offen lds
    s_add_u32 m0, s62, 6144
    s_nop 0
    buffer_load_dwordx4 v12, s[28:31], s60 offen lds
    v_mfma_f32_32x32x16_bf16 v[132:147], v[64:67], v[76:79], v[132:147]
    ds_read_b64_tr_b16 v[54:55], v24 offset:21888
    ds_read_b64_tr_b16 v[56:57], v24 offset:20672
    ds_read_b64_tr_b16 v[58:59], v24 offset:21952
    s_add_u32 m0, s62, 7168
    s_nop 0
    buffer_load_dwordx4 v13, s[28:31], s60 offen lds
    s_add_u32 s60, s60, 128
    s_add_u32 m0, s63, 69632
    s_nop 0
    buffer_load_dwordx4 v14, s[32:35], s61 offen lds
    v_mfma_f32_32x32x16_bf16 v[148:163], v[64:67], v[80:83], v[148:163]
    ds_read_b64_tr_b16 v[60:61], v24 offset:20736
    ds_read_b64_tr_b16 v[62:63], v24 offset:22016
    s_add_u32 m0, s63, 70656
    s_nop 0
    buffer_load_dwordx4 v15, s[32:35], s61 offen lds
    s_add_u32 m0, s63, 71680
    s_nop 0
    buffer_load_dwordx4 v16, s[32:35], s61 offen lds
    v_mfma_f32_32x32x16_bf16 v[164:179], v[64:67], v[84:87], v[164:179]
    s_add_u32 m0, s63, 72704
    s_nop 0
    buffer_load_dwordx4 v17, s[32:35], s61 offen lds
    s_add_u32 m0, s63, 73728
    s_nop 0
    buffer_load_dwordx4 v18, s[32:35], s61 offen lds
    s_add_u32 s61, s61, 245760
    s_waitcnt lgkmcnt(0)
    v_mfma_f32_32x32x16_bf16 v[100:115], v[40:43], v[44:47], v[100:115]
    ds_read_b128 v[64:67], v21 offset:20480
    ds_read_b64_tr_b16 v[68:69], v24 offset:25600
    ds_read_b64_tr_b16 v[70:71], v24 offset:26880
    v_mfma_f32_32x32x16_bf16 v[116:131], v[40:43], v[48:51], v[116:131]
    ds_read_b64_tr_b16 v[72:73], v24 offset:25664
    ds_read_b64_tr_b16 v[74:75], v24 offset:26944
    ds_read_b64_tr_b16 v[76:77], v24 offset:25728
    v_mfma_f32_32x32x16_bf16 v[132:147], v[40:43], v[52:55], v[132:147]
    ds_read_b64_tr_b16 v[78:79], v24 offset:27008
    ds_read_b64_tr_b16 v[80:81], v24 offset:25792
    ds_read_b64_tr_b16 v[82:83], v24 offset:27072
    v_mfma_f32_32x32x16_bf16 v[148:163], v[40:43], v[56:59], v[148:163]
    ds_read_b64_tr_b16 v[84:85], v24 offset:25856
    ds_read_b64_tr_b16 v[86:87], v24 offset:27136
    v_mfma_f32_32x32x16_bf16 v[164:179], v[40:43], v[60:63], v[164:179]
    s_waitcnt lgkmcnt(0)
    v_mfma_f32_32x32x16_bf16 v[100:115], v[64:67], v[68:71], v[100:115]
    ds_read_b128 v[40:43], v22 offset:20480
    ds_read_b64_tr_b16 v[44:45], v24 offset:30720
    ds_read_b64_tr_b16 v[46:47], v24 offset:32000
    v_mfma_f32_32x32x16_bf16 v[116:131], v[64:67], v[72:75], v[116:131]
    ds_read_b64_tr_b16 v[48:49], v24 offset:30784
    ds_read_b64_tr_b16 v[50:51], v24 offset:32064
    ds_read_b64_tr_b16 v[52:53], v24 offset:30848
    v_mfma_f32_32x32x16_bf16 v[132:147], v[64:67], v[76:79], v[132:147]
    ds_read_b64_tr_b16 v[54:55], v24 offset:32128
    ds_read_b64_tr_b16 v[56:57], v24 offset:30912
    ds_read_b64_tr_b16 v[58:59], v24 offset:32192
    v_mfma_f32_32x32x16_bf16 v[148:163], v[64:67], v[80:83], v[148:163]
    ds_read_b64_tr_b16 v[60:61], v24 offset:30976
    ds_read_b64_tr_b16 v[62:63], v24 offset:32256
    v_mfma_f32_32x32x16_bf16 v[164:179], v[64:67], v[84:87], v[164:179]
    s_waitcnt lgkmcnt(0)
    v_mfma_f32_32x32x16_bf16 v[100:115], v[40:43], v[44:47], v[100:115]
    ds_read_b128 v[64:67], v23 offset:20480
    ds_read_b64_tr_b16 v[68:69], v24 offset:35840
    ds_read_b64_tr_b16 v[70:71], v24 offset:37120
    v_mfma_f32_32x32x16_bf16 v[116:131], v[40:43], v[48:51], v[116:131]
    ds_read_b64_tr_b16 v[72:73], v24 offset:35904
    ds_read_b64_tr_b16 v[74:75], v24 offset:37184
    ds_read_b64_tr_b16 v[76:77], v24 offset:35968
    v_mfma_f32_32x32x16_bf16 v[132:147], v[40:43], v[52:55], v[132:147]
    ds_read_b64_tr_b16 v[78:79], v24 offset:37248
    ds_read_b64_tr_b16 v[80:81], v24 offset:36032
    ds_read_b64_tr_b16 v[82:83], v24 offset:37312
    v_mfma_f32_32x32x16_bf16 v[148:163], v[40:43], v[56:59], v[148:163]
    ds_read_b64_tr_b16 v[84:85], v24 offset:36096
    ds_read_b64_tr_b16 v[86:87], v24 offset:37376
    v_mfma_f32_32x32x16_bf16 v[164:179], v[40:43], v[60:63], v[164:179]
    s_waitcnt lgkmcnt(0)
    s_waitcnt vmcnt(18)
    s_barrier
    v_mfma_f32_32x32x16_bf16 v[100:115], v[64:67], v[68:71], v[100:115]
    ds_read_b128 v[40:43], v20 offset:36864
    ds_read_b64_tr_b16 v[44:45], v24 offset:40960
    ds_read_b64_tr_b16 v[46:47], v24 offset:42240
    v_mfma_f32_32x32x16_bf16 v[116:131], v[64:67], v[72:75], v[116:131]
    ds_read_b64_tr_b16 v[48:49], v24 offset:41024
    ds_read_b64_tr_b16 v[50:51], v24 offset:42304
    ds_read_b64_tr_b16 v[52:53], v24 offset:41088
    s_add_u32 m0, s62, 20480
    s_nop 0
    buffer_load_dwordx4 v10, s[28:31], s60 offen lds
    s_add_u32 m0, s62, 21504
    s_nop 0
    buffer_load_dwordx4 v11, s[28:31], s60 offen lds
    s_add_u32 m0, s62, 22528
    s_nop 0
    buffer_load_dwordx4 v12, s[28:31], s60 offen lds
    v_mfma_f32_32x32x16_bf16 v[132:147], v[64:67], v[76:79], v[132:147]
    ds_read_b64_tr_b16 v[54:55], v24 offset:42368
    ds_read_b64_tr_b16 v[56:57], v24 offset:41152
    ds_read_b64_tr_b16 v[58:59], v24 offset:42432
    s_add_u32 m0, s62, 23552
    s_nop 0
    buffer_load_dwordx4 v13, s[28:31], s60 offen lds
    s_add_u32 s60, s60, 128
    s_add_u32 m0, s63, 90112
    s_nop 0
    buffer_load_dwordx4 v14, s[32:35], s61 offen lds
    v_mfma_f32_32x32x16_bf16 v[148:163], v[64:67], v[80:83], v[148:163]
    ds_read_b64_tr_b16 v[60:61], v24 offset:41216
    ds_read_b64_tr_b16 v[62:63], v24 offset:42496
    s_add_u32 m0, s63, 91136
    s_nop 0
    buffer_load_dwordx4 v15, s[32:35], s61 offen lds
    s_add_u32 m0, s63, 92160
    s_nop 0
    buffer_load_dwordx4 v16, s[32:35], s61 offen lds
    v_mfma_f32_32x32x16_bf16 v[164:179], v[64:67], v[84:87], v[164:179]
    s_add_u32 m0, s63, 93184
    s_nop 0
    buffer_load_dwordx4 v17, s[32:35], s61 offen lds
    s_add_u32 m0, s63, 94208
    s_nop 0
    buffer_load_dwordx4 v18, s[32:35], s61 offen lds
    s_add_u32 s61, s61, 245760
    s_waitcnt lgkmcnt(0)
    v_mfma_f32_32x32x16_bf16 v[100:115], v[40:43], v[44:47], v[100:115]
    ds_read_b128 v[64:67], v21 offset:36864
    ds_read_b64_tr_b16 v[68:69], v24 offset:46080
    ds_read_b64_tr_b16 v[70:71], v24 offset:47360
    v_mfma_f32_32x32x16_bf16 v[116:131], v[40:43], v[48:51], v[116:131]
    ds_read_b64_tr_b16 v[72:73], v24 offset:46144
    ds_read_b64_tr_b16 v[74:75], v24 offset:47424
    ds_read_b64_tr_b16 v[76:77], v24 offset:46208
    v_mfma_f32_32x32x16_bf16 v[132:147], v[40:43], v[52:55], v[132:147]
    ds_read_b64_tr_b16 v[78:79], v24 offset:47488
    ds_read_b64_tr_b16 v[80:81], v24 offset:46272
    ds_read_b64_tr_b16 v[82:83], v24 offset:47552
    v_mfma_f32_32x32x16_bf16 v[148:163], v[40:43], v[56:59], v[148:163]
    ds_read_b64_tr_b16 v[84:85], v24 offset:46336
    ds_read_b64_tr_b16 v[86:87], v24 offset:47616
    v_mfma_f32_32x32x16_bf16 v[164:179], v[40:43], v[60:63], v[164:179]
    s_waitcnt lgkmcnt(0)
    v_mfma_f32_32x32x16_bf16 v[100:115], v[64:67], v[68:71], v[100:115]
    ds_read_b128 v[40:43], v22 offset:36864
    ds_read_b64_tr_b16 v[44:45], v24 offset:51200
    ds_read_b64_tr_b16 v[46:47], v24 offset:52480
    v_mfma_f32_32x32x16_bf16 v[116:131], v[64:67], v[72:75], v[116:131]
    ds_read_b64_tr_b16 v[48:49], v24 offset:51264
    ds_read_b64_tr_b16 v[50:51], v24 offset:52544
    ds_read_b64_tr_b16 v[52:53], v24 offset:51328
    v_mfma_f32_32x32x16_bf16 v[132:147], v[64:67], v[76:79], v[132:147]
    ds_read_b64_tr_b16 v[54:55], v24 offset:52608
    ds_read_b64_tr_b16 v[56:57], v24 offset:51392
    ds_read_b64_tr_b16 v[58:59], v24 offset:52672
    v_mfma_f32_32x32x16_bf16 v[148:163], v[64:67], v[80:83], v[148:163]
    ds_read_b64_tr_b16 v[60:61], v24 offset:51456
    ds_read_b64_tr_b16 v[62:63], v24 offset:52736
    v_mfma_f32_32x32x16_bf16 v[164:179], v[64:67], v[84:87], v[164:179]
    s_waitcnt lgkmcnt(0)
    v_mfma_f32_32x32x16_bf16 v[100:115], v[40:43], v[44:47], v[100:115]
    ds_read_b128 v[64:67], v23 offset:36864
    ds_read_b64_tr_b16 v[68:69], v24 offset:56320
    ds_read_b64_tr_b16 v[70:71], v24 offset:57600
    v_mfma_f32_32x32x16_bf16 v[116:131], v[40:43], v[48:51], v[116:131]
    ds_read_b64_tr_b16 v[72:73], v24 offset:56384
    ds_read_b64_tr_b16 v[74:75], v24 offset:57664
    ds_read_b64_tr_b16 v[76:77], v24 offset:56448
    v_mfma_f32_32x32x16_bf16 v[132:147], v[40:43], v[52:55], v[132:147]
    ds_read_b64_tr_b16 v[78:79], v24 offset:57728
    ds_read_b64_tr_b16 v[80:81], v24 offset:56512
    ds_read_b64_tr_b16 v[82:83], v24 offset:57792
    v_mfma_f32_32x32x16_bf16 v[148:163], v[40:43], v[56:59], v[148:163]
    ds_read_b64_tr_b16 v[84:85], v24 offset:56576
    ds_read_b64_tr_b16 v[86:87], v24 offset:57856
    v_mfma_f32_32x32x16_bf16 v[164:179], v[40:43], v[60:63], v[164:179]
    s_waitcnt lgkmcnt(0)
    s_waitcnt vmcnt(18)
    s_barrier
    v_mfma_f32_32x32x16_bf16 v[100:115], v[64:67], v[68:71], v[100:115]
    ds_read_b128 v[40:43], v20 offset:53248
    ds_read_b64_tr_b16 v[44:45], v24 offset:61440
    ds_read_b64_tr_b16 v[46:47], v24 offset:62720
    v_mfma_f32_32x32x16_bf16 v[116:131], v[64:67], v[72:75], v[116:131]
    ds_read_b64_tr_b16 v[48:49], v24 offset:61504
    ds_read_b64_tr_b16 v[50:51], v24 offset:62784
    ds_read_b64_tr_b16 v[52:53], v24 offset:61568
    v_mfma_f32_32x32x16_bf16 v[132:147], v[64:67], v[76:79], v[132:147]
    ds_read_b64_tr_b16 v[54:55], v24 offset:62848
    ds_read_b64_tr_b16 v[56:57], v24 offset:61632
    ds_read_b64_tr_b16 v[58:59], v24 offset:62912
    v_mfma_f32_32x32x16_bf16 v[148:163], v[64:67], v[80:83], v[148:163]
    ds_read_b64_tr_b16 v[60:61], v24 offset:61696
    ds_read_b64_tr_b16 v[62:63], v24 offset:62976
    v_mfma_f32_32x32x16_bf16 v[164:179], v[64:67], v[84:87], v[164:179]
    s_waitcnt lgkmcnt(0)
    v_mfma_f32_32x32x16_bf16 v[100:115], v[40:43], v[44:47], v[100:115]
    ds_read_b128 v[64:67], v21 offset:53248
    ds_read_b64_tr_b16 v[68:69], v25 offset:25600
    ds_read_b64_tr_b16 v[70:71], v25 offset:26880
    v_mfma_f32_32x32x16_bf16 v[116:131], v[40:43], v[48:51], v[116:131]
    ds_read_b64_tr_b16 v[72:73], v25 offset:25664
    ds_read_b64_tr_b16 v[74:75], v25 offset:26944
    ds_read_b64_tr_b16 v[76:77], v25 offset:25728
    v_mfma_f32_32x32x16_bf16 v[132:147], v[40:43], v[52:55], v[132:147]
    ds_read_b64_tr_b16 v[78:79], v25 offset:27008
    ds_read_b64_tr_b16 v[80:81], v25 offset:25792
    ds_read_b64_tr_b16 v[82:83], v25 offset:27072
    v_mfma_f32_32x32x16_bf16 v[148:163], v[40:43], v[56:59], v[148:163]
    ds_read_b64_tr_b16 v[84:85], v25 offset:25856
    ds_read_b64_tr_b16 v[86:87], v25 offset:27136
    v_mfma_f32_32x32x16_bf16 v[164:179], v[40:43], v[60:63], v[164:179]
    s_waitcnt lgkmcnt(0)
    v_mfma_f32_32x32x16_bf16 v[100:115], v[64:67], v[68:71], v[100:115]
    ds_read_b128 v[40:43], v22 offset:53248
    ds_read_b64_tr_b16 v[44:45], v25 offset:30720
    ds_read_b64_tr_b16 v[46:47], v25 offset:32000
    v_mfma_f32_32x32x16_bf16 v[116:131], v[64:67], v[72:75], v[116:131]
    ds_read_b64_tr_b16 v[48:49], v25 offset:30784
    ds_read_b64_tr_b16 v[50:51], v25 offset:32064
    ds_read_b64_tr_b16 v[52:53], v25 offset:30848
    v_mfma_f32_32x32x16_bf16 v[132:147], v[64:67], v[76:79], v[132:147]
    ds_read_b64_tr_b16 v[54:55], v25 offset:32128
    ds_read_b64_tr_b16 v[56:57], v25 offset:30912
    ds_read_b64_tr_b16 v[58:59], v25 offset:32192
    v_mfma_f32_32x32x16_bf16 v[148:163], v[64:67], v[80:83], v[148:163]
    ds_read_b64_tr_b16 v[60:61], v25 offset:30976
    ds_read_b64_tr_b16 v[62:63], v25 offset:32256
    v_mfma_f32_32x32x16_bf16 v[164:179], v[64:67], v[84:87], v[164:179]
    s_waitcnt lgkmcnt(0)
    v_mfma_f32_32x32x16_bf16 v[100:115], v[40:43], v[44:47], v[100:115]
    ds_read_b128 v[64:67], v23 offset:53248
    ds_read_b64_tr_b16 v[68:69], v25 offset:35840
    ds_read_b64_tr_b16 v[70:71], v25 offset:37120
    v_mfma_f32_32x32x16_bf16 v[116:131], v[40:43], v[48:51], v[116:131]
    ds_read_b64_tr_b16 v[72:73], v25 offset:35904
    ds_read_b64_tr_b16 v[74:75], v25 offset:37184
    ds_read_b64_tr_b16 v[76:77], v25 offset:35968
    v_mfma_f32_32x32x16_bf16 v[132:147], v[40:43], v[52:55], v[132:147]
    ds_read_b64_tr_b16 v[78:79], v25 offset:37248
    ds_read_b64_tr_b16 v[80:81], v25 offset:36032
    ds_read_b64_tr_b16 v[82:83], v25 offset:37312
    v_mfma_f32_32x32x16_bf16 v[148:163], v[40:43], v[56:59], v[148:163]
    ds_read_b64_tr_b16 v[84:85], v25 offset:36096
    ds_read_b64_tr_b16 v[86:87], v25 offset:37376
    v_mfma_f32_32x32x16_bf16 v[164:179], v[40:43], v[60:63], v[164:179]
    s_waitcnt lgkmcnt(0)
    s_waitcnt vmcnt(9)
    s_barrier
    v_mfma_f32_32x32x16_bf16 v[100:115], v[64:67], v[68:71], v[100:115]
    ds_read_b128 v[40:43], v20 offset:4096
    ds_read_b64_tr_b16 v[44:45], v24 offset:0
    ds_read_b64_tr_b16 v[46:47], v24 offset:1280
    v_mfma_f32_32x32x16_bf16 v[116:131], v[64:67], v[72:75], v[116:131]
    ds_read_b64_tr_b16 v[48:49], v24 offset:64
    ds_read_b64_tr_b16 v[50:51], v24 offset:1344
    ds_read_b64_tr_b16 v[52:53], v24 offset:128
    v_mfma_f32_32x32x16_bf16 v[132:147], v[64:67], v[76:79], v[132:147]
    ds_read_b64_tr_b16 v[54:55], v24 offset:1408
    ds_read_b64_tr_b16 v[56:57], v24 offset:192
    ds_read_b64_tr_b16 v[58:59], v24 offset:1472
    v_mfma_f32_32x32x16_bf16 v[148:163], v[64:67], v[80:83], v[148:163]
    ds_read_b64_tr_b16 v[60:61], v24 offset:256
    ds_read_b64_tr_b16 v[62:63], v24 offset:1536
    v_mfma_f32_32x32x16_bf16 v[164:179], v[64:67], v[84:87], v[164:179]
    s_waitcnt lgkmcnt(0)
    v_mfma_f32_32x32x16_bf16 v[100:115], v[40:43], v[44:47], v[100:115]
    ds_read_b128 v[64:67], v21 offset:4096
    ds_read_b64_tr_b16 v[68:69], v24 offset:5120
    ds_read_b64_tr_b16 v[70:71], v24 offset:6400
    v_mfma_f32_32x32x16_bf16 v[116:131], v[40:43], v[48:51], v[116:131]
    ds_read_b64_tr_b16 v[72:73], v24 offset:5184
    ds_read_b64_tr_b16 v[74:75], v24 offset:6464
    ds_read_b64_tr_b16 v[76:77], v24 offset:5248
    v_mfma_f32_32x32x16_bf16 v[132:147], v[40:43], v[52:55], v[132:147]
    ds_read_b64_tr_b16 v[78:79], v24 offset:6528
    ds_read_b64_tr_b16 v[80:81], v24 offset:5312
    ds_read_b64_tr_b16 v[82:83], v24 offset:6592
    v_mfma_f32_32x32x16_bf16 v[148:163], v[40:43], v[56:59], v[148:163]
    ds_read_b64_tr_b16 v[84:85], v24 offset:5376
    ds_read_b64_tr_b16 v[86:87], v24 offset:6656
    v_mfma_f32_32x32x16_bf16 v[164:179], v[40:43], v[60:63], v[164:179]
    s_waitcnt lgkmcnt(0)
    v_mfma_f32_32x32x16_bf16 v[100:115], v[64:67], v[68:71], v[100:115]
    ds_read_b128 v[40:43], v22 offset:4096
    ds_read_b64_tr_b16 v[44:45], v24 offset:10240
    ds_read_b64_tr_b16 v[46:47], v24 offset:11520
    v_mfma_f32_32x32x16_bf16 v[116:131], v[64:67], v[72:75], v[116:131]
    ds_read_b64_tr_b16 v[48:49], v24 offset:10304
    ds_read_b64_tr_b16 v[50:51], v24 offset:11584
    ds_read_b64_tr_b16 v[52:53], v24 offset:10368
    v_mfma_f32_32x32x16_bf16 v[132:147], v[64:67], v[76:79], v[132:147]
    ds_read_b64_tr_b16 v[54:55], v24 offset:11648
    ds_read_b64_tr_b16 v[56:57], v24 offset:10432
    ds_read_b64_tr_b16 v[58:59], v24 offset:11712
    v_mfma_f32_32x32x16_bf16 v[148:163], v[64:67], v[80:83], v[148:163]
    ds_read_b64_tr_b16 v[60:61], v24 offset:10496
    ds_read_b64_tr_b16 v[62:63], v24 offset:11776
    v_mfma_f32_32x32x16_bf16 v[164:179], v[64:67], v[84:87], v[164:179]
    s_waitcnt lgkmcnt(0)
    v_mfma_f32_32x32x16_bf16 v[100:115], v[40:43], v[44:47], v[100:115]
    ds_read_b128 v[64:67], v23 offset:4096
    ds_read_b64_tr_b16 v[68:69], v24 offset:15360
    ds_read_b64_tr_b16 v[70:71], v24 offset:16640
    v_mfma_f32_32x32x16_bf16 v[116:131], v[40:43], v[48:51], v[116:131]
    ds_read_b64_tr_b16 v[72:73], v24 offset:15424
    ds_read_b64_tr_b16 v[74:75], v24 offset:16704
    ds_read_b64_tr_b16 v[76:77], v24 offset:15488
    v_mfma_f32_32x32x16_bf16 v[132:147], v[40:43], v[52:55], v[132:147]
    ds_read_b64_tr_b16 v[78:79], v24 offset:16768
    ds_read_b64_tr_b16 v[80:81], v24 offset:15552
    ds_read_b64_tr_b16 v[82:83], v24 offset:16832
    v_mfma_f32_32x32x16_bf16 v[148:163], v[40:43], v[56:59], v[148:163]
    ds_read_b64_tr_b16 v[84:85], v24 offset:15616
    ds_read_b64_tr_b16 v[86:87], v24 offset:16896
    v_mfma_f32_32x32x16_bf16 v[164:179], v[40:43], v[60:63], v[164:179]
    s_waitcnt lgkmcnt(0)
    s_waitcnt vmcnt(0)
    s_barrier
    v_mfma_f32_32x32x16_bf16 v[100:115], v[64:67], v[68:71], v[100:115]
    ds_read_b128 v[40:43], v20 offset:20480
    ds_read_b64_tr_b16 v[44:45], v24 offset:20480
    ds_read_b64_tr_b16 v[46:47], v24 offset:21760
    v_mfma_f32_32x32x16_bf16 v[116:131], v[64:67], v[72:75], v[116:131]
    ds_read_b64_tr_b16 v[48:49], v24 offset:20544
    ds_read_b64_tr_b16 v[50:51], v24 offset:21824
    ds_read_b64_tr_b16 v[52:53], v24 offset:20608
    v_mfma_f32_32x32x16_bf16 v[132:147], v[64:67], v[76:79], v[132:147]
    ds_read_b64_tr_b16 v[54:55], v24 offset:21888
    ds_read_b64_tr_b16 v[56:57], v24 offset:20672
    ds_read_b64_tr_b16 v[58:59], v24 offset:21952
    v_mfma_f32_32x32x16_bf16 v[148:163], v[64:67], v[80:83], v[148:163]
    ds_read_b64_tr_b16 v[60:61], v24 offset:20736
    ds_read_b64_tr_b16 v[62:63], v24 offset:22016
    v_mfma_f32_32x32x16_bf16 v[164:179], v[64:67], v[84:87], v[164:179]
    s_waitcnt lgkmcnt(0)
    v_mfma_f32_32x32x16_bf16 v[100:115], v[40:43], v[44:47], v[100:115]
    ds_read_b128 v[64:67], v21 offset:20480
    ds_read_b64_tr_b16 v[68:69], v24 offset:25600
    ds_read_b64_tr_b16 v[70:71], v24 offset:26880
    v_mfma_f32_32x32x16_bf16 v[116:131], v[40:43], v[48:51], v[116:131]
    ds_read_b64_tr_b16 v[72:73], v24 offset:25664
    ds_read_b64_tr_b16 v[74:75], v24 offset:26944
    ds_read_b64_tr_b16 v[76:77], v24 offset:25728
    v_mfma_f32_32x32x16_bf16 v[132:147], v[40:43], v[52:55], v[132:147]
    ds_read_b64_tr_b16 v[78:79], v24 offset:27008
    ds_read_b64_tr_b16 v[80:81], v24 offset:25792
    ds_read_b64_tr_b16 v[82:83], v24 offset:27072
    v_mfma_f32_32x32x16_bf16 v[148:163], v[40:43], v[56:59], v[148:163]
    ds_read_b64_tr_b16 v[84:85], v24 offset:25856
    ds_read_b64_tr_b16 v[86:87], v24 offset:27136
    v_mfma_f32_32x32x16_bf16 v[164:179], v[40:43], v[60:63], v[164:179]
    s_waitcnt lgkmcnt(0)
    v_mfma_f32_32x32x16_bf16 v[100:115], v[64:67], v[68:71], v[100:115]
    ds_read_b128 v[40:43], v22 offset:20480
    ds_read_b64_tr_b16 v[44:45], v24 offset:30720
    ds_read_b64_tr_b16 v[46:47], v24 offset:32000
    v_mfma_f32_32x32x16_bf16 v[116:131], v[64:67], v[72:75], v[116:131]
    ds_read_b64_tr_b16 v[48:49], v24 offset:30784
    ds_read_b64_tr_b16 v[50:51], v24 offset:32064
    ds_read_b64_tr_b16 v[52:53], v24 offset:30848
    v_mfma_f32_32x32x16_bf16 v[132:147], v[64:67], v[76:79], v[132:147]
    ds_read_b64_tr_b16 v[54:55], v24 offset:32128
    ds_read_b64_tr_b16 v[56:57], v24 offset:30912
    ds_read_b64_tr_b16 v[58:59], v24 offset:32192
    v_mfma_f32_32x32x16_bf16 v[148:163], v[64:67], v[80:83], v[148:163]
    ds_read_b64_tr_b16 v[60:61], v24 offset:30976
    ds_read_b64_tr_b16 v[62:63], v24 offset:32256
    v_mfma_f32_32x32x16_bf16 v[164:179], v[64:67], v[84:87], v[164:179]
    s_waitcnt lgkmcnt(0)
    v_mfma_f32_32x32x16_bf16 v[100:115], v[40:43], v[44:47], v[100:115]
    ds_read_b128 v[64:67], v23 offset:20480
    ds_read_b64_tr_b16 v[68:69], v24 offset:35840
    ds_read_b64_tr_b16 v[70:71], v24 offset:37120
    v_mfma_f32_32x32x16_bf16 v[116:131], v[40:43], v[48:51], v[116:131]
    ds_read_b64_tr_b16 v[72:73], v24 offset:35904
    ds_read_b64_tr_b16 v[74:75], v24 offset:37184
    ds_read_b64_tr_b16 v[76:77], v24 offset:35968
    v_mfma_f32_32x32x16_bf16 v[132:147], v[40:43], v[52:55], v[132:147]
    ds_read_b64_tr_b16 v[78:79], v24 offset:37248
    ds_read_b64_tr_b16 v[80:81], v24 offset:36032
    ds_read_b64_tr_b16 v[82:83], v24 offset:37312
    v_mfma_f32_32x32x16_bf16 v[148:163], v[40:43], v[56:59], v[148:163]
    ds_read_b64_tr_b16 v[84:85], v24 offset:36096
    ds_read_b64_tr_b16 v[86:87], v24 offset:37376
    v_mfma_f32_32x32x16_bf16 v[164:179], v[40:43], v[60:63], v[164:179]
    s_waitcnt lgkmcnt(0)
    v_mfma_f32_32x32x16_bf16 v[100:115], v[64:67], v[68:71], v[100:115]
    v_mfma_f32_32x32x16_bf16 v[116:131], v[64:67], v[72:75], v[116:131]
    v_mfma_f32_32x32x16_bf16 v[132:147], v[64:67], v[76:79], v[132:147]
    v_mfma_f32_32x32x16_bf16 v[148:163], v[64:67], v[80:83], v[148:163]
    v_mfma_f32_32x32x16_bf16 v[164:179], v[64:67], v[84:87], v[164:179]
    s_nop 7
    s_nop 7
    s_waitcnt vmcnt(0) lgkmcnt(0)
    s_barrier
    v_and_b32 v1, 63, v0
    v_and_b32 v2, 31, v1
    v_lshrrev_b32 v3, 5, v1
    s_lshl_b32 s58, s26, 5
    v_lshlrev_b32 v4, 2, v3
    v_add_u32 v4, s58, v4
    v_lshlrev_b32 v4, 3, v4
    ds_read_b128 v[200:203], v4 offset:0
    ds_read_b128 v[204:207], v4 offset:16
    ds_read_b128 v[208:211], v4 offset:64
    ds_read_b128 v[212:215], v4 offset:80
    ds_read_b128 v[216:219], v4 offset:128
    ds_read_b128 v[220:223], v4 offset:144
    ds_read_b128 v[224:227], v4 offset:192
    ds_read_b128 v[228:231], v4 offset:208
    v_lshlrev_b32 v5, 2, v2
    ds_read_b32 v232, v5 offset:1024
    ds_read_b32 v233, v5 offset:1152
    ds_read_b32 v234, v5 offset:1280
    ds_read_b32 v235, v5 offset:1408
    ds_read_b32 v236, v5 offset:1536
    s_waitcnt lgkmcnt(0)
    s_barrier
    s_mov_b32 s64, 0x3fb8aa3b
    s_mov_b32 s65, 0x358637bd
    v_mul_f32 v4, v201, v232
    v_fma_f32 v100, v200, v100, v4
    v_mul_f32 v5, s64, v100
    v_exp_f32 v5, v5
    v_add_f32 v6, 1.0, v100
    v_cmp_lt_f32 vcc, 0, v100
    s_nop 1
    v_cndmask_b32 v5, v5, v6, vcc
    v_add_f32 v100, s65, v5
    v_mul_f32 v4, v203, v232
    v_fma_f32 v101, v202, v101, v4
    v_mul_f32 v5, s64, v101
    v_exp_f32 v5, v5
    v_add_f32 v6, 1.0, v101
    v_cmp_lt_f32 vcc, 0, v101
    s_nop 1
    v_cndmask_b32 v5, v5, v6, vcc
    v_add_f32 v101, s65, v5
    v_mul_f32 v4, v205, v232
    v_fma_f32 v102, v204, v102, v4
    v_mul_f32 v5, s64, v102
    v_exp_f32 v5, v5
    v_add_f32 v6, 1.0, v102
    v_cmp_lt_f32 vcc, 0, v102
    s_nop 1
    v_cndmask_b32 v5, v5, v6, vcc
    v_add_f32 v102, s65, v5
    v_mul_f32 v4, v207, v232
    v_fma_f32 v103, v206, v103, v4
    v_mul_f32 v5, s64, v103
    v_exp_f32 v5, v5
    v_add_f32 v6, 1.0, v103
    v_cmp_lt_f32 vcc, 0, v103
    s_nop 1
    v_cndmask_b32 v5, v5, v6, vcc
    v_add_f32 v103, s65, v5
    v_mul_f32 v4, v209, v232
    v_fma_f32 v104, v208, v104, v4
    v_mul_f32 v5, s64, v104
    v_exp_f32 v5, v5
    v_add_f32 v6, 1.0, v104
    v_cmp_lt_f32 vcc, 0, v104
    s_nop 1
    v_cndmask_b32 v5, v5, v6, vcc
    v_add_f32 v104, s65, v5
    v_mul_f32 v4, v211, v232
    v_fma_f32 v105, v210, v105, v4
    v_mul_f32 v5, s64, v105
    v_exp_f32 v5, v5
    v_add_f32 v6, 1.0, v105
    v_cmp_lt_f32 vcc, 0, v105
    s_nop 1
    v_cndmask_b32 v5, v5, v6, vcc
    v_add_f32 v105, s65, v5
    v_mul_f32 v4, v213, v232
    v_fma_f32 v106, v212, v106, v4
    v_mul_f32 v5, s64, v106
    v_exp_f32 v5, v5
    v_add_f32 v6, 1.0, v106
    v_cmp_lt_f32 vcc, 0, v106
    s_nop 1
    v_cndmask_b32 v5, v5, v6, vcc
    v_add_f32 v106, s65, v5
    v_mul_f32 v4, v215, v232
    v_fma_f32 v107, v214, v107, v4
    v_mul_f32 v5, s64, v107
    v_exp_f32 v5, v5
    v_add_f32 v6, 1.0, v107
    v_cmp_lt_f32 vcc, 0, v107
    s_nop 1
    v_cndmask_b32 v5, v5, v6, vcc
    v_add_f32 v107, s65, v5
    v_mul_f32 v4, v217, v232
    v_fma_f32 v108, v216, v108, v4
    v_mul_f32 v5, s64, v108
    v_exp_f32 v5, v5
    v_add_f32 v6, 1.0, v108
    v_cmp_lt_f32 vcc, 0, v108
    s_nop 1
    v_cndmask_b32 v5, v5, v6, vcc
    v_add_f32 v108, s65, v5
    v_mul_f32 v4, v219, v232
    v_fma_f32 v109, v218, v109, v4
    v_mul_f32 v5, s64, v109
    v_exp_f32 v5, v5
    v_add_f32 v6, 1.0, v109
    v_cmp_lt_f32 vcc, 0, v109
    s_nop 1
    v_cndmask_b32 v5, v5, v6, vcc
    v_add_f32 v109, s65, v5
    v_mul_f32 v4, v221, v232
    v_fma_f32 v110, v220, v110, v4
    v_mul_f32 v5, s64, v110
    v_exp_f32 v5, v5
    v_add_f32 v6, 1.0, v110
    v_cmp_lt_f32 vcc, 0, v110
    s_nop 1
    v_cndmask_b32 v5, v5, v6, vcc
    v_add_f32 v110, s65, v5
    v_mul_f32 v4, v223, v232
    v_fma_f32 v111, v222, v111, v4
    v_mul_f32 v5, s64, v111
    v_exp_f32 v5, v5
    v_add_f32 v6, 1.0, v111
    v_cmp_lt_f32 vcc, 0, v111
    s_nop 1
    v_cndmask_b32 v5, v5, v6, vcc
    v_add_f32 v111, s65, v5
    v_mul_f32 v4, v225, v232
    v_fma_f32 v112, v224, v112, v4
    v_mul_f32 v5, s64, v112
    v_exp_f32 v5, v5
    v_add_f32 v6, 1.0, v112
    v_cmp_lt_f32 vcc, 0, v112
    s_nop 1
    v_cndmask_b32 v5, v5, v6, vcc
    v_add_f32 v112, s65, v5
    v_mul_f32 v4, v227, v232
    v_fma_f32 v113, v226, v113, v4
    v_mul_f32 v5, s64, v113
    v_exp_f32 v5, v5
    v_add_f32 v6, 1.0, v113
    v_cmp_lt_f32 vcc, 0, v113
    s_nop 1
    v_cndmask_b32 v5, v5, v6, vcc
    v_add_f32 v113, s65, v5
    v_mul_f32 v4, v229, v232
    v_fma_f32 v114, v228, v114, v4
    v_mul_f32 v5, s64, v114
    v_exp_f32 v5, v5
    v_add_f32 v6, 1.0, v114
    v_cmp_lt_f32 vcc, 0, v114
    s_nop 1
    v_cndmask_b32 v5, v5, v6, vcc
    v_add_f32 v114, s65, v5
    v_mul_f32 v4, v231, v232
    v_fma_f32 v115, v230, v115, v4
    v_mul_f32 v5, s64, v115
    v_exp_f32 v5, v5
    v_add_f32 v6, 1.0, v115
    v_cmp_lt_f32 vcc, 0, v115
    s_nop 1
    v_cndmask_b32 v5, v5, v6, vcc
    v_add_f32 v115, s65, v5
    v_mul_f32 v4, v201, v233
    v_fma_f32 v116, v200, v116, v4
    v_mul_f32 v5, s64, v116
    v_exp_f32 v5, v5
    v_add_f32 v6, 1.0, v116
    v_cmp_lt_f32 vcc, 0, v116
    s_nop 1
    v_cndmask_b32 v5, v5, v6, vcc
    v_add_f32 v116, s65, v5
    v_mul_f32 v4, v203, v233
    v_fma_f32 v117, v202, v117, v4
    v_mul_f32 v5, s64, v117
    v_exp_f32 v5, v5
    v_add_f32 v6, 1.0, v117
    v_cmp_lt_f32 vcc, 0, v117
    s_nop 1
    v_cndmask_b32 v5, v5, v6, vcc
    v_add_f32 v117, s65, v5
    v_mul_f32 v4, v205, v233
    v_fma_f32 v118, v204, v118, v4
    v_mul_f32 v5, s64, v118
    v_exp_f32 v5, v5
    v_add_f32 v6, 1.0, v118
    v_cmp_lt_f32 vcc, 0, v118
    s_nop 1
    v_cndmask_b32 v5, v5, v6, vcc
    v_add_f32 v118, s65, v5
    v_mul_f32 v4, v207, v233
    v_fma_f32 v119, v206, v119, v4
    v_mul_f32 v5, s64, v119
    v_exp_f32 v5, v5
    v_add_f32 v6, 1.0, v119
    v_cmp_lt_f32 vcc, 0, v119
    s_nop 1
    v_cndmask_b32 v5, v5, v6, vcc
    v_add_f32 v119, s65, v5
    v_mul_f32 v4, v209, v233
    v_fma_f32 v120, v208, v120, v4
    v_mul_f32 v5, s64, v120
    v_exp_f32 v5, v5
    v_add_f32 v6, 1.0, v120
    v_cmp_lt_f32 vcc, 0, v120
    s_nop 1
    v_cndmask_b32 v5, v5, v6, vcc
    v_add_f32 v120, s65, v5
    v_mul_f32 v4, v211, v233
    v_fma_f32 v121, v210, v121, v4
    v_mul_f32 v5, s64, v121
    v_exp_f32 v5, v5
    v_add_f32 v6, 1.0, v121
    v_cmp_lt_f32 vcc, 0, v121
    s_nop 1
    v_cndmask_b32 v5, v5, v6, vcc
    v_add_f32 v121, s65, v5
    v_mul_f32 v4, v213, v233
    v_fma_f32 v122, v212, v122, v4
    v_mul_f32 v5, s64, v122
    v_exp_f32 v5, v5
    v_add_f32 v6, 1.0, v122
    v_cmp_lt_f32 vcc, 0, v122
    s_nop 1
    v_cndmask_b32 v5, v5, v6, vcc
    v_add_f32 v122, s65, v5
    v_mul_f32 v4, v215, v233
    v_fma_f32 v123, v214, v123, v4
    v_mul_f32 v5, s64, v123
    v_exp_f32 v5, v5
    v_add_f32 v6, 1.0, v123
    v_cmp_lt_f32 vcc, 0, v123
    s_nop 1
    v_cndmask_b32 v5, v5, v6, vcc
    v_add_f32 v123, s65, v5
    v_mul_f32 v4, v217, v233
    v_fma_f32 v124, v216, v124, v4
    v_mul_f32 v5, s64, v124
    v_exp_f32 v5, v5
    v_add_f32 v6, 1.0, v124
    v_cmp_lt_f32 vcc, 0, v124
    s_nop 1
    v_cndmask_b32 v5, v5, v6, vcc
    v_add_f32 v124, s65, v5
    v_mul_f32 v4, v219, v233
    v_fma_f32 v125, v218, v125, v4
    v_mul_f32 v5, s64, v125
    v_exp_f32 v5, v5
    v_add_f32 v6, 1.0, v125
    v_cmp_lt_f32 vcc, 0, v125
    s_nop 1
    v_cndmask_b32 v5, v5, v6, vcc
    v_add_f32 v125, s65, v5
    v_mul_f32 v4, v221, v233
    v_fma_f32 v126, v220, v126, v4
    v_mul_f32 v5, s64, v126
    v_exp_f32 v5, v5
    v_add_f32 v6, 1.0, v126
    v_cmp_lt_f32 vcc, 0, v126
    s_nop 1
    v_cndmask_b32 v5, v5, v6, vcc
    v_add_f32 v126, s65, v5
    v_mul_f32 v4, v223, v233
    v_fma_f32 v127, v222, v127, v4
    v_mul_f32 v5, s64, v127
    v_exp_f32 v5, v5
    v_add_f32 v6, 1.0, v127
    v_cmp_lt_f32 vcc, 0, v127
    s_nop 1
    v_cndmask_b32 v5, v5, v6, vcc
    v_add_f32 v127, s65, v5
    v_mul_f32 v4, v225, v233
    v_fma_f32 v128, v224, v128, v4
    v_mul_f32 v5, s64, v128
    v_exp_f32 v5, v5
    v_add_f32 v6, 1.0, v128
    v_cmp_lt_f32 vcc, 0, v128
    s_nop 1
    v_cndmask_b32 v5, v5, v6, vcc
    v_add_f32 v128, s65, v5
    v_mul_f32 v4, v227, v233
    v_fma_f32 v129, v226, v129, v4
    v_mul_f32 v5, s64, v129
    v_exp_f32 v5, v5
    v_add_f32 v6, 1.0, v129
    v_cmp_lt_f32 vcc, 0, v129
    s_nop 1
    v_cndmask_b32 v5, v5, v6, vcc
    v_add_f32 v129, s65, v5
    v_mul_f32 v4, v229, v233
    v_fma_f32 v130, v228, v130, v4
    v_mul_f32 v5, s64, v130
    v_exp_f32 v5, v5
    v_add_f32 v6, 1.0, v130
    v_cmp_lt_f32 vcc, 0, v130
    s_nop 1
    v_cndmask_b32 v5, v5, v6, vcc
    v_add_f32 v130, s65, v5
    v_mul_f32 v4, v231, v233
    v_fma_f32 v131, v230, v131, v4
    v_mul_f32 v5, s64, v131
    v_exp_f32 v5, v5
    v_add_f32 v6, 1.0, v131
    v_cmp_lt_f32 vcc, 0, v131
    s_nop 1
    v_cndmask_b32 v5, v5, v6, vcc
    v_add_f32 v131, s65, v5
    v_mul_f32 v4, v201, v234
    v_fma_f32 v132, v200, v132, v4
    v_mul_f32 v5, s64, v132
    v_exp_f32 v5, v5
    v_add_f32 v6, 1.0, v132
    v_cmp_lt_f32 vcc, 0, v132
    s_nop 1
    v_cndmask_b32 v5, v5, v6, vcc
    v_add_f32 v5, s65, v5
    v_cmp_gt_u32 vcc, 16, v2
    s_nop 1
    v_cndmask_b32 v132, v132, v5, vcc
    v_mul_f32 v4, v203, v234
    v_fma_f32 v133, v202, v133, v4
    v_mul_f32 v5, s64, v133
    v_exp_f32 v5, v5
    v_add_f32 v6, 1.0, v133
    v_cmp_lt_f32 vcc, 0, v133
    s_nop 1
    v_cndmask_b32 v5, v5, v6, vcc
    v_add_f32 v5, s65, v5
    v_cmp_gt_u32 vcc, 16, v2
    s_nop 1
    v_cndmask_b32 v133, v133, v5, vcc
    v_mul_f32 v4, v205, v234
    v_fma_f32 v134, v204, v134, v4
    v_mul_f32 v5, s64, v134
    v_exp_f32 v5, v5
    v_add_f32 v6, 1.0, v134
    v_cmp_lt_f32 vcc, 0, v134
    s_nop 1
    v_cndmask_b32 v5, v5, v6, vcc
    v_add_f32 v5, s65, v5
    v_cmp_gt_u32 vcc, 16, v2
    s_nop 1
    v_cndmask_b32 v134, v134, v5, vcc
    v_mul_f32 v4, v207, v234
    v_fma_f32 v135, v206, v135, v4
    v_mul_f32 v5, s64, v135
    v_exp_f32 v5, v5
    v_add_f32 v6, 1.0, v135
    v_cmp_lt_f32 vcc, 0, v135
    s_nop 1
    v_cndmask_b32 v5, v5, v6, vcc
    v_add_f32 v5, s65, v5
    v_cmp_gt_u32 vcc, 16, v2
    s_nop 1
    v_cndmask_b32 v135, v135, v5, vcc
    v_mul_f32 v4, v209, v234
    v_fma_f32 v136, v208, v136, v4
    v_mul_f32 v5, s64, v136
    v_exp_f32 v5, v5
    v_add_f32 v6, 1.0, v136
    v_cmp_lt_f32 vcc, 0, v136
    s_nop 1
    v_cndmask_b32 v5, v5, v6, vcc
    v_add_f32 v5, s65, v5
    v_cmp_gt_u32 vcc, 16, v2
    s_nop 1
    v_cndmask_b32 v136, v136, v5, vcc
    v_mul_f32 v4, v211, v234
    v_fma_f32 v137, v210, v137, v4
    v_mul_f32 v5, s64, v137
    v_exp_f32 v5, v5
    v_add_f32 v6, 1.0, v137
    v_cmp_lt_f32 vcc, 0, v137
    s_nop 1
    v_cndmask_b32 v5, v5, v6, vcc
    v_add_f32 v5, s65, v5
    v_cmp_gt_u32 vcc, 16, v2
    s_nop 1
    v_cndmask_b32 v137, v137, v5, vcc
    v_mul_f32 v4, v213, v234
    v_fma_f32 v138, v212, v138, v4
    v_mul_f32 v5, s64, v138
    v_exp_f32 v5, v5
    v_add_f32 v6, 1.0, v138
    v_cmp_lt_f32 vcc, 0, v138
    s_nop 1
    v_cndmask_b32 v5, v5, v6, vcc
    v_add_f32 v5, s65, v5
    v_cmp_gt_u32 vcc, 16, v2
    s_nop 1
    v_cndmask_b32 v138, v138, v5, vcc
    v_mul_f32 v4, v215, v234
    v_fma_f32 v139, v214, v139, v4
    v_mul_f32 v5, s64, v139
    v_exp_f32 v5, v5
    v_add_f32 v6, 1.0, v139
    v_cmp_lt_f32 vcc, 0, v139
    s_nop 1
    v_cndmask_b32 v5, v5, v6, vcc
    v_add_f32 v5, s65, v5
    v_cmp_gt_u32 vcc, 16, v2
    s_nop 1
    v_cndmask_b32 v139, v139, v5, vcc
    v_mul_f32 v4, v217, v234
    v_fma_f32 v140, v216, v140, v4
    v_mul_f32 v5, s64, v140
    v_exp_f32 v5, v5
    v_add_f32 v6, 1.0, v140
    v_cmp_lt_f32 vcc, 0, v140
    s_nop 1
    v_cndmask_b32 v5, v5, v6, vcc
    v_add_f32 v5, s65, v5
    v_cmp_gt_u32 vcc, 16, v2
    s_nop 1
    v_cndmask_b32 v140, v140, v5, vcc
    v_mul_f32 v4, v219, v234
    v_fma_f32 v141, v218, v141, v4
    v_mul_f32 v5, s64, v141
    v_exp_f32 v5, v5
    v_add_f32 v6, 1.0, v141
    v_cmp_lt_f32 vcc, 0, v141
    s_nop 1
    v_cndmask_b32 v5, v5, v6, vcc
    v_add_f32 v5, s65, v5
    v_cmp_gt_u32 vcc, 16, v2
    s_nop 1
    v_cndmask_b32 v141, v141, v5, vcc
    v_mul_f32 v4, v221, v234
    v_fma_f32 v142, v220, v142, v4
    v_mul_f32 v5, s64, v142
    v_exp_f32 v5, v5
    v_add_f32 v6, 1.0, v142
    v_cmp_lt_f32 vcc, 0, v142
    s_nop 1
    v_cndmask_b32 v5, v5, v6, vcc
    v_add_f32 v5, s65, v5
    v_cmp_gt_u32 vcc, 16, v2
    s_nop 1
    v_cndmask_b32 v142, v142, v5, vcc
    v_mul_f32 v4, v223, v234
    v_fma_f32 v143, v222, v143, v4
    v_mul_f32 v5, s64, v143
    v_exp_f32 v5, v5
    v_add_f32 v6, 1.0, v143
    v_cmp_lt_f32 vcc, 0, v143
    s_nop 1
    v_cndmask_b32 v5, v5, v6, vcc
    v_add_f32 v5, s65, v5
    v_cmp_gt_u32 vcc, 16, v2
    s_nop 1
    v_cndmask_b32 v143, v143, v5, vcc
    v_mul_f32 v4, v225, v234
    v_fma_f32 v144, v224, v144, v4
    v_mul_f32 v5, s64, v144
    v_exp_f32 v5, v5
    v_add_f32 v6, 1.0, v144
    v_cmp_lt_f32 vcc, 0, v144
    s_nop 1
    v_cndmask_b32 v5, v5, v6, vcc
    v_add_f32 v5, s65, v5
    v_cmp_gt_u32 vcc, 16, v2
    s_nop 1
    v_cndmask_b32 v144, v144, v5, vcc
    v_mul_f32 v4, v227, v234
    v_fma_f32 v145, v226, v145, v4
    v_mul_f32 v5, s64, v145
    v_exp_f32 v5, v5
    v_add_f32 v6, 1.0, v145
    v_cmp_lt_f32 vcc, 0, v145
    s_nop 1
    v_cndmask_b32 v5, v5, v6, vcc
    v_add_f32 v5, s65, v5
    v_cmp_gt_u32 vcc, 16, v2
    s_nop 1
    v_cndmask_b32 v145, v145, v5, vcc
    v_mul_f32 v4, v229, v234
    v_fma_f32 v146, v228, v146, v4
    v_mul_f32 v5, s64, v146
    v_exp_f32 v5, v5
    v_add_f32 v6, 1.0, v146
    v_cmp_lt_f32 vcc, 0, v146
    s_nop 1
    v_cndmask_b32 v5, v5, v6, vcc
    v_add_f32 v5, s65, v5
    v_cmp_gt_u32 vcc, 16, v2
    s_nop 1
    v_cndmask_b32 v146, v146, v5, vcc
    v_mul_f32 v4, v231, v234
    v_fma_f32 v147, v230, v147, v4
    v_mul_f32 v5, s64, v147
    v_exp_f32 v5, v5
    v_add_f32 v6, 1.0, v147
    v_cmp_lt_f32 vcc, 0, v147
    s_nop 1
    v_cndmask_b32 v5, v5, v6, vcc
    v_add_f32 v5, s65, v5
    v_cmp_gt_u32 vcc, 16, v2
    s_nop 1
    v_cndmask_b32 v147, v147, v5, vcc
    v_mul_f32 v4, v201, v235
    v_fma_f32 v148, v200, v148, v4
    v_mul_f32 v4, v203, v235
    v_fma_f32 v149, v202, v149, v4
    v_mul_f32 v4, v205, v235
    v_fma_f32 v150, v204, v150, v4
    v_mul_f32 v4, v207, v235
    v_fma_f32 v151, v206, v151, v4
    v_mul_f32 v4, v209, v235
    v_fma_f32 v152, v208, v152, v4
    v_mul_f32 v4, v211, v235
    v_fma_f32 v153, v210, v153, v4
    v_mul_f32 v4, v213, v235
    v_fma_f32 v154, v212, v154, v4
    v_mul_f32 v4, v215, v235
    v_fma_f32 v155, v214, v155, v4
    v_mul_f32 v4, v217, v235
    v_fma_f32 v156, v216, v156, v4
    v_mul_f32 v4, v219, v235
    v_fma_f32 v157, v218, v157, v4
    v_mul_f32 v4, v221, v235
    v_fma_f32 v158, v220, v158, v4
    v_mul_f32 v4, v223, v235
    v_fma_f32 v159, v222, v159, v4
    v_mul_f32 v4, v225, v235
    v_fma_f32 v160, v224, v160, v4
    v_mul_f32 v4, v227, v235
    v_fma_f32 v161, v226, v161, v4
    v_mul_f32 v4, v229, v235
    v_fma_f32 v162, v228, v162, v4
    v_mul_f32 v4, v231, v235
    v_fma_f32 v163, v230, v163, v4
    v_mul_f32 v4, v201, v236
    v_fma_f32 v164, v200, v164, v4
    v_mul_f32 v4, v203, v236
    v_fma_f32 v165, v202, v165, v4
    v_mul_f32 v4, v205, v236
    v_fma_f32 v166, v204, v166, v4
    v_mul_f32 v4, v207, v236
    v_fma_f32 v167, v206, v167, v4
    v_mul_f32 v4, v209, v236
    v_fma_f32 v168, v208, v168, v4
    v_mul_f32 v4, v211, v236
    v_fma_f32 v169, v210, v169, v4
    v_mul_f32 v4, v213, v236
    v_fma_f32 v170, v212, v170, v4
    v_mul_f32 v4, v215, v236
    v_fma_f32 v171, v214, v171, v4
    v_mul_f32 v4, v217, v236
    v_fma_f32 v172, v216, v172, v4
    v_mul_f32 v4, v219, v236
    v_fma_f32 v173, v218, v173, v4
    v_mul_f32 v4, v221, v236
    v_fma_f32 v174, v220, v174, v4
    v_mul_f32 v4, v223, v236
    v_fma_f32 v175, v222, v175, v4
    v_mul_f32 v4, v225, v236
    v_fma_f32 v176, v224, v176, v4
    v_mul_f32 v4, v227, v236
    v_fma_f32 v177, v226, v177, v4
    v_mul_f32 v4, v229, v236
    v_fma_f32 v178, v228, v178, v4
    v_mul_f32 v4, v231, v236
    v_fma_f32 v179, v230, v179, v4
    v_add_f32 v240, v100, v101
    v_add_f32 v240, v240, v102
    v_add_f32 v240, v240, v103
    v_add_f32 v240, v240, v104
    v_add_f32 v240, v240, v105
    v_add_f32 v240, v240, v106
    v_add_f32 v240, v240, v107
    v_add_f32 v240, v240, v108
    v_add_f32 v240, v240, v109
    v_add_f32 v240, v240, v110
    v_add_f32 v240, v240, v111
    v_add_f32 v240, v240, v112
    v_add_f32 v240, v240, v113
    v_add_f32 v240, v240, v114
    v_add_f32 v240, v240, v115
    v_add_f32 v241, v116, v117
    v_add_f32 v241, v241, v118
    v_add_f32 v241, v241, v119
    v_add_f32 v241, v241, v120
    v_add_f32 v241, v241, v121
    v_add_f32 v241, v241, v122
    v_add_f32 v241, v241, v123
    v_add_f32 v241, v241, v124
    v_add_f32 v241, v241, v125
    v_add_f32 v241, v241, v126
    v_add_f32 v241, v241, v127
    v_add_f32 v241, v241, v128
    v_add_f32 v241, v241, v129
    v_add_f32 v241, v241, v130
    v_add_f32 v241, v241, v131
    v_add_f32 v242, v132, v133
    v_add_f32 v242, v242, v134
    v_add_f32 v242, v242, v135
    v_add_f32 v242, v242, v136
    v_add_f32 v242, v242, v137
    v_add_f32 v242, v242, v138
    v_add_f32 v242, v242, v139
    v_add_f32 v242, v242, v140
    v_add_f32 v242, v242, v141
    v_add_f32 v242, v242, v142
    v_add_f32 v242, v242, v143
    v_add_f32 v242, v242, v144
    v_add_f32 v242, v242, v145
    v_add_f32 v242, v242, v146
    v_add_f32 v242, v242, v147
    v_cvt_pk_bf16_f32 v40, v100, v101
    v_cvt_pk_bf16_f32 v41, v102, v103
    v_cvt_pk_bf16_f32 v42, v104, v105
    v_cvt_pk_bf16_f32 v43, v106, v107
    v_cvt_pk_bf16_f32 v44, v108, v109
    v_cvt_pk_bf16_f32 v45, v110, v111
    v_cvt_pk_bf16_f32 v46, v112, v113
    v_cvt_pk_bf16_f32 v47, v114, v115
    v_cvt_pk_bf16_f32 v48, v116, v117
    v_cvt_pk_bf16_f32 v49, v118, v119
    v_cvt_pk_bf16_f32 v50, v120, v121
    v_cvt_pk_bf16_f32 v51, v122, v123
    v_cvt_pk_bf16_f32 v52, v124, v125
    v_cvt_pk_bf16_f32 v53, v126, v127
    v_cvt_pk_bf16_f32 v54, v128, v129
    v_cvt_pk_bf16_f32 v55, v130, v131
    v_cvt_pk_bf16_f32 v56, v132, v133
    v_cvt_pk_bf16_f32 v57, v134, v135
    v_cvt_pk_bf16_f32 v58, v136, v137
    v_cvt_pk_bf16_f32 v59, v138, v139
    v_cvt_pk_bf16_f32 v60, v140, v141
    v_cvt_pk_bf16_f32 v61, v142, v143
    v_cvt_pk_bf16_f32 v62, v144, v145
    v_cvt_pk_bf16_f32 v63, v146, v147
    v_cvt_pk_bf16_f32 v64, v148, v149
    v_cvt_pk_bf16_f32 v65, v150, v151
    v_cvt_pk_bf16_f32 v66, v152, v153
    v_cvt_pk_bf16_f32 v67, v154, v155
    v_cvt_pk_bf16_f32 v68, v156, v157
    v_cvt_pk_bf16_f32 v69, v158, v159
    v_cvt_pk_bf16_f32 v70, v160, v161
    v_cvt_pk_bf16_f32 v71, v162, v163
    v_cvt_pk_bf16_f32 v72, v164, v165
    v_cvt_pk_bf16_f32 v73, v166, v167
    v_cvt_pk_bf16_f32 v74, v168, v169
    v_cvt_pk_bf16_f32 v75, v170, v171
    v_cvt_pk_bf16_f32 v76, v172, v173
    v_cvt_pk_bf16_f32 v77, v174, v175
    v_cvt_pk_bf16_f32 v78, v176, v177
    v_cvt_pk_bf16_f32 v79, v178, v179
    s_nop 1
    v_mov_b32 v100, 0
    v_mov_b32 v101, 0
    v_mov_b32 v102, 0
    v_mov_b32 v103, 0
    v_mov_b32 v104, 0
    v_mov_b32 v105, 0
    v_mov_b32 v106, 0
    v_mov_b32 v107, 0
    v_mov_b32 v108, 0
    v_mov_b32 v109, 0
    v_mov_b32 v110, 0
    v_mov_b32 v111, 0
    v_mov_b32 v112, 0
    v_mov_b32 v113, 0
    v_mov_b32 v114, 0
    v_mov_b32 v115, 0
    v_mov_b32 v116, 0
    v_mov_b32 v117, 0
    v_mov_b32 v118, 0
    v_mov_b32 v119, 0
    v_mov_b32 v120, 0
    v_mov_b32 v121, 0
    v_mov_b32 v122, 0
    v_mov_b32 v123, 0
    v_mov_b32 v124, 0
    v_mov_b32 v125, 0
    v_mov_b32 v126, 0
    v_mov_b32 v127, 0
    v_mov_b32 v128, 0
    v_mov_b32 v129, 0
    v_mov_b32 v130, 0
    v_mov_b32 v131, 0
    v_mov_b32 v132, 0
    v_mov_b32 v133, 0
    v_mov_b32 v134, 0
    v_mov_b32 v135, 0
    v_mov_b32 v136, 0
    v_mov_b32 v137, 0
    v_mov_b32 v138, 0
    v_mov_b32 v139, 0
    v_mov_b32 v140, 0
    v_mov_b32 v141, 0
    v_mov_b32 v142, 0
    v_mov_b32 v143, 0
    v_mov_b32 v144, 0
    v_mov_b32 v145, 0
    v_mov_b32 v146, 0
    v_mov_b32 v147, 0
    v_mov_b32 v148, 0
    v_mov_b32 v149, 0
    v_mov_b32 v150, 0
    v_mov_b32 v151, 0
    v_mov_b32 v152, 0
    v_mov_b32 v153, 0
    v_mov_b32 v154, 0
    v_mov_b32 v155, 0
    v_mov_b32 v156, 0
    v_mov_b32 v157, 0
    v_mov_b32 v158, 0
    v_mov_b32 v159, 0
    v_mov_b32 v160, 0
    v_mov_b32 v161, 0
    v_mov_b32 v162, 0
    v_mov_b32 v163, 0
    v_mov_b32 v164, 0
    v_mov_b32 v165, 0
    v_mov_b32 v166, 0
    v_mov_b32 v167, 0
    v_mov_b32 v168, 0
    v_mov_b32 v169, 0
    v_mov_b32 v170, 0
    v_mov_b32 v171, 0
    v_mov_b32 v172, 0
    v_mov_b32 v173, 0
    v_mov_b32 v174, 0
    v_mov_b32 v175, 0
    v_mov_b32 v176, 0
    v_mov_b32 v177, 0
    v_mov_b32 v178, 0
    v_mov_b32 v179, 0
    s_nop 1
    v_mfma_f32_32x32x16_bf16 v[100:115], v[40:43], v[56:59], v[100:115]
    v_mfma_f32_32x32x16_bf16 v[100:115], v[44:47], v[60:63], v[100:115]
    v_mfma_f32_32x32x16_bf16 v[116:131], v[40:43], v[64:67], v[116:131]
    v_mfma_f32_32x32x16_bf16 v[116:131], v[44:47], v[68:71], v[116:131]
    v_mfma_f32_32x32x16_bf16 v[132:147], v[48:51], v[64:67], v[132:147]
    v_mfma_f32_32x32x16_bf16 v[132:147], v[52:55], v[68:71], v[132:147]
    v_mfma_f32_32x32x16_bf16 v[148:163], v[48:51], v[72:75], v[148:163]
    v_mfma_f32_32x32x16_bf16 v[148:163], v[52:55], v[76:79], v[148:163]
    v_mfma_f32_32x32x16_bf16 v[164:179], v[56:59], v[72:75], v[164:179]
    v_mfma_f32_32x32x16_bf16 v[164:179], v[60:63], v[76:79], v[164:179]
    s_nop 7
    s_nop 7
    v_lshlrev_b32 v5, 2, v1
    s_mul_i32 s58, s26, 21504
    v_add_u32 v5, s58, v5
    ds_write_b32 v5, v100 offset:4096
    ds_write_b32 v5, v101 offset:4352
    ds_write_b32 v5, v102 offset:4608
    ds_write_b32 v5, v103 offset:4864
    ds_write_b32 v5, v104 offset:5120
    ds_write_b32 v5, v105 offset:5376
    ds_write_b32 v5, v106 offset:5632
    ds_write_b32 v5, v107 offset:5888
    ds_write_b32 v5, v108 offset:6144
    ds_write_b32 v5, v109 offset:6400
    ds_write_b32 v5, v110 offset:6656
    ds_write_b32 v5, v111 offset:6912
    ds_write_b32 v5, v112 offset:7168
    ds_write_b32 v5, v113 offset:7424
    ds_write_b32 v5, v114 offset:7680
    ds_write_b32 v5, v115 offset:7936
    ds_write_b32 v5, v116 offset:8192
    ds_write_b32 v5, v117 offset:8448
    ds_write_b32 v5, v118 offset:8704
    ds_write_b32 v5, v119 offset:8960
    ds_write_b32 v5, v120 offset:9216
    ds_write_b32 v5, v121 offset:9472
    ds_write_b32 v5, v122 offset:9728
    ds_write_b32 v5, v123 offset:9984
    ds_write_b32 v5, v124 offset:10240
    ds_write_b32 v5, v125 offset:10496
    ds_write_b32 v5, v126 offset:10752
    ds_write_b32 v5, v127 offset:11008
    ds_write_b32 v5, v128 offset:11264
    ds_write_b32 v5, v129 offset:11520
    ds_write_b32 v5, v130 offset:11776
    ds_write_b32 v5, v131 offset:12032
    ds_write_b32 v5, v132 offset:12288
    ds_write_b32 v5, v133 offset:12544
    ds_write_b32 v5, v134 offset:12800
    ds_write_b32 v5, v135 offset:13056
    ds_write_b32 v5, v136 offset:13312
    ds_write_b32 v5, v137 offset:13568
    ds_write_b32 v5, v138 offset:13824
    ds_write_b32 v5, v139 offset:14080
    ds_write_b32 v5, v140 offset:14336
    ds_write_b32 v5, v141 offset:14592
    ds_write_b32 v5, v142 offset:14848
    ds_write_b32 v5, v143 offset:15104
    ds_write_b32 v5, v144 offset:15360
    ds_write_b32 v5, v145 offset:15616
    ds_write_b32 v5, v146 offset:15872
    ds_write_b32 v5, v147 offset:16128
    ds_write_b32 v5, v148 offset:16384
    ds_write_b32 v5, v149 offset:16640
    ds_write_b32 v5, v150 offset:16896
    ds_write_b32 v5, v151 offset:17152
    ds_write_b32 v5, v152 offset:17408
    ds_write_b32 v5, v153 offset:17664
    ds_write_b32 v5, v154 offset:17920
    ds_write_b32 v5, v155 offset:18176
    ds_write_b32 v5, v156 offset:18432
    ds_write_b32 v5, v157 offset:18688
    ds_write_b32 v5, v158 offset:18944
    ds_write_b32 v5, v159 offset:19200
    ds_write_b32 v5, v160 offset:19456
    ds_write_b32 v5, v161 offset:19712
    ds_write_b32 v5, v162 offset:19968
    ds_write_b32 v5, v163 offset:20224
    ds_write_b32 v5, v164 offset:20480
    ds_write_b32 v5, v165 offset:20736
    ds_write_b32 v5, v166 offset:20992
    ds_write_b32 v5, v167 offset:21248
    ds_write_b32 v5, v168 offset:21504
    ds_write_b32 v5, v169 offset:21760
    ds_write_b32 v5, v170 offset:22016
    ds_write_b32 v5, v171 offset:22272
    ds_write_b32 v5, v172 offset:22528
    ds_write_b32 v5, v173 offset:22784
    ds_write_b32 v5, v174 offset:23040
    ds_write_b32 v5, v175 offset:23296
    ds_write_b32 v5, v176 offset:23552
    ds_write_b32 v5, v177 offset:23808
    ds_write_b32 v5, v178 offset:24064
    ds_write_b32 v5, v179 offset:24320
    ds_write_b32 v5, v240 offset:24576
    ds_write_b32 v5, v241 offset:24832
    ds_write_b32 v5, v242 offset:25088
    s_waitcnt lgkmcnt(0)
    s_barrier
    s_mul_i32 s42, s101, 131072
    s_add_u32 s42, s42, 20971520
    s_add_u32 s36, s24, s42
    s_addc_u32 s37, s25, 0
    s_mov_b32 s38, 131072
    s_mov_b32 s39, 0x00020000
    s_lshl_b32 s42, s53, 14
    v_add_u32 v4, 0, v0
    v_mov_b32 v7, 1249
    v_mul_u32_u24 v5, v7, v4
    v_lshrrev_b32 v5, 19, v5
    v_mul_u32_u24 v7, 420, v5
    v_sub_u32 v6, v4, v7
    v_mov_b32 v7, 205
    v_mul_u32_u24 v9, v7, v6
    v_lshrrev_b32 v9, 12, v9
    v_mul_u32_u24 v7, 20, v9
    v_sub_u32 v8, v6, v7
    v_mul_u32_u24 v10, 20, v5
    v_add_u32 v11, v10, v8
    v_add_u32 v12, v10, v9
    v_add_u32 v12, 80, v12
    v_cmp_eq_u32 vcc, 20, v9
    v_lshrrev_b32 v14, 5, v11
    v_lshrrev_b32 v15, 5, v12
    v_add_u32 v14, v14, v15
    v_subrev_u32 v14, 2, v14
    v_and_b32 v15, 31, v11
    v_lshrrev_b32 v16, 3, v15
    v_lshlrev_b32 v16, 2, v16
    v_and_b32 v17, 3, v15
    v_add_u32 v16, v16, v17
    v_lshlrev_b32 v14, 4, v14
    v_add_u32 v14, v14, v16
    v_lshlrev_b32 v14, 8, v14
    v_lshrrev_b32 v16, 2, v15
    v_and_b32 v16, 1, v16
    v_lshlrev_b32 v16, 5, v16
    v_and_b32 v17, 31, v12
    v_add_u32 v16, v16, v17
    v_lshlrev_b32 v16, 2, v16
    v_add_u32 v14, v14, v16
    v_lshrrev_b32 v16, 5, v11
    v_lshlrev_b32 v16, 8, v16
    v_lshlrev_b32 v17, 2, v15
    v_add_u32 v16, v16, v17
    v_add_u32 v16, 20480, v16
    v_cndmask_b32 v14, v14, v16, vcc
    v_add_u32 v23, 43008, v14
    v_add_u32 v24, 43008, v16
    ds_read_b32 v18, v14 offset:4096
    ds_read_b32 v25, v14 offset:25600
    ds_read_b32 v26, v23 offset:4096
    ds_read_b32 v27, v23 offset:25600
    ds_read_b32 v19, v16 offset:4224
    ds_read_b32 v28, v16 offset:25728
    ds_read_b32 v29, v24 offset:4224
    ds_read_b32 v30, v24 offset:25728
    v_lshlrev_b32 v20, 12, v5
    v_lshlrev_b32 v21, 7, v9
    v_lshlrev_b32 v22, 2, v8
    v_add_u32 v21, v21, v22
    v_add_u32 v20, v20, v21
    s_waitcnt lgkmcnt(0)
    v_add_f32 v18, v18, v25
    v_add_f32 v26, v26, v27
    v_add_f32 v18, v18, v26
    v_add_f32 v19, v19, v28
    v_add_f32 v29, v29, v30
    v_add_f32 v19, v19, v29
    v_add_f32 v19, v18, v19
    v_cndmask_b32 v18, v18, v19, vcc
    buffer_atomic_add_f32 v18, v20, s[36:39], s42 offen
    v_add_u32 v4, 256, v0
    v_mov_b32 v7, 1249
    v_mul_u32_u24 v5, v7, v4
    v_lshrrev_b32 v5, 19, v5
    v_mul_u32_u24 v7, 420, v5
    v_sub_u32 v6, v4, v7
    v_mov_b32 v7, 205
    v_mul_u32_u24 v9, v7, v6
    v_lshrrev_b32 v9, 12, v9
    v_mul_u32_u24 v7, 20, v9
    v_sub_u32 v8, v6, v7
    v_mul_u32_u24 v10, 20, v5
    v_add_u32 v11, v10, v8
    v_add_u32 v12, v10, v9
    v_add_u32 v12, 80, v12
    v_cmp_eq_u32 vcc, 20, v9
    v_lshrrev_b32 v14, 5, v11
    v_lshrrev_b32 v15, 5, v12
    v_add_u32 v14, v14, v15
    v_subrev_u32 v14, 2, v14
    v_and_b32 v15, 31, v11
    v_lshrrev_b32 v16, 3, v15
    v_lshlrev_b32 v16, 2, v16
    v_and_b32 v17, 3, v15
    v_add_u32 v16, v16, v17
    v_lshlrev_b32 v14, 4, v14
    v_add_u32 v14, v14, v16
    v_lshlrev_b32 v14, 8, v14
    v_lshrrev_b32 v16, 2, v15
    v_and_b32 v16, 1, v16
    v_lshlrev_b32 v16, 5, v16
    v_and_b32 v17, 31, v12
    v_add_u32 v16, v16, v17
    v_lshlrev_b32 v16, 2, v16
    v_add_u32 v14, v14, v16
    v_lshrrev_b32 v16, 5, v11
    v_lshlrev_b32 v16, 8, v16
    v_lshlrev_b32 v17, 2, v15
    v_add_u32 v16, v16, v17
    v_add_u32 v16, 20480, v16
    v_cndmask_b32 v14, v14, v16, vcc
    v_add_u32 v23, 43008, v14
    v_add_u32 v24, 43008, v16
    ds_read_b32 v18, v14 offset:4096
    ds_read_b32 v25, v14 offset:25600
    ds_read_b32 v26, v23 offset:4096
    ds_read_b32 v27, v23 offset:25600
    ds_read_b32 v19, v16 offset:4224
    ds_read_b32 v28, v16 offset:25728
    ds_read_b32 v29, v24 offset:4224
    ds_read_b32 v30, v24 offset:25728
    v_lshlrev_b32 v20, 12, v5
    v_lshlrev_b32 v21, 7, v9
    v_lshlrev_b32 v22, 2, v8
    v_add_u32 v21, v21, v22
    v_add_u32 v20, v20, v21
    s_waitcnt lgkmcnt(0)
    v_add_f32 v18, v18, v25
    v_add_f32 v26, v26, v27
    v_add_f32 v18, v18, v26
    v_add_f32 v19, v19, v28
    v_add_f32 v29, v29, v30
    v_add_f32 v19, v19, v29
    v_add_f32 v19, v18, v19
    v_cndmask_b32 v18, v18, v19, vcc
    buffer_atomic_add_f32 v18, v20, s[36:39], s42 offen
    v_add_u32 v4, 512, v0
    v_mov_b32 v7, 1249
    v_mul_u32_u24 v5, v7, v4
    v_lshrrev_b32 v5, 19, v5
    v_mul_u32_u24 v7, 420, v5
    v_sub_u32 v6, v4, v7
    v_mov_b32 v7, 205
    v_mul_u32_u24 v9, v7, v6
    v_lshrrev_b32 v9, 12, v9
    v_mul_u32_u24 v7, 20, v9
    v_sub_u32 v8, v6, v7
    v_mul_u32_u24 v10, 20, v5
    v_add_u32 v11, v10, v8
    v_add_u32 v12, v10, v9
    v_add_u32 v12, 80, v12
    v_cmp_eq_u32 vcc, 20, v9
    v_lshrrev_b32 v14, 5, v11
    v_lshrrev_b32 v15, 5, v12
    v_add_u32 v14, v14, v15
    v_subrev_u32 v14, 2, v14
    v_and_b32 v15, 31, v11
    v_lshrrev_b32 v16, 3, v15
    v_lshlrev_b32 v16, 2, v16
    v_and_b32 v17, 3, v15
    v_add_u32 v16, v16, v17
    v_lshlrev_b32 v14, 4, v14
    v_add_u32 v14, v14, v16
    v_lshlrev_b32 v14, 8, v14
    v_lshrrev_b32 v16, 2, v15
    v_and_b32 v16, 1, v16
    v_lshlrev_b32 v16, 5, v16
    v_and_b32 v17, 31, v12
    v_add_u32 v16, v16, v17
    v_lshlrev_b32 v16, 2, v16
    v_add_u32 v14, v14, v16
    v_lshrrev_b32 v16, 5, v11
    v_lshlrev_b32 v16, 8, v16
    v_lshlrev_b32 v17, 2, v15
    v_add_u32 v16, v16, v17
    v_add_u32 v16, 20480, v16
    v_cndmask_b32 v14, v14, v16, vcc
    v_add_u32 v23, 43008, v14
    v_add_u32 v24, 43008, v16
    ds_read_b32 v18, v14 offset:4096
    ds_read_b32 v25, v14 offset:25600
    ds_read_b32 v26, v23 offset:4096
    ds_read_b32 v27, v23 offset:25600
    ds_read_b32 v19, v16 offset:4224
    ds_read_b32 v28, v16 offset:25728
    ds_read_b32 v29, v24 offset:4224
    ds_read_b32 v30, v24 offset:25728
    v_lshlrev_b32 v20, 12, v5
    v_lshlrev_b32 v21, 7, v9
    v_lshlrev_b32 v22, 2, v8
    v_add_u32 v21, v21, v22
    v_add_u32 v20, v20, v21
    s_waitcnt lgkmcnt(0)
    v_add_f32 v18, v18, v25
    v_add_f32 v26, v26, v27
    v_add_f32 v18, v18, v26
    v_add_f32 v19, v19, v28
    v_add_f32 v29, v29, v30
    v_add_f32 v19, v19, v29
    v_add_f32 v19, v18, v19
    v_cndmask_b32 v18, v18, v19, vcc
    buffer_atomic_add_f32 v18, v20, s[36:39], s42 offen
    v_add_u32 v4, 768, v0
    v_mov_b32 v7, 1249
    v_mul_u32_u24 v5, v7, v4
    v_lshrrev_b32 v5, 19, v5
    v_mul_u32_u24 v7, 420, v5
    v_sub_u32 v6, v4, v7
    v_mov_b32 v7, 205
    v_mul_u32_u24 v9, v7, v6
    v_lshrrev_b32 v9, 12, v9
    v_mul_u32_u24 v7, 20, v9
    v_sub_u32 v8, v6, v7
    v_mul_u32_u24 v10, 20, v5
    v_add_u32 v11, v10, v8
    v_add_u32 v12, v10, v9
    v_add_u32 v12, 80, v12
    v_cmp_eq_u32 vcc, 20, v9
    v_lshrrev_b32 v14, 5, v11
    v_lshrrev_b32 v15, 5, v12
    v_add_u32 v14, v14, v15
    v_subrev_u32 v14, 2, v14
    v_and_b32 v15, 31, v11
    v_lshrrev_b32 v16, 3, v15
    v_lshlrev_b32 v16, 2, v16
    v_and_b32 v17, 3, v15
    v_add_u32 v16, v16, v17
    v_lshlrev_b32 v14, 4, v14
    v_add_u32 v14, v14, v16
    v_lshlrev_b32 v14, 8, v14
    v_lshrrev_b32 v16, 2, v15
    v_and_b32 v16, 1, v16
    v_lshlrev_b32 v16, 5, v16
    v_and_b32 v17, 31, v12
    v_add_u32 v16, v16, v17
    v_lshlrev_b32 v16, 2, v16
    v_add_u32 v14, v14, v16
    v_lshrrev_b32 v16, 5, v11
    v_lshlrev_b32 v16, 8, v16
    v_lshlrev_b32 v17, 2, v15
    v_add_u32 v16, v16, v17
    v_add_u32 v16, 20480, v16
    v_cndmask_b32 v14, v14, v16, vcc
    v_add_u32 v23, 43008, v14
    v_add_u32 v24, 43008, v16
    ds_read_b32 v18, v14 offset:4096
    ds_read_b32 v25, v14 offset:25600
    ds_read_b32 v26, v23 offset:4096
    ds_read_b32 v27, v23 offset:25600
    ds_read_b32 v19, v16 offset:4224
    ds_read_b32 v28, v16 offset:25728
    ds_read_b32 v29, v24 offset:4224
    ds_read_b32 v30, v24 offset:25728
    v_lshlrev_b32 v20, 12, v5
    v_lshlrev_b32 v21, 7, v9
    v_lshlrev_b32 v22, 2, v8
    v_add_u32 v21, v21, v22
    v_add_u32 v20, v20, v21
    s_waitcnt lgkmcnt(0)
    v_add_f32 v18, v18, v25
    v_add_f32 v26, v26, v27
    v_add_f32 v18, v18, v26
    v_add_f32 v19, v19, v28
    v_add_f32 v29, v29, v30
    v_add_f32 v19, v19, v29
    v_add_f32 v19, v18, v19
    v_cndmask_b32 v18, v18, v19, vcc
    buffer_atomic_add_f32 v18, v20, s[36:39], s42 offen
    v_add_u32 v4, 1024, v0
    v_mov_b32 v7, 1249
    v_mul_u32_u24 v5, v7, v4
    v_lshrrev_b32 v5, 19, v5
    v_mul_u32_u24 v7, 420, v5
    v_sub_u32 v6, v4, v7
    v_mov_b32 v7, 205
    v_mul_u32_u24 v9, v7, v6
    v_lshrrev_b32 v9, 12, v9
    v_mul_u32_u24 v7, 20, v9
    v_sub_u32 v8, v6, v7
    v_mul_u32_u24 v10, 20, v5
    v_add_u32 v11, v10, v8
    v_add_u32 v12, v10, v9
    v_add_u32 v12, 80, v12
    v_cmp_eq_u32 vcc, 20, v9
    v_lshrrev_b32 v14, 5, v11
    v_lshrrev_b32 v15, 5, v12
    v_add_u32 v14, v14, v15
    v_subrev_u32 v14, 2, v14
    v_and_b32 v15, 31, v11
    v_lshrrev_b32 v16, 3, v15
    v_lshlrev_b32 v16, 2, v16
    v_and_b32 v17, 3, v15
    v_add_u32 v16, v16, v17
    v_lshlrev_b32 v14, 4, v14
    v_add_u32 v14, v14, v16
    v_lshlrev_b32 v14, 8, v14
    v_lshrrev_b32 v16, 2, v15
    v_and_b32 v16, 1, v16
    v_lshlrev_b32 v16, 5, v16
    v_and_b32 v17, 31, v12
    v_add_u32 v16, v16, v17
    v_lshlrev_b32 v16, 2, v16
    v_add_u32 v14, v14, v16
    v_lshrrev_b32 v16, 5, v11
    v_lshlrev_b32 v16, 8, v16
    v_lshlrev_b32 v17, 2, v15
    v_add_u32 v16, v16, v17
    v_add_u32 v16, 20480, v16
    v_cndmask_b32 v14, v14, v16, vcc
    v_add_u32 v23, 43008, v14
    v_add_u32 v24, 43008, v16
    ds_read_b32 v18, v14 offset:4096
    ds_read_b32 v25, v14 offset:25600
    ds_read_b32 v26, v23 offset:4096
    ds_read_b32 v27, v23 offset:25600
    ds_read_b32 v19, v16 offset:4224
    ds_read_b32 v28, v16 offset:25728
    ds_read_b32 v29, v24 offset:4224
    ds_read_b32 v30, v24 offset:25728
    v_lshlrev_b32 v20, 12, v5
    v_lshlrev_b32 v21, 7, v9
    v_lshlrev_b32 v22, 2, v8
    v_add_u32 v21, v21, v22
    v_add_u32 v20, v20, v21
    s_waitcnt lgkmcnt(0)
    v_add_f32 v18, v18, v25
    v_add_f32 v26, v26, v27
    v_add_f32 v18, v18, v26
    v_add_f32 v19, v19, v28
    v_add_f32 v29, v29, v30
    v_add_f32 v19, v19, v29
    v_add_f32 v19, v18, v19
    v_cndmask_b32 v18, v18, v19, vcc
    buffer_atomic_add_f32 v18, v20, s[36:39], s42 offen
    v_add_u32 v4, 1280, v0
    v_mov_b32 v7, 1249
    v_mul_u32_u24 v5, v7, v4
    v_lshrrev_b32 v5, 19, v5
    v_mul_u32_u24 v7, 420, v5
    v_sub_u32 v6, v4, v7
    v_mov_b32 v7, 205
    v_mul_u32_u24 v9, v7, v6
    v_lshrrev_b32 v9, 12, v9
    v_mul_u32_u24 v7, 20, v9
    v_sub_u32 v8, v6, v7
    v_mul_u32_u24 v10, 20, v5
    v_add_u32 v11, v10, v8
    v_add_u32 v12, v10, v9
    v_add_u32 v12, 80, v12
    v_cmp_eq_u32 vcc, 20, v9
    v_lshrrev_b32 v14, 5, v11
    v_lshrrev_b32 v15, 5, v12
    v_add_u32 v14, v14, v15
    v_subrev_u32 v14, 2, v14
    v_and_b32 v15, 31, v11
    v_lshrrev_b32 v16, 3, v15
    v_lshlrev_b32 v16, 2, v16
    v_and_b32 v17, 3, v15
    v_add_u32 v16, v16, v17
    v_lshlrev_b32 v14, 4, v14
    v_add_u32 v14, v14, v16
    v_lshlrev_b32 v14, 8, v14
    v_lshrrev_b32 v16, 2, v15
    v_and_b32 v16, 1, v16
    v_lshlrev_b32 v16, 5, v16
    v_and_b32 v17, 31, v12
    v_add_u32 v16, v16, v17
    v_lshlrev_b32 v16, 2, v16
    v_add_u32 v14, v14, v16
    v_lshrrev_b32 v16, 5, v11
    v_lshlrev_b32 v16, 8, v16
    v_lshlrev_b32 v17, 2, v15
    v_add_u32 v16, v16, v17
    v_add_u32 v16, 20480, v16
    v_cndmask_b32 v14, v14, v16, vcc
    v_add_u32 v23, 43008, v14
    v_add_u32 v24, 43008, v16
    ds_read_b32 v18, v14 offset:4096
    ds_read_b32 v25, v14 offset:25600
    ds_read_b32 v26, v23 offset:4096
    ds_read_b32 v27, v23 offset:25600
    ds_read_b32 v19, v16 offset:4224
    ds_read_b32 v28, v16 offset:25728
    ds_read_b32 v29, v24 offset:4224
    ds_read_b32 v30, v24 offset:25728
    v_lshlrev_b32 v20, 12, v5
    v_lshlrev_b32 v21, 7, v9
    v_lshlrev_b32 v22, 2, v8
    v_add_u32 v21, v21, v22
    v_add_u32 v20, v20, v21
    s_waitcnt lgkmcnt(0)
    v_add_f32 v18, v18, v25
    v_add_f32 v26, v26, v27
    v_add_f32 v18, v18, v26
    v_add_f32 v19, v19, v28
    v_add_f32 v29, v29, v30
    v_add_f32 v19, v19, v29
    v_add_f32 v19, v18, v19
    v_cndmask_b32 v18, v18, v19, vcc
    buffer_atomic_add_f32 v18, v20, s[36:39], s42 offen
    v_add_u32 v4, 1536, v0
    v_cmp_gt_u32 vcc, 1680, v4
    s_and_saveexec_b64 s[56:57], vcc
    v_mov_b32 v7, 1249
    v_mul_u32_u24 v5, v7, v4
    v_lshrrev_b32 v5, 19, v5
    v_mul_u32_u24 v7, 420, v5
    v_sub_u32 v6, v4, v7
    v_mov_b32 v7, 205
    v_mul_u32_u24 v9, v7, v6
    v_lshrrev_b32 v9, 12, v9
    v_mul_u32_u24 v7, 20, v9
    v_sub_u32 v8, v6, v7
    v_mul_u32_u24 v10, 20, v5
    v_add_u32 v11, v10, v8
    v_add_u32 v12, v10, v9
    v_add_u32 v12, 80, v12
    v_cmp_eq_u32 vcc, 20, v9
    v_lshrrev_b32 v14, 5, v11
    v_lshrrev_b32 v15, 5, v12
    v_add_u32 v14, v14, v15
    v_subrev_u32 v14, 2, v14
    v_and_b32 v15, 31, v11
    v_lshrrev_b32 v16, 3, v15
    v_lshlrev_b32 v16, 2, v16
    v_and_b32 v17, 3, v15
    v_add_u32 v16, v16, v17
    v_lshlrev_b32 v14, 4, v14
    v_add_u32 v14, v14, v16
    v_lshlrev_b32 v14, 8, v14
    v_lshrrev_b32 v16, 2, v15
    v_and_b32 v16, 1, v16
    v_lshlrev_b32 v16, 5, v16
    v_and_b32 v17, 31, v12
    v_add_u32 v16, v16, v17
    v_lshlrev_b32 v16, 2, v16
    v_add_u32 v14, v14, v16
    v_lshrrev_b32 v16, 5, v11
    v_lshlrev_b32 v16, 8, v16
    v_lshlrev_b32 v17, 2, v15
    v_add_u32 v16, v16, v17
    v_add_u32 v16, 20480, v16
    v_cndmask_b32 v14, v14, v16, vcc
    v_add_u32 v23, 43008, v14
    v_add_u32 v24, 43008, v16
    ds_read_b32 v18, v14 offset:4096
    ds_read_b32 v25, v14 offset:25600
    ds_read_b32 v26, v23 offset:4096
    ds_read_b32 v27, v23 offset:25600
    ds_read_b32 v19, v16 offset:4224
    ds_read_b32 v28, v16 offset:25728
    ds_read_b32 v29, v24 offset:4224
    ds_read_b32 v30, v24 offset:25728
    v_lshlrev_b32 v20, 12, v5
    v_lshlrev_b32 v21, 7, v9
    v_lshlrev_b32 v22, 2, v8
    v_add_u32 v21, v21, v22
    v_add_u32 v20, v20, v21
    s_waitcnt lgkmcnt(0)
    v_add_f32 v18, v18, v25
    v_add_f32 v26, v26, v27
    v_add_f32 v18, v18, v26
    v_add_f32 v19, v19, v28
    v_add_f32 v29, v29, v30
    v_add_f32 v19, v19, v29
    v_add_f32 v19, v18, v19
    v_cndmask_b32 v18, v18, v19, vcc
    buffer_atomic_add_f32 v18, v20, s[36:39], s42 offen
    s_mov_b64 exec, s[56:57]
    s_waitcnt vmcnt(0)
    s_endpgm
K1_qpath:
    v_mov_b32 v100, 0
    v_mov_b32 v101, 0
    v_mov_b32 v102, 0
    v_mov_b32 v103, 0
    v_mov_b32 v104, 0
    v_mov_b32 v105, 0
    v_mov_b32 v106, 0
    v_mov_b32 v107, 0
    v_mov_b32 v108, 0
    v_mov_b32 v109, 0
    v_mov_b32 v110, 0
    v_mov_b32 v111, 0
    v_mov_b32 v112, 0
    v_mov_b32 v113, 0
    v_mov_b32 v114, 0
    v_mov_b32 v115, 0
    v_mov_b32 v116, 0
    v_mov_b32 v117, 0
    v_mov_b32 v118, 0
    v_mov_b32 v119, 0
    v_mov_b32 v120, 0
    v_mov_b32 v121, 0
    v_mov_b32 v122, 0
    v_mov_b32 v123, 0
    v_mov_b32 v124, 0
    v_mov_b32 v125, 0
    v_mov_b32 v126, 0
    v_mov_b32 v127, 0
    v_mov_b32 v128, 0
    v_mov_b32 v129, 0
    v_mov_b32 v130, 0
    v_mov_b32 v131, 0
    v_mov_b32 v132, 0
    v_mov_b32 v133, 0
    v_mov_b32 v134, 0
    v_mov_b32 v135, 0
    v_mov_b32 v136, 0
    v_mov_b32 v137, 0
    v_mov_b32 v138, 0
    v_mov_b32 v139, 0
    v_mov_b32 v140, 0
    v_mov_b32 v141, 0
    v_mov_b32 v142, 0
    v_mov_b32 v143, 0
    v_mov_b32 v144, 0
    v_mov_b32 v145, 0
    v_mov_b32 v146, 0
    v_mov_b32 v147, 0
    v_mov_b32 v148, 0
    v_mov_b32 v149, 0
    v_mov_b32 v150, 0
    v_mov_b32 v151, 0
    v_mov_b32 v152, 0
    v_mov_b32 v153, 0
    v_mov_b32 v154, 0
    v_mov_b32 v155, 0
    v_mov_b32 v156, 0
    v_mov_b32 v157, 0
    v_mov_b32 v158, 0
    v_mov_b32 v159, 0
    v_mov_b32 v160, 0
    v_mov_b32 v161, 0
    v_mov_b32 v162, 0
    v_mov_b32 v163, 0
    v_mov_b32 v164, 0
    v_mov_b32 v165, 0
    v_mov_b32 v166, 0
    v_mov_b32 v167, 0
    v_mov_b32 v168, 0
    v_mov_b32 v169, 0
    v_mov_b32 v170, 0
    v_mov_b32 v171, 0
    v_mov_b32 v172, 0
    v_mov_b32 v173, 0
    v_mov_b32 v174, 0
    v_mov_b32 v175, 0
    v_mov_b32 v176, 0
    v_mov_b32 v177, 0
    v_mov_b32 v178, 0
    v_mov_b32 v179, 0
    s_add_u32 m0, s62, 4096
    s_nop 0
    buffer_load_dwordx4 v10, s[28:31], s60 offen lds
    s_add_u32 m0, s62, 5120
    s_nop 0
    buffer_load_dwordx4 v11, s[28:31], s60 offen lds
    s_add_u32 m0, s62, 6144
    s_nop 0
    buffer_load_dwordx4 v12, s[28:31], s60 offen lds
    s_add_u32 m0, s62, 7168
    s_nop 0
    buffer_load_dwordx4 v13, s[28:31], s60 offen lds
    s_add_u32 s60, s60, 128
    s_add_u32 m0, s63, 69632
    s_nop 0
    buffer_load_dwordx4 v14, s[32:35], s61 offen lds
    s_add_u32 m0, s63, 70656
    s_nop 0
    buffer_load_dwordx4 v15, s[32:35], s61 offen lds
    s_add_u32 m0, s63, 71680
    s_nop 0
    buffer_load_dwordx4 v16, s[32:35], s61 offen lds
    s_add_u32 m0, s63, 72704
    s_nop 0
    buffer_load_dwordx4 v17, s[32:35], s61 offen lds
    s_add_u32 m0, s63, 73728
    s_nop 0
    buffer_load_dwordx4 v18, s[32:35], s61 offen lds
    s_add_u32 s61, s61, 245760
    s_add_u32 m0, s62, 20480
    s_nop 0
    buffer_load_dwordx4 v10, s[28:31], s60 offen lds
    s_add_u32 m0, s62, 21504
    s_nop 0
    buffer_load_dwordx4 v11, s[28:31], s60 offen lds
    s_add_u32 m0, s62, 22528
    s_nop 0
    buffer_load_dwordx4 v12, s[28:31], s60 offen lds
    s_add_u32 m0, s62, 23552
    s_nop 0
    buffer_load_dwordx4 v13, s[28:31], s60 offen lds
    s_add_u32 s60, s60, 128
    s_add_u32 m0, s63, 90112
    s_nop 0
    buffer_load_dwordx4 v14, s[32:35], s61 offen lds
    s_add_u32 m0, s63, 91136
    s_nop 0
    buffer_load_dwordx4 v15, s[32:35], s61 offen lds
    s_add_u32 m0, s63, 92160
    s_nop 0
    buffer_load_dwordx4 v16, s[32:35], s61 offen lds
    s_add_u32 m0, s63, 93184
    s_nop 0
    buffer_load_dwordx4 v17, s[32:35], s61 offen lds
    s_add_u32 m0, s63, 94208
    s_nop 0
    buffer_load_dwordx4 v18, s[32:35], s61 offen lds
    s_add_u32 s61, s61, 245760
    s_add_u32 m0, s62, 36864
    s_nop 0
    buffer_load_dwordx4 v10, s[28:31], s60 offen lds
    s_add_u32 m0, s62, 37888
    s_nop 0
    buffer_load_dwordx4 v11, s[28:31], s60 offen lds
    s_add_u32 m0, s62, 38912
    s_nop 0
    buffer_load_dwordx4 v12, s[28:31], s60 offen lds
    s_add_u32 m0, s62, 39936
    s_nop 0
    buffer_load_dwordx4 v13, s[28:31], s60 offen lds
    s_add_u32 s60, s60, 128
    s_add_u32 m0, s63, 110592
    s_nop 0
    buffer_load_dwordx4 v14, s[32:35], s61 offen lds
    s_add_u32 m0, s63, 111616
    s_nop 0
    buffer_load_dwordx4 v15, s[32:35], s61 offen lds
    s_add_u32 m0, s63, 112640
    s_nop 0
    buffer_load_dwordx4 v16, s[32:35], s61 offen lds
    s_add_u32 m0, s63, 113664
    s_nop 0
    buffer_load_dwordx4 v17, s[32:35], s61 offen lds
    s_add_u32 m0, s63, 114688
    s_nop 0
    buffer_load_dwordx4 v18, s[32:35], s61 offen lds
    s_add_u32 s61, s61, 245760
    s_waitcnt vmcnt(18)
    s_barrier
    v_cmp_gt_u32 vcc, 128, v0
    s_and_saveexec_b64 s[56:57], vcc
    v_add_f32 v202, v180, v182
    v_add_f32 v202, v202, v184
    v_add_f32 v202, v202, v186
    v_add_f32 v202, v202, v188
    v_add_f32 v202, v202, v190
    v_add_f32 v202, v202, v192
    v_add_f32 v202, v202, v194
    v_mul_f32 v202, 986500301, v202
    v_add_f32 v203, v181, v183
    v_add_f32 v203, v203, v185
    v_add_f32 v203, v203, v187
    v_add_f32 v203, v203, v189
    v_add_f32 v203, v203, v191
    v_add_f32 v203, v203, v193
    v_add_f32 v203, v203, v195
    v_fma_f32 v204, v180, s99, -v202
    v_mul_f32 v205, v204, v204
    v_fma_f32 v203, v205, s100, v203
    v_fma_f32 v204, v182, s99, -v202
    v_mul_f32 v205, v204, v204
    v_fma_f32 v203, v205, s100, v203
    v_fma_f32 v204, v184, s99, -v202
    v_mul_f32 v205, v204, v204
    v_fma_f32 v203, v205, s100, v203
    v_fma_f32 v204, v186, s99, -v202
    v_mul_f32 v205, v204, v204
    v_fma_f32 v203, v205, s100, v203
    v_fma_f32 v204, v188, s99, -v202
    v_mul_f32 v205, v204, v204
    v_fma_f32 v203, v205, s100, v203
    v_fma_f32 v204, v190, s99, -v202
    v_mul_f32 v205, v204, v204
    v_fma_f32 v203, v205, s100, v203
    v_fma_f32 v204, v192, s99, -v202
    v_mul_f32 v205, v204, v204
    v_fma_f32 v203, v205, s100, v203
    v_fma_f32 v204, v194, s99, -v202
    v_mul_f32 v205, v204, v204
    v_fma_f32 v203, v205, s100, v203
    v_mul_f32 v203, 986500301, v203
    v_add_f32 v203, 925353388, v203
    v_rsq_f32 v200, v203
    s_nop 0
    v_mul_f32 v201, v200, v202
    v_sub_f32 v201, 0, v201
    v_lshlrev_b32 v202, 3, v0
    ds_write_b64 v202, v[200:201] offset:0
    s_mov_b64 exec, s[56:57]
    v_cmp_gt_u32 vcc, 40, v0
    s_and_saveexec_b64 s[56:57], vcc
    v_lshlrev_b32 v202, 4, v0
    ds_write_b128 v202, v[196:199] offset:1024
    s_mov_b64 exec, s[56:57]
    ds_read_b128 v[40:43], v20 offset:4096
    ds_read_b64_tr_b16 v[44:45], v24 offset:0
    ds_read_b64_tr_b16 v[46:47], v24 offset:1280
    ds_read_b64_tr_b16 v[48:49], v24 offset:64
    ds_read_b64_tr_b16 v[50:51], v24 offset:1344
    ds_read_b64_tr_b16 v[52:53], v24 offset:128
    ds_read_b64_tr_b16 v[54:55], v24 offset:1408
    ds_read_b64_tr_b16 v[56:57], v24 offset:192
    ds_read_b64_tr_b16 v[58:59], v24 offset:1472
    ds_read_b64_tr_b16 v[60:61], v24 offset:256
    ds_read_b64_tr_b16 v[62:63], v24 offset:1536
    s_waitcnt lgkmcnt(0)
    v_mfma_f32_32x32x16_bf16 v[100:115], v[44:47], v[40:43], v[100:115]
    ds_read_b128 v[64:67], v21 offset:4096
    ds_read_b64_tr_b16 v[68:69], v24 offset:5120
    ds_read_b64_tr_b16 v[70:71], v24 offset:6400
    v_mfma_f32_32x32x16_bf16 v[116:131], v[48:51], v[40:43], v[116:131]
    ds_read_b64_tr_b16 v[72:73], v24 offset:5184
    ds_read_b64_tr_b16 v[74:75], v24 offset:6464
    ds_read_b64_tr_b16 v[76:77], v24 offset:5248
    s_add_u32 m0, s62, 53248
    s_nop 0
    buffer_load_dwordx4 v10, s[28:31], s60 offen lds
    v_mfma_f32_32x32x16_bf16 v[132:147], v[52:55], v[40:43], v[132:147]
    ds_read_b64_tr_b16 v[78:79], v24 offset:6528
    ds_read_b64_tr_b16 v[80:81], v24 offset:5312
    ds_read_b64_tr_b16 v[82:83], v24 offset:6592
    s_add_u32 m0, s62, 54272
    s_nop 0
    buffer_load_dwordx4 v11, s[28:31], s60 offen lds
    v_mfma_f32_32x32x16_bf16 v[148:163], v[56:59], v[40:43], v[148:163]
    ds_read_b64_tr_b16 v[84:85], v24 offset:5376
    ds_read_b64_tr_b16 v[86:87], v24 offset:6656
    s_add_u32 m0, s62, 55296
    s_nop 0
    buffer_load_dwordx4 v12, s[28:31], s60 offen lds
    v_mfma_f32_32x32x16_bf16 v[164:179], v[60:63], v[40:43], v[164:179]
    s_waitcnt lgkmcnt(0)
    v_mfma_f32_32x32x16_bf16 v[100:115], v[68:71], v[64:67], v[100:115]
    ds_read_b128 v[40:43], v22 offset:4096
    ds_read_b64_tr_b16 v[44:45], v24 offset:10240
    ds_read_b64_tr_b16 v[46:47], v24 offset:11520
    v_mfma_f32_32x32x16_bf16 v[116:131], v[72:75], v[64:67], v[116:131]
    ds_read_b64_tr_b16 v[48:49], v24 offset:10304
    ds_read_b64_tr_b16 v[50:51], v24 offset:11584
    ds_read_b64_tr_b16 v[52:53], v24 offset:10368
    s_add_u32 m0, s62, 56320
    s_nop 0
    buffer_load_dwordx4 v13, s[28:31], s60 offen lds
    s_add_u32 s60, s60, 128
    v_mfma_f32_32x32x16_bf16 v[132:147], v[76:79], v[64:67], v[132:147]
    ds_read_b64_tr_b16 v[54:55], v24 offset:11648
    ds_read_b64_tr_b16 v[56:57], v24 offset:10432
    ds_read_b64_tr_b16 v[58:59], v24 offset:11712
    v_mfma_f32_32x32x16_bf16 v[148:163], v[80:83], v[64:67], v[148:163]
    ds_read_b64_tr_b16 v[60:61], v24 offset:10496
    ds_read_b64_tr_b16 v[62:63], v24 offset:11776
    s_add_u32 m0, s63, 131072
    s_nop 0
    buffer_load_dwordx4 v14, s[32:35], s61 offen lds
    v_mfma_f32_32x32x16_bf16 v[164:179], v[84:87], v[64:67], v[164:179]
    s_waitcnt lgkmcnt(0)
    v_mfma_f32_32x32x16_bf16 v[100:115], v[44:47], v[40:43], v[100:115]
    ds_read_b128 v[64:67], v23 offset:4096
    ds_read_b64_tr_b16 v[68:69], v24 offset:15360
    ds_read_b64_tr_b16 v[70:71], v24 offset:16640
    v_mfma_f32_32x32x16_bf16 v[116:131], v[48:51], v[40:43], v[116:131]
    ds_read_b64_tr_b16 v[72:73], v24 offset:15424
    ds_read_b64_tr_b16 v[74:75], v24 offset:16704
    ds_read_b64_tr_b16 v[76:77], v24 offset:15488
    s_add_u32 m0, s63, 132096
    s_nop 0
    buffer_load_dwordx4 v15, s[32:35], s61 offen lds
    v_mfma_f32_32x32x16_bf16 v[132:147], v[52:55], v[40:43], v[132:147]
    ds_read_b64_tr_b16 v[78:79], v24 offset:16768
    ds_read_b64_tr_b16 v[80:81], v24 offset:15552
    ds_read_b64_tr_b16 v[82:83], v24 offset:16832
    v_mfma_f32_32x32x16_bf16 v[148:163], v[56:59], v[40:43], v[148:163]
    ds_read_b64_tr_b16 v[84:85], v24 offset:15616
    ds_read_b64_tr_b16 v[86:87], v24 offset:16896
    s_add_u32 m0, s63, 133120
    s_nop 0
    buffer_load_dwordx4 v16, s[32:35], s61 offen lds
    v_mfma_f32_32x32x16_bf16 v[164:179], v[60:63], v[40:43], v[164:179]
    s_waitcnt lgkmcnt(0)
    s_add_u32 m0, s63, 134144
    s_nop 0
    buffer_load_dwordx4 v17, s[32:35], s61 offen lds
    s_add_u32 m0, s63, 135168
    s_nop 0
    buffer_load_dwordx4 v18, s[32:35], s61 offen lds
    s_add_u32 s61, s61, 245760
    s_waitcnt vmcnt(18)
    s_barrier
    v_mfma_f32_32x32x16_bf16 v[100:115], v[68:71], v[64:67], v[100:115]
    ds_read_b128 v[40:43], v20 offset:20480
    ds_read_b64_tr_b16 v[44:45], v24 offset:20480
    ds_read_b64_tr_b16 v[46:47], v24 offset:21760
    v_mfma_f32_32x32x16_bf16 v[116:131], v[72:75], v[64:67], v[116:131]
    ds_read_b64_tr_b16 v[48:49], v24 offset:20544
    ds_read_b64_tr_b16 v[50:51], v24 offset:21824
    ds_read_b64_tr_b16 v[52:53], v24 offset:20608
    s_add_u32 m0, s62, 4096
    s_nop 0
    buffer_load_dwordx4 v10, s[28:31], s60 offen lds
    s_add_u32 m0, s62, 5120
    s_nop 0
    buffer_load_dwordx4 v11, s[28:31], s60 offen lds
    s_add_u32 m0, s62, 6144
    s_nop 0
    buffer_load_dwordx4 v12, s[28:31], s60 offen lds
    v_mfma_f32_32x32x16_bf16 v[132:147], v[76:79], v[64:67], v[132:147]
    ds_read_b64_tr_b16 v[54:55], v24 offset:21888
    ds_read_b64_tr_b16 v[56:57], v24 offset:20672
    ds_read_b64_tr_b16 v[58:59], v24 offset:21952
    s_add_u32 m0, s62, 7168
    s_nop 0
    buffer_load_dwordx4 v13, s[28:31], s60 offen lds
    s_add_u32 s60, s60, 128
    s_add_u32 m0, s63, 69632
    s_nop 0
    buffer_load_dwordx4 v14, s[32:35], s61 offen lds
    v_mfma_f32_32x32x16_bf16 v[148:163], v[80:83], v[64:67], v[148:163]
    ds_read_b64_tr_b16 v[60:61], v24 offset:20736
    ds_read_b64_tr_b16 v[62:63], v24 offset:22016
    s_add_u32 m0, s63, 70656
    s_nop 0
    buffer_load_dwordx4 v15, s[32:35], s61 offen lds
    s_add_u32 m0, s63, 71680
    s_nop 0
    buffer_load_dwordx4 v16, s[32:35], s61 offen lds
    v_mfma_f32_32x32x16_bf16 v[164:179], v[84:87], v[64:67], v[164:179]
    s_add_u32 m0, s63, 72704
    s_nop 0
    buffer_load_dwordx4 v17, s[32:35], s61 offen lds
    s_add_u32 m0, s63, 73728
    s_nop 0
    buffer_load_dwordx4 v18, s[32:35], s61 offen lds
    s_add_u32 s61, s61, 245760
    s_waitcnt lgkmcnt(0)
    v_mfma_f32_32x32x16_bf16 v[100:115], v[44:47], v[40:43], v[100:115]
    ds_read_b128 v[64:67], v21 offset:20480
    ds_read_b64_tr_b16 v[68:69], v24 offset:25600
    ds_read_b64_tr_b16 v[70:71], v24 offset:26880
    v_mfma_f32_32x32x16_bf16 v[116:131], v[48:51], v[40:43], v[116:131]
    ds_read_b64_tr_b16 v[72:73], v24 offset:25664
    ds_read_b64_tr_b16 v[74:75], v24 offset:26944
    ds_read_b64_tr_b16 v[76:77], v24 offset:25728
    v_mfma_f32_32x32x16_bf16 v[132:147], v[52:55], v[40:43], v[132:147]
    ds_read_b64_tr_b16 v[78:79], v24 offset:27008
    ds_read_b64_tr_b16 v[80:81], v24 offset:25792
    ds_read_b64_tr_b16 v[82:83], v24 offset:27072
    v_mfma_f32_32x32x16_bf16 v[148:163], v[56:59], v[40:43], v[148:163]
    ds_read_b64_tr_b16 v[84:85], v24 offset:25856
    ds_read_b64_tr_b16 v[86:87], v24 offset:27136
    v_mfma_f32_32x32x16_bf16 v[164:179], v[60:63], v[40:43], v[164:179]
    s_waitcnt lgkmcnt(0)
    v_mfma_f32_32x32x16_bf16 v[100:115], v[68:71], v[64:67], v[100:115]
    ds_read_b128 v[40:43], v22 offset:20480
    ds_read_b64_tr_b16 v[44:45], v24 offset:30720
    ds_read_b64_tr_b16 v[46:47], v24 offset:32000
    v_mfma_f32_32x32x16_bf16 v[116:131], v[72:75], v[64:67], v[116:131]
    ds_read_b64_tr_b16 v[48:49], v24 offset:30784
    ds_read_b64_tr_b16 v[50:51], v24 offset:32064
    ds_read_b64_tr_b16 v[52:53], v24 offset:30848
    v_mfma_f32_32x32x16_bf16 v[132:147], v[76:79], v[64:67], v[132:147]
    ds_read_b64_tr_b16 v[54:55], v24 offset:32128
    ds_read_b64_tr_b16 v[56:57], v24 offset:30912
    ds_read_b64_tr_b16 v[58:59], v24 offset:32192
    v_mfma_f32_32x32x16_bf16 v[148:163], v[80:83], v[64:67], v[148:163]
    ds_read_b64_tr_b16 v[60:61], v24 offset:30976
    ds_read_b64_tr_b16 v[62:63], v24 offset:32256
    v_mfma_f32_32x32x16_bf16 v[164:179], v[84:87], v[64:67], v[164:179]
    s_waitcnt lgkmcnt(0)
    v_mfma_f32_32x32x16_bf16 v[100:115], v[44:47], v[40:43], v[100:115]
    ds_read_b128 v[64:67], v23 offset:20480
    ds_read_b64_tr_b16 v[68:69], v24 offset:35840
    ds_read_b64_tr_b16 v[70:71], v24 offset:37120
    v_mfma_f32_32x32x16_bf16 v[116:131], v[48:51], v[40:43], v[116:131]
    ds_read_b64_tr_b16 v[72:73], v24 offset:35904
    ds_read_b64_tr_b16 v[74:75], v24 offset:37184
    ds_read_b64_tr_b16 v[76:77], v24 offset:35968
    v_mfma_f32_32x32x16_bf16 v[132:147], v[52:55], v[40:43], v[132:147]
    ds_read_b64_tr_b16 v[78:79], v24 offset:37248
    ds_read_b64_tr_b16 v[80:81], v24 offset:36032
    ds_read_b64_tr_b16 v[82:83], v24 offset:37312
    v_mfma_f32_32x32x16_bf16 v[148:163], v[56:59], v[40:43], v[148:163]
    ds_read_b64_tr_b16 v[84:85], v24 offset:36096
    ds_read_b64_tr_b16 v[86:87], v24 offset:37376
    v_mfma_f32_32x32x16_bf16 v[164:179], v[60:63], v[40:43], v[164:179]
    s_waitcnt lgkmcnt(0)
    s_waitcnt vmcnt(18)
    s_barrier
    v_mfma_f32_32x32x16_bf16 v[100:115], v[68:71], v[64:67], v[100:115]
    ds_read_b128 v[40:43], v20 offset:36864
    ds_read_b64_tr_b16 v[44:45], v24 offset:40960
    ds_read_b64_tr_b16 v[46:47], v24 offset:42240
    v_mfma_f32_32x32x16_bf16 v[116:131], v[72:75], v[64:67], v[116:131]
    ds_read_b64_tr_b16 v[48:49], v24 offset:41024
    ds_read_b64_tr_b16 v[50:51], v24 offset:42304
    ds_read_b64_tr_b16 v[52:53], v24 offset:41088
    s_add_u32 m0, s62, 20480
    s_nop 0
    buffer_load_dwordx4 v10, s[28:31], s60 offen lds
    s_add_u32 m0, s62, 21504
    s_nop 0
    buffer_load_dwordx4 v11, s[28:31], s60 offen lds
    s_add_u32 m0, s62, 22528
    s_nop 0
    buffer_load_dwordx4 v12, s[28:31], s60 offen lds
    v_mfma_f32_32x32x16_bf16 v[132:147], v[76:79], v[64:67], v[132:147]
    ds_read_b64_tr_b16 v[54:55], v24 offset:42368
    ds_read_b64_tr_b16 v[56:57], v24 offset:41152
    ds_read_b64_tr_b16 v[58:59], v24 offset:42432
    s_add_u32 m0, s62, 23552
    s_nop 0
    buffer_load_dwordx4 v13, s[28:31], s60 offen lds
    s_add_u32 s60, s60, 128
    s_add_u32 m0, s63, 90112
    s_nop 0
    buffer_load_dwordx4 v14, s[32:35], s61 offen lds
    v_mfma_f32_32x32x16_bf16 v[148:163], v[80:83], v[64:67], v[148:163]
    ds_read_b64_tr_b16 v[60:61], v24 offset:41216
    ds_read_b64_tr_b16 v[62:63], v24 offset:42496
    s_add_u32 m0, s63, 91136
    s_nop 0
    buffer_load_dwordx4 v15, s[32:35], s61 offen lds
    s_add_u32 m0, s63, 92160
    s_nop 0
    buffer_load_dwordx4 v16, s[32:35], s61 offen lds
    v_mfma_f32_32x32x16_bf16 v[164:179], v[84:87], v[64:67], v[164:179]
    s_add_u32 m0, s63, 93184
    s_nop 0
    buffer_load_dwordx4 v17, s[32:35], s61 offen lds
    s_add_u32 m0, s63, 94208
    s_nop 0
    buffer_load_dwordx4 v18, s[32:35], s61 offen lds
    s_add_u32 s61, s61, 245760
    s_waitcnt lgkmcnt(0)
    v_mfma_f32_32x32x16_bf16 v[100:115], v[44:47], v[40:43], v[100:115]
    ds_read_b128 v[64:67], v21 offset:36864
    ds_read_b64_tr_b16 v[68:69], v24 offset:46080
    ds_read_b64_tr_b16 v[70:71], v24 offset:47360
    v_mfma_f32_32x32x16_bf16 v[116:131], v[48:51], v[40:43], v[116:131]
    ds_read_b64_tr_b16 v[72:73], v24 offset:46144
    ds_read_b64_tr_b16 v[74:75], v24 offset:47424
    ds_read_b64_tr_b16 v[76:77], v24 offset:46208
    v_mfma_f32_32x32x16_bf16 v[132:147], v[52:55], v[40:43], v[132:147]
    ds_read_b64_tr_b16 v[78:79], v24 offset:47488
    ds_read_b64_tr_b16 v[80:81], v24 offset:46272
    ds_read_b64_tr_b16 v[82:83], v24 offset:47552
    v_mfma_f32_32x32x16_bf16 v[148:163], v[56:59], v[40:43], v[148:163]
    ds_read_b64_tr_b16 v[84:85], v24 offset:46336
    ds_read_b64_tr_b16 v[86:87], v24 offset:47616
    v_mfma_f32_32x32x16_bf16 v[164:179], v[60:63], v[40:43], v[164:179]
    s_waitcnt lgkmcnt(0)
    v_mfma_f32_32x32x16_bf16 v[100:115], v[68:71], v[64:67], v[100:115]
    ds_read_b128 v[40:43], v22 offset:36864
    ds_read_b64_tr_b16 v[44:45], v24 offset:51200
    ds_read_b64_tr_b16 v[46:47], v24 offset:52480
    v_mfma_f32_32x32x16_bf16 v[116:131], v[72:75], v[64:67], v[116:131]
    ds_read_b64_tr_b16 v[48:49], v24 offset:51264
    ds_read_b64_tr_b16 v[50:51], v24 offset:52544
    ds_read_b64_tr_b16 v[52:53], v24 offset:51328
    v_mfma_f32_32x32x16_bf16 v[132:147], v[76:79], v[64:67], v[132:147]
    ds_read_b64_tr_b16 v[54:55], v24 offset:52608
    ds_read_b64_tr_b16 v[56:57], v24 offset:51392
    ds_read_b64_tr_b16 v[58:59], v24 offset:52672
    v_mfma_f32_32x32x16_bf16 v[148:163], v[80:83], v[64:67], v[148:163]
    ds_read_b64_tr_b16 v[60:61], v24 offset:51456
    ds_read_b64_tr_b16 v[62:63], v24 offset:52736
    v_mfma_f32_32x32x16_bf16 v[164:179], v[84:87], v[64:67], v[164:179]
    s_waitcnt lgkmcnt(0)
    v_mfma_f32_32x32x16_bf16 v[100:115], v[44:47], v[40:43], v[100:115]
    ds_read_b128 v[64:67], v23 offset:36864
    ds_read_b64_tr_b16 v[68:69], v24 offset:56320
    ds_read_b64_tr_b16 v[70:71], v24 offset:57600
    v_mfma_f32_32x32x16_bf16 v[116:131], v[48:51], v[40:43], v[116:131]
    ds_read_b64_tr_b16 v[72:73], v24 offset:56384
    ds_read_b64_tr_b16 v[74:75], v24 offset:57664
    ds_read_b64_tr_b16 v[76:77], v24 offset:56448
    v_mfma_f32_32x32x16_bf16 v[132:147], v[52:55], v[40:43], v[132:147]
    ds_read_b64_tr_b16 v[78:79], v24 offset:57728
    ds_read_b64_tr_b16 v[80:81], v24 offset:56512
    ds_read_b64_tr_b16 v[82:83], v24 offset:57792
    v_mfma_f32_32x32x16_bf16 v[148:163], v[56:59], v[40:43], v[148:163]
    ds_read_b64_tr_b16 v[84:85], v24 offset:56576
    ds_read_b64_tr_b16 v[86:87], v24 offset:57856
    v_mfma_f32_32x32x16_bf16 v[164:179], v[60:63], v[40:43], v[164:179]
    s_waitcnt lgkmcnt(0)
    s_waitcnt vmcnt(18)
    s_barrier
    v_mfma_f32_32x32x16_bf16 v[100:115], v[68:71], v[64:67], v[100:115]
    ds_read_b128 v[40:43], v20 offset:53248
    ds_read_b64_tr_b16 v[44:45], v24 offset:61440
    ds_read_b64_tr_b16 v[46:47], v24 offset:62720
    v_mfma_f32_32x32x16_bf16 v[116:131], v[72:75], v[64:67], v[116:131]
    ds_read_b64_tr_b16 v[48:49], v24 offset:61504
    ds_read_b64_tr_b16 v[50:51], v24 offset:62784
    ds_read_b64_tr_b16 v[52:53], v24 offset:61568
    s_add_u32 m0, s62, 36864
    s_nop 0
    buffer_load_dwordx4 v10, s[28:31], s60 offen lds
    s_add_u32 m0, s62, 37888
    s_nop 0
    buffer_load_dwordx4 v11, s[28:31], s60 offen lds
    s_add_u32 m0, s62, 38912
    s_nop 0
    buffer_load_dwordx4 v12, s[28:31], s60 offen lds
    v_mfma_f32_32x32x16_bf16 v[132:147], v[76:79], v[64:67], v[132:147]
    ds_read_b64_tr_b16 v[54:55], v24 offset:62848
    ds_read_b64_tr_b16 v[56:57], v24 offset:61632
    ds_read_b64_tr_b16 v[58:59], v24 offset:62912
    s_add_u32 m0, s62, 39936
    s_nop 0
    buffer_load_dwordx4 v13, s[28:31], s60 offen lds
    s_add_u32 s60, s60, 128
    s_add_u32 m0, s63, 110592
    s_nop 0
    buffer_load_dwordx4 v14, s[32:35], s61 offen lds
    v_mfma_f32_32x32x16_bf16 v[148:163], v[80:83], v[64:67], v[148:163]
    ds_read_b64_tr_b16 v[60:61], v24 offset:61696
    ds_read_b64_tr_b16 v[62:63], v24 offset:62976
    s_add_u32 m0, s63, 111616
    s_nop 0
    buffer_load_dwordx4 v15, s[32:35], s61 offen lds
    s_add_u32 m0, s63, 112640
    s_nop 0
    buffer_load_dwordx4 v16, s[32:35], s61 offen lds
    v_mfma_f32_32x32x16_bf16 v[164:179], v[84:87], v[64:67], v[164:179]
    s_add_u32 m0, s63, 113664
    s_nop 0
    buffer_load_dwordx4 v17, s[32:35], s61 offen lds
    s_add_u32 m0, s63, 114688
    s_nop 0
    buffer_load_dwordx4 v18, s[32:35], s61 offen lds
    s_add_u32 s61, s61, 245760
    s_waitcnt lgkmcnt(0)
    v_mfma_f32_32x32x16_bf16 v[100:115], v[44:47], v[40:43], v[100:115]
    ds_read_b128 v[64:67], v21 offset:53248
    ds_read_b64_tr_b16 v[68:69], v25 offset:25600
    ds_read_b64_tr_b16 v[70:71], v25 offset:26880
    v_mfma_f32_32x32x16_bf16 v[116:131], v[48:51], v[40:43], v[116:131]
    ds_read_b64_tr_b16 v[72:73], v25 offset:25664
    ds_read_b64_tr_b16 v[74:75], v25 offset:26944
    ds_read_b64_tr_b16 v[76:77], v25 offset:25728
    v_mfma_f32_32x32x16_bf16 v[132:147], v[52:55], v[40:43], v[132:147]
    ds_read_b64_tr_b16 v[78:79], v25 offset:27008
    ds_read_b64_tr_b16 v[80:81], v25 offset:25792
    ds_read_b64_tr_b16 v[82:83], v25 offset:27072
    v_mfma_f32_32x32x16_bf16 v[148:163], v[56:59], v[40:43], v[148:163]
    ds_read_b64_tr_b16 v[84:85], v25 offset:25856
    ds_read_b64_tr_b16 v[86:87], v25 offset:27136
    v_mfma_f32_32x32x16_bf16 v[164:179], v[60:63], v[40:43], v[164:179]
    s_waitcnt lgkmcnt(0)
    v_mfma_f32_32x32x16_bf16 v[100:115], v[68:71], v[64:67], v[100:115]
    ds_read_b128 v[40:43], v22 offset:53248
    ds_read_b64_tr_b16 v[44:45], v25 offset:30720
    ds_read_b64_tr_b16 v[46:47], v25 offset:32000
    v_mfma_f32_32x32x16_bf16 v[116:131], v[72:75], v[64:67], v[116:131]
    ds_read_b64_tr_b16 v[48:49], v25 offset:30784
    ds_read_b64_tr_b16 v[50:51], v25 offset:32064
    ds_read_b64_tr_b16 v[52:53], v25 offset:30848
    v_mfma_f32_32x32x16_bf16 v[132:147], v[76:79], v[64:67], v[132:147]
    ds_read_b64_tr_b16 v[54:55], v25 offset:32128
    ds_read_b64_tr_b16 v[56:57], v25 offset:30912
    ds_read_b64_tr_b16 v[58:59], v25 offset:32192
    v_mfma_f32_32x32x16_bf16 v[148:163], v[80:83], v[64:67], v[148:163]
    ds_read_b64_tr_b16 v[60:61], v25 offset:30976
    ds_read_b64_tr_b16 v[62:63], v25 offset:32256
    v_mfma_f32_32x32x16_bf16 v[164:179], v[84:87], v[64:67], v[164:179]
    s_waitcnt lgkmcnt(0)
    v_mfma_f32_32x32x16_bf16 v[100:115], v[44:47], v[40:43], v[100:115]
    ds_read_b128 v[64:67], v23 offset:53248
    ds_read_b64_tr_b16 v[68:69], v25 offset:35840
    ds_read_b64_tr_b16 v[70:71], v25 offset:37120
    v_mfma_f32_32x32x16_bf16 v[116:131], v[48:51], v[40:43], v[116:131]
    ds_read_b64_tr_b16 v[72:73], v25 offset:35904
    ds_read_b64_tr_b16 v[74:75], v25 offset:37184
    ds_read_b64_tr_b16 v[76:77], v25 offset:35968
    v_mfma_f32_32x32x16_bf16 v[132:147], v[52:55], v[40:43], v[132:147]
    ds_read_b64_tr_b16 v[78:79], v25 offset:37248
    ds_read_b64_tr_b16 v[80:81], v25 offset:36032
    ds_read_b64_tr_b16 v[82:83], v25 offset:37312
    v_mfma_f32_32x32x16_bf16 v[148:163], v[56:59], v[40:43], v[148:163]
    ds_read_b64_tr_b16 v[84:85], v25 offset:36096
    ds_read_b64_tr_b16 v[86:87], v25 offset:37376
    v_mfma_f32_32x32x16_bf16 v[164:179], v[60:63], v[40:43], v[164:179]
    s_waitcnt lgkmcnt(0)
    s_waitcnt vmcnt(18)
    s_barrier
    v_mfma_f32_32x32x16_bf16 v[100:115], v[68:71], v[64:67], v[100:115]
    ds_read_b128 v[40:43], v20 offset:4096
    ds_read_b64_tr_b16 v[44:45], v24 offset:0
    ds_read_b64_tr_b16 v[46:47], v24 offset:1280
    v_mfma_f32_32x32x16_bf16 v[116:131], v[72:75], v[64:67], v[116:131]
    ds_read_b64_tr_b16 v[48:49], v24 offset:64
    ds_read_b64_tr_b16 v[50:51], v24 offset:1344
    ds_read_b64_tr_b16 v[52:53], v24 offset:128
    s_add_u32 m0, s62, 53248
    s_nop 0
    buffer_load_dwordx4 v10, s[28:31], s60 offen lds
    s_add_u32 m0, s62, 54272
    s_nop 0
    buffer_load_dwordx4 v11, s[28:31], s60 offen lds
    s_add_u32 m0, s62, 55296
    s_nop 0
    buffer_load_dwordx4 v12, s[28:31], s60 offen lds
    v_mfma_f32_32x32x16_bf16 v[132:147], v[76:79], v[64:67], v[132:147]
    ds_read_b64_tr_b16 v[54:55], v24 offset:1408
    ds_read_b64_tr_b16 v[56:57], v24 offset:192
    ds_read_b64_tr_b16 v[58:59], v24 offset:1472
    s_add_u32 m0, s62, 56320
    s_nop 0
    buffer_load_dwordx4 v13, s[28:31], s60 offen lds
    s_add_u32 s60, s60, 128
    s_add_u32 m0, s63, 131072
    s_nop 0
    buffer_load_dwordx4 v14, s[32:35], s61 offen lds
    v_mfma_f32_32x32x16_bf16 v[148:163], v[80:83], v[64:67], v[148:163]
    ds_read_b64_tr_b16 v[60:61], v24 offset:256
    ds_read_b64_tr_b16 v[62:63], v24 offset:1536
    s_add_u32 m0, s63, 132096
    s_nop 0
    buffer_load_dwordx4 v15, s[32:35], s61 offen lds
    s_add_u32 m0, s63, 133120
    s_nop 0
    buffer_load_dwordx4 v16, s[32:35], s61 offen lds
    v_mfma_f32_32x32x16_bf16 v[164:179], v[84:87], v[64:67], v[164:179]
    s_add_u32 m0, s63, 134144
    s_nop 0
    buffer_load_dwordx4 v17, s[32:35], s61 offen lds
    s_add_u32 m0, s63, 135168
    s_nop 0
    buffer_load_dwordx4 v18, s[32:35], s61 offen lds
    s_add_u32 s61, s61, 245760
    s_waitcnt lgkmcnt(0)
    v_mfma_f32_32x32x16_bf16 v[100:115], v[44:47], v[40:43], v[100:115]
    ds_read_b128 v[64:67], v21 offset:4096
    ds_read_b64_tr_b16 v[68:69], v24 offset:5120
    ds_read_b64_tr_b16 v[70:71], v24 offset:6400
    v_mfma_f32_32x32x16_bf16 v[116:131], v[48:51], v[40:43], v[116:131]
    ds_read_b64_tr_b16 v[72:73], v24 offset:5184
    ds_read_b64_tr_b16 v[74:75], v24 offset:6464
    ds_read_b64_tr_b16 v[76:77], v24 offset:5248
    v_mfma_f32_32x32x16_bf16 v[132:147], v[52:55], v[40:43], v[132:147]
    ds_read_b64_tr_b16 v[78:79], v24 offset:6528
    ds_read_b64_tr_b16 v[80:81], v24 offset:5312
    ds_read_b64_tr_b16 v[82:83], v24 offset:6592
    v_mfma_f32_32x32x16_bf16 v[148:163], v[56:59], v[40:43], v[148:163]
    ds_read_b64_tr_b16 v[84:85], v24 offset:5376
    ds_read_b64_tr_b16 v[86:87], v24 offset:6656
    v_mfma_f32_32x32x16_bf16 v[164:179], v[60:63], v[40:43], v[164:179]
    s_waitcnt lgkmcnt(0)
    v_mfma_f32_32x32x16_bf16 v[100:115], v[68:71], v[64:67], v[100:115]
    ds_read_b128 v[40:43], v22 offset:4096
    ds_read_b64_tr_b16 v[44:45], v24 offset:10240
    ds_read_b64_tr_b16 v[46:47], v24 offset:11520
    v_mfma_f32_32x32x16_bf16 v[116:131], v[72:75], v[64:67], v[116:131]
    ds_read_b64_tr_b16 v[48:49], v24 offset:10304
    ds_read_b64_tr_b16 v[50:51], v24 offset:11584
    ds_read_b64_tr_b16 v[52:53], v24 offset:10368
    v_mfma_f32_32x32x16_bf16 v[132:147], v[76:79], v[64:67], v[132:147]
    ds_read_b64_tr_b16 v[54:55], v24 offset:11648
    ds_read_b64_tr_b16 v[56:57], v24 offset:10432
    ds_read_b64_tr_b16 v[58:59], v24 offset:11712
    v_mfma_f32_32x32x16_bf16 v[148:163], v[80:83], v[64:67], v[148:163]
    ds_read_b64_tr_b16 v[60:61], v24 offset:10496
    ds_read_b64_tr_b16 v[62:63], v24 offset:11776
    v_mfma_f32_32x32x16_bf16 v[164:179], v[84:87], v[64:67], v[164:179]
    s_waitcnt lgkmcnt(0)
    v_mfma_f32_32x32x16_bf16 v[100:115], v[44:47], v[40:43], v[100:115]
    ds_read_b128 v[64:67], v23 offset:4096
    ds_read_b64_tr_b16 v[68:69], v24 offset:15360
    ds_read_b64_tr_b16 v[70:71], v24 offset:16640
    v_mfma_f32_32x32x16_bf16 v[116:131], v[48:51], v[40:43], v[116:131]
    ds_read_b64_tr_b16 v[72:73], v24 offset:15424
    ds_read_b64_tr_b16 v[74:75], v24 offset:16704
    ds_read_b64_tr_b16 v[76:77], v24 offset:15488
    v_mfma_f32_32x32x16_bf16 v[132:147], v[52:55], v[40:43], v[132:147]
    ds_read_b64_tr_b16 v[78:79], v24 offset:16768
    ds_read_b64_tr_b16 v[80:81], v24 offset:15552
    ds_read_b64_tr_b16 v[82:83], v24 offset:16832
    v_mfma_f32_32x32x16_bf16 v[148:163], v[56:59], v[40:43], v[148:163]
    ds_read_b64_tr_b16 v[84:85], v24 offset:15616
    ds_read_b64_tr_b16 v[86:87], v24 offset:16896
    v_mfma_f32_32x32x16_bf16 v[164:179], v[60:63], v[40:43], v[164:179]
    s_waitcnt lgkmcnt(0)
    s_waitcnt vmcnt(18)
    s_barrier
    v_mfma_f32_32x32x16_bf16 v[100:115], v[68:71], v[64:67], v[100:115]
    ds_read_b128 v[40:43], v20 offset:20480
    ds_read_b64_tr_b16 v[44:45], v24 offset:20480
    ds_read_b64_tr_b16 v[46:47], v24 offset:21760
    v_mfma_f32_32x32x16_bf16 v[116:131], v[72:75], v[64:67], v[116:131]
    ds_read_b64_tr_b16 v[48:49], v24 offset:20544
    ds_read_b64_tr_b16 v[50:51], v24 offset:21824
    ds_read_b64_tr_b16 v[52:53], v24 offset:20608
    s_add_u32 m0, s62, 4096
    s_nop 0
    buffer_load_dwordx4 v10, s[28:31], s60 offen lds
    s_add_u32 m0, s62, 5120
    s_nop 0
    buffer_load_dwordx4 v11, s[28:31], s60 offen lds
    s_add_u32 m0, s62, 6144
    s_nop 0
    buffer_load_dwordx4 v12, s[28:31], s60 offen lds
    v_mfma_f32_32x32x16_bf16 v[132:147], v[76:79], v[64:67], v[132:147]
    ds_read_b64_tr_b16 v[54:55], v24 offset:21888
    ds_read_b64_tr_b16 v[56:57], v24 offset:20672
    ds_read_b64_tr_b16 v[58:59], v24 offset:21952
    s_add_u32 m0, s62, 7168
    s_nop 0
    buffer_load_dwordx4 v13, s[28:31], s60 offen lds
    s_add_u32 s60, s60, 128
    s_add_u32 m0, s63, 69632
    s_nop 0
    buffer_load_dwordx4 v14, s[32:35], s61 offen lds
    v_mfma_f32_32x32x16_bf16 v[148:163], v[80:83], v[64:67], v[148:163]
    ds_read_b64_tr_b16 v[60:61], v24 offset:20736
    ds_read_b64_tr_b16 v[62:63], v24 offset:22016
    s_add_u32 m0, s63, 70656
    s_nop 0
    buffer_load_dwordx4 v15, s[32:35], s61 offen lds
    s_add_u32 m0, s63, 71680
    s_nop 0
    buffer_load_dwordx4 v16, s[32:35], s61 offen lds
    v_mfma_f32_32x32x16_bf16 v[164:179], v[84:87], v[64:67], v[164:179]
    s_add_u32 m0, s63, 72704
    s_nop 0
    buffer_load_dwordx4 v17, s[32:35], s61 offen lds
    s_add_u32 m0, s63, 73728
    s_nop 0
    buffer_load_dwordx4 v18, s[32:35], s61 offen lds
    s_add_u32 s61, s61, 245760
    s_waitcnt lgkmcnt(0)
    v_mfma_f32_32x32x16_bf16 v[100:115], v[44:47], v[40:43], v[100:115]
    ds_read_b128 v[64:67], v21 offset:20480
    ds_read_b64_tr_b16 v[68:69], v24 offset:25600
    ds_read_b64_tr_b16 v[70:71], v24 offset:26880
    v_mfma_f32_32x32x16_bf16 v[116:131], v[48:51], v[40:43], v[116:131]
    ds_read_b64_tr_b16 v[72:73], v24 offset:25664
    ds_read_b64_tr_b16 v[74:75], v24 offset:26944
    ds_read_b64_tr_b16 v[76:77], v24 offset:25728
    v_mfma_f32_32x32x16_bf16 v[132:147], v[52:55], v[40:43], v[132:147]
    ds_read_b64_tr_b16 v[78:79], v24 offset:27008
    ds_read_b64_tr_b16 v[80:81], v24 offset:25792
    ds_read_b64_tr_b16 v[82:83], v24 offset:27072
    v_mfma_f32_32x32x16_bf16 v[148:163], v[56:59], v[40:43], v[148:163]
    ds_read_b64_tr_b16 v[84:85], v24 offset:25856
    ds_read_b64_tr_b16 v[86:87], v24 offset:27136
    v_mfma_f32_32x32x16_bf16 v[164:179], v[60:63], v[40:43], v[164:179]
    s_waitcnt lgkmcnt(0)
    v_mfma_f32_32x32x16_bf16 v[100:115], v[68:71], v[64:67], v[100:115]
    ds_read_b128 v[40:43], v22 offset:20480
    ds_read_b64_tr_b16 v[44:45], v24 offset:30720
    ds_read_b64_tr_b16 v[46:47], v24 offset:32000
    v_mfma_f32_32x32x16_bf16 v[116:131], v[72:75], v[64:67], v[116:131]
    ds_read_b64_tr_b16 v[48:49], v24 offset:30784
    ds_read_b64_tr_b16 v[50:51], v24 offset:32064
    ds_read_b64_tr_b16 v[52:53], v24 offset:30848
    v_mfma_f32_32x32x16_bf16 v[132:147], v[76:79], v[64:67], v[132:147]
    ds_read_b64_tr_b16 v[54:55], v24 offset:32128
    ds_read_b64_tr_b16 v[56:57], v24 offset:30912
    ds_read_b64_tr_b16 v[58:59], v24 offset:32192
    v_mfma_f32_32x32x16_bf16 v[148:163], v[80:83], v[64:67], v[148:163]
    ds_read_b64_tr_b16 v[60:61], v24 offset:30976
    ds_read_b64_tr_b16 v[62:63], v24 offset:32256
    v_mfma_f32_32x32x16_bf16 v[164:179], v[84:87], v[64:67], v[164:179]
    s_waitcnt lgkmcnt(0)
    v_mfma_f32_32x32x16_bf16 v[100:115], v[44:47], v[40:43], v[100:115]
    ds_read_b128 v[64:67], v23 offset:20480
    ds_read_b64_tr_b16 v[68:69], v24 offset:35840
    ds_read_b64_tr_b16 v[70:71], v24 offset:37120
    v_mfma_f32_32x32x16_bf16 v[116:131], v[48:51], v[40:43], v[116:131]
    ds_read_b64_tr_b16 v[72:73], v24 offset:35904
    ds_read_b64_tr_b16 v[74:75], v24 offset:37184
    ds_read_b64_tr_b16 v[76:77], v24 offset:35968
    v_mfma_f32_32x32x16_bf16 v[132:147], v[52:55], v[40:43], v[132:147]
    ds_read_b64_tr_b16 v[78:79], v24 offset:37248
    ds_read_b64_tr_b16 v[80:81], v24 offset:36032
    ds_read_b64_tr_b16 v[82:83], v24 offset:37312
    v_mfma_f32_32x32x16_bf16 v[148:163], v[56:59], v[40:43], v[148:163]
    ds_read_b64_tr_b16 v[84:85], v24 offset:36096
    ds_read_b64_tr_b16 v[86:87], v24 offset:37376
    v_mfma_f32_32x32x16_bf16 v[164:179], v[60:63], v[40:43], v[164:179]
    s_waitcnt lgkmcnt(0)
    s_waitcnt vmcnt(18)
    s_barrier
    v_mfma_f32_32x32x16_bf16 v[100:115], v[68:71], v[64:67], v[100:115]
    ds_read_b128 v[40:43], v20 offset:36864
    ds_read_b64_tr_b16 v[44:45], v24 offset:40960
    ds_read_b64_tr_b16 v[46:47], v24 offset:42240
    v_mfma_f32_32x32x16_bf16 v[116:131], v[72:75], v[64:67], v[116:131]
    ds_read_b64_tr_b16 v[48:49], v24 offset:41024
    ds_read_b64_tr_b16 v[50:51], v24 offset:42304
    ds_read_b64_tr_b16 v[52:53], v24 offset:41088
    s_add_u32 m0, s62, 20480
    s_nop 0
    buffer_load_dwordx4 v10, s[28:31], s60 offen lds
    s_add_u32 m0, s62, 21504
    s_nop 0
    buffer_load_dwordx4 v11, s[28:31], s60 offen lds
    s_add_u32 m0, s62, 22528
    s_nop 0
    buffer_load_dwordx4 v12, s[28:31], s60 offen lds
    v_mfma_f32_32x32x16_bf16 v[132:147], v[76:79], v[64:67], v[132:147]
    ds_read_b64_tr_b16 v[54:55], v24 offset:42368
    ds_read_b64_tr_b16 v[56:57], v24 offset:41152
    ds_read_b64_tr_b16 v[58:59], v24 offset:42432
    s_add_u32 m0, s62, 23552
    s_nop 0
    buffer_load_dwordx4 v13, s[28:31], s60 offen lds
    s_add_u32 s60, s60, 128
    s_add_u32 m0, s63, 90112
    s_nop 0
    buffer_load_dwordx4 v14, s[32:35], s61 offen lds
    v_mfma_f32_32x32x16_bf16 v[148:163], v[80:83], v[64:67], v[148:163]
    ds_read_b64_tr_b16 v[60:61], v24 offset:41216
    ds_read_b64_tr_b16 v[62:63], v24 offset:42496
    s_add_u32 m0, s63, 91136
    s_nop 0
    buffer_load_dwordx4 v15, s[32:35], s61 offen lds
    s_add_u32 m0, s63, 92160
    s_nop 0
    buffer_load_dwordx4 v16, s[32:35], s61 offen lds
    v_mfma_f32_32x32x16_bf16 v[164:179], v[84:87], v[64:67], v[164:179]
    s_add_u32 m0, s63, 93184
    s_nop 0
    buffer_load_dwordx4 v17, s[32:35], s61 offen lds
    s_add_u32 m0, s63, 94208
    s_nop 0
    buffer_load_dwordx4 v18, s[32:35], s61 offen lds
    s_add_u32 s61, s61, 245760
    s_waitcnt lgkmcnt(0)
    v_mfma_f32_32x32x16_bf16 v[100:115], v[44:47], v[40:43], v[100:115]
    ds_read_b128 v[64:67], v21 offset:36864
    ds_read_b64_tr_b16 v[68:69], v24 offset:46080
    ds_read_b64_tr_b16 v[70:71], v24 offset:47360
    v_mfma_f32_32x32x16_bf16 v[116:131], v[48:51], v[40:43], v[116:131]
    ds_read_b64_tr_b16 v[72:73], v24 offset:46144
    ds_read_b64_tr_b16 v[74:75], v24 offset:47424
    ds_read_b64_tr_b16 v[76:77], v24 offset:46208
    v_mfma_f32_32x32x16_bf16 v[132:147], v[52:55], v[40:43], v[132:147]
    ds_read_b64_tr_b16 v[78:79], v24 offset:47488
    ds_read_b64_tr_b16 v[80:81], v24 offset:46272
    ds_read_b64_tr_b16 v[82:83], v24 offset:47552
    v_mfma_f32_32x32x16_bf16 v[148:163], v[56:59], v[40:43], v[148:163]
    ds_read_b64_tr_b16 v[84:85], v24 offset:46336
    ds_read_b64_tr_b16 v[86:87], v24 offset:47616
    v_mfma_f32_32x32x16_bf16 v[164:179], v[60:63], v[40:43], v[164:179]
    s_waitcnt lgkmcnt(0)
    v_mfma_f32_32x32x16_bf16 v[100:115], v[68:71], v[64:67], v[100:115]
    ds_read_b128 v[40:43], v22 offset:36864
    ds_read_b64_tr_b16 v[44:45], v24 offset:51200
    ds_read_b64_tr_b16 v[46:47], v24 offset:52480
    v_mfma_f32_32x32x16_bf16 v[116:131], v[72:75], v[64:67], v[116:131]
    ds_read_b64_tr_b16 v[48:49], v24 offset:51264
    ds_read_b64_tr_b16 v[50:51], v24 offset:52544
    ds_read_b64_tr_b16 v[52:53], v24 offset:51328
    v_mfma_f32_32x32x16_bf16 v[132:147], v[76:79], v[64:67], v[132:147]
    ds_read_b64_tr_b16 v[54:55], v24 offset:52608
    ds_read_b64_tr_b16 v[56:57], v24 offset:51392
    ds_read_b64_tr_b16 v[58:59], v24 offset:52672
    v_mfma_f32_32x32x16_bf16 v[148:163], v[80:83], v[64:67], v[148:163]
    ds_read_b64_tr_b16 v[60:61], v24 offset:51456
    ds_read_b64_tr_b16 v[62:63], v24 offset:52736
    v_mfma_f32_32x32x16_bf16 v[164:179], v[84:87], v[64:67], v[164:179]
    s_waitcnt lgkmcnt(0)
    v_mfma_f32_32x32x16_bf16 v[100:115], v[44:47], v[40:43], v[100:115]
    ds_read_b128 v[64:67], v23 offset:36864
    ds_read_b64_tr_b16 v[68:69], v24 offset:56320
    ds_read_b64_tr_b16 v[70:71], v24 offset:57600
    v_mfma_f32_32x32x16_bf16 v[116:131], v[48:51], v[40:43], v[116:131]
    ds_read_b64_tr_b16 v[72:73], v24 offset:56384
    ds_read_b64_tr_b16 v[74:75], v24 offset:57664
    ds_read_b64_tr_b16 v[76:77], v24 offset:56448
    v_mfma_f32_32x32x16_bf16 v[132:147], v[52:55], v[40:43], v[132:147]
    ds_read_b64_tr_b16 v[78:79], v24 offset:57728
    ds_read_b64_tr_b16 v[80:81], v24 offset:56512
    ds_read_b64_tr_b16 v[82:83], v24 offset:57792
    v_mfma_f32_32x32x16_bf16 v[148:163], v[56:59], v[40:43], v[148:163]
    ds_read_b64_tr_b16 v[84:85], v24 offset:56576
    ds_read_b64_tr_b16 v[86:87], v24 offset:57856
    v_mfma_f32_32x32x16_bf16 v[164:179], v[60:63], v[40:43], v[164:179]
    s_waitcnt lgkmcnt(0)
    s_waitcnt vmcnt(18)
    s_barrier
    v_mfma_f32_32x32x16_bf16 v[100:115], v[68:71], v[64:67], v[100:115]
    ds_read_b128 v[40:43], v20 offset:53248
    ds_read_b64_tr_b16 v[44:45], v24 offset:61440
    ds_read_b64_tr_b16 v[46:47], v24 offset:62720
    v_mfma_f32_32x32x16_bf16 v[116:131], v[72:75], v[64:67], v[116:131]
    ds_read_b64_tr_b16 v[48:49], v24 offset:61504
    ds_read_b64_tr_b16 v[50:51], v24 offset:62784
    ds_read_b64_tr_b16 v[52:53], v24 offset:61568
    v_mfma_f32_32x32x16_bf16 v[132:147], v[76:79], v[64:67], v[132:147]
    ds_read_b64_tr_b16 v[54:55], v24 offset:62848
    ds_read_b64_tr_b16 v[56:57], v24 offset:61632
    ds_read_b64_tr_b16 v[58:59], v24 offset:62912
    v_mfma_f32_32x32x16_bf16 v[148:163], v[80:83], v[64:67], v[148:163]
    ds_read_b64_tr_b16 v[60:61], v24 offset:61696
    ds_read_b64_tr_b16 v[62:63], v24 offset:62976
    v_mfma_f32_32x32x16_bf16 v[164:179], v[84:87], v[64:67], v[164:179]
    s_waitcnt lgkmcnt(0)
    v_mfma_f32_32x32x16_bf16 v[100:115], v[44:47], v[40:43], v[100:115]
    ds_read_b128 v[64:67], v21 offset:53248
    ds_read_b64_tr_b16 v[68:69], v25 offset:25600
    ds_read_b64_tr_b16 v[70:71], v25 offset:26880
    v_mfma_f32_32x32x16_bf16 v[116:131], v[48:51], v[40:43], v[116:131]
    ds_read_b64_tr_b16 v[72:73], v25 offset:25664
    ds_read_b64_tr_b16 v[74:75], v25 offset:26944
    ds_read_b64_tr_b16 v[76:77], v25 offset:25728
    v_mfma_f32_32x32x16_bf16 v[132:147], v[52:55], v[40:43], v[132:147]
    ds_read_b64_tr_b16 v[78:79], v25 offset:27008
    ds_read_b64_tr_b16 v[80:81], v25 offset:25792
    ds_read_b64_tr_b16 v[82:83], v25 offset:27072
    v_mfma_f32_32x32x16_bf16 v[148:163], v[56:59], v[40:43], v[148:163]
    ds_read_b64_tr_b16 v[84:85], v25 offset:25856
    ds_read_b64_tr_b16 v[86:87], v25 offset:27136
    v_mfma_f32_32x32x16_bf16 v[164:179], v[60:63], v[40:43], v[164:179]
    s_waitcnt lgkmcnt(0)
    v_mfma_f32_32x32x16_bf16 v[100:115], v[68:71], v[64:67], v[100:115]
    ds_read_b128 v[40:43], v22 offset:53248
    ds_read_b64_tr_b16 v[44:45], v25 offset:30720
    ds_read_b64_tr_b16 v[46:47], v25 offset:32000
    v_mfma_f32_32x32x16_bf16 v[116:131], v[72:75], v[64:67], v[116:131]
    ds_read_b64_tr_b16 v[48:49], v25 offset:30784
    ds_read_b64_tr_b16 v[50:51], v25 offset:32064
    ds_read_b64_tr_b16 v[52:53], v25 offset:30848
    v_mfma_f32_32x32x16_bf16 v[132:147], v[76:79], v[64:67], v[132:147]
    ds_read_b64_tr_b16 v[54:55], v25 offset:32128
    ds_read_b64_tr_b16 v[56:57], v25 offset:30912
    ds_read_b64_tr_b16 v[58:59], v25 offset:32192
    v_mfma_f32_32x32x16_bf16 v[148:163], v[80:83], v[64:67], v[148:163]
    ds_read_b64_tr_b16 v[60:61], v25 offset:30976
    ds_read_b64_tr_b16 v[62:63], v25 offset:32256
    v_mfma_f32_32x32x16_bf16 v[164:179], v[84:87], v[64:67], v[164:179]
    s_waitcnt lgkmcnt(0)
    v_mfma_f32_32x32x16_bf16 v[100:115], v[44:47], v[40:43], v[100:115]
    ds_read_b128 v[64:67], v23 offset:53248
    ds_read_b64_tr_b16 v[68:69], v25 offset:35840
    ds_read_b64_tr_b16 v[70:71], v25 offset:37120
    v_mfma_f32_32x32x16_bf16 v[116:131], v[48:51], v[40:43], v[116:131]
    ds_read_b64_tr_b16 v[72:73], v25 offset:35904
    ds_read_b64_tr_b16 v[74:75], v25 offset:37184
    ds_read_b64_tr_b16 v[76:77], v25 offset:35968
    v_mfma_f32_32x32x16_bf16 v[132:147], v[52:55], v[40:43], v[132:147]
    ds_read_b64_tr_b16 v[78:79], v25 offset:37248
    ds_read_b64_tr_b16 v[80:81], v25 offset:36032
    ds_read_b64_tr_b16 v[82:83], v25 offset:37312
    v_mfma_f32_32x32x16_bf16 v[148:163], v[56:59], v[40:43], v[148:163]
    ds_read_b64_tr_b16 v[84:85], v25 offset:36096
    ds_read_b64_tr_b16 v[86:87], v25 offset:37376
    v_mfma_f32_32x32x16_bf16 v[164:179], v[60:63], v[40:43], v[164:179]
    s_waitcnt lgkmcnt(0)
    s_waitcnt vmcnt(9)
    s_barrier
    v_mfma_f32_32x32x16_bf16 v[100:115], v[68:71], v[64:67], v[100:115]
    ds_read_b128 v[40:43], v20 offset:4096
    ds_read_b64_tr_b16 v[44:45], v24 offset:0
    ds_read_b64_tr_b16 v[46:47], v24 offset:1280
    v_mfma_f32_32x32x16_bf16 v[116:131], v[72:75], v[64:67], v[116:131]
    ds_read_b64_tr_b16 v[48:49], v24 offset:64
    ds_read_b64_tr_b16 v[50:51], v24 offset:1344
    ds_read_b64_tr_b16 v[52:53], v24 offset:128
    v_mfma_f32_32x32x16_bf16 v[132:147], v[76:79], v[64:67], v[132:147]
    ds_read_b64_tr_b16 v[54:55], v24 offset:1408
    ds_read_b64_tr_b16 v[56:57], v24 offset:192
    ds_read_b64_tr_b16 v[58:59], v24 offset:1472
    v_mfma_f32_32x32x16_bf16 v[148:163], v[80:83], v[64:67], v[148:163]
    ds_read_b64_tr_b16 v[60:61], v24 offset:256
    ds_read_b64_tr_b16 v[62:63], v24 offset:1536
    v_mfma_f32_32x32x16_bf16 v[164:179], v[84:87], v[64:67], v[164:179]
    s_waitcnt lgkmcnt(0)
    v_mfma_f32_32x32x16_bf16 v[100:115], v[44:47], v[40:43], v[100:115]
    ds_read_b128 v[64:67], v21 offset:4096
    ds_read_b64_tr_b16 v[68:69], v24 offset:5120
    ds_read_b64_tr_b16 v[70:71], v24 offset:6400
    v_mfma_f32_32x32x16_bf16 v[116:131], v[48:51], v[40:43], v[116:131]
    ds_read_b64_tr_b16 v[72:73], v24 offset:5184
    ds_read_b64_tr_b16 v[74:75], v24 offset:6464
    ds_read_b64_tr_b16 v[76:77], v24 offset:5248
    v_mfma_f32_32x32x16_bf16 v[132:147], v[52:55], v[40:43], v[132:147]
    ds_read_b64_tr_b16 v[78:79], v24 offset:6528
    ds_read_b64_tr_b16 v[80:81], v24 offset:5312
    ds_read_b64_tr_b16 v[82:83], v24 offset:6592
    v_mfma_f32_32x32x16_bf16 v[148:163], v[56:59], v[40:43], v[148:163]
    ds_read_b64_tr_b16 v[84:85], v24 offset:5376
    ds_read_b64_tr_b16 v[86:87], v24 offset:6656
    v_mfma_f32_32x32x16_bf16 v[164:179], v[60:63], v[40:43], v[164:179]
    s_waitcnt lgkmcnt(0)
    v_mfma_f32_32x32x16_bf16 v[100:115], v[68:71], v[64:67], v[100:115]
    ds_read_b128 v[40:43], v22 offset:4096
    ds_read_b64_tr_b16 v[44:45], v24 offset:10240
    ds_read_b64_tr_b16 v[46:47], v24 offset:11520
    v_mfma_f32_32x32x16_bf16 v[116:131], v[72:75], v[64:67], v[116:131]
    ds_read_b64_tr_b16 v[48:49], v24 offset:10304
    ds_read_b64_tr_b16 v[50:51], v24 offset:11584
    ds_read_b64_tr_b16 v[52:53], v24 offset:10368
    v_mfma_f32_32x32x16_bf16 v[132:147], v[76:79], v[64:67], v[132:147]
    ds_read_b64_tr_b16 v[54:55], v24 offset:11648
    ds_read_b64_tr_b16 v[56:57], v24 offset:10432
    ds_read_b64_tr_b16 v[58:59], v24 offset:11712
    v_mfma_f32_32x32x16_bf16 v[148:163], v[80:83], v[64:67], v[148:163]
    ds_read_b64_tr_b16 v[60:61], v24 offset:10496
    ds_read_b64_tr_b16 v[62:63], v24 offset:11776
    v_mfma_f32_32x32x16_bf16 v[164:179], v[84:87], v[64:67], v[164:179]
    s_waitcnt lgkmcnt(0)
    v_mfma_f32_32x32x16_bf16 v[100:115], v[44:47], v[40:43], v[100:115]
    ds_read_b128 v[64:67], v23 offset:4096
    ds_read_b64_tr_b16 v[68:69], v24 offset:15360
    ds_read_b64_tr_b16 v[70:71], v24 offset:16640
    v_mfma_f32_32x32x16_bf16 v[116:131], v[48:51], v[40:43], v[116:131]
    ds_read_b64_tr_b16 v[72:73], v24 offset:15424
    ds_read_b64_tr_b16 v[74:75], v24 offset:16704
    ds_read_b64_tr_b16 v[76:77], v24 offset:15488
    v_mfma_f32_32x32x16_bf16 v[132:147], v[52:55], v[40:43], v[132:147]
    ds_read_b64_tr_b16 v[78:79], v24 offset:16768
    ds_read_b64_tr_b16 v[80:81], v24 offset:15552
    ds_read_b64_tr_b16 v[82:83], v24 offset:16832
    v_mfma_f32_32x32x16_bf16 v[148:163], v[56:59], v[40:43], v[148:163]
    ds_read_b64_tr_b16 v[84:85], v24 offset:15616
    ds_read_b64_tr_b16 v[86:87], v24 offset:16896
    v_mfma_f32_32x32x16_bf16 v[164:179], v[60:63], v[40:43], v[164:179]
    s_waitcnt lgkmcnt(0)
    s_waitcnt vmcnt(0)
    s_barrier
    v_mfma_f32_32x32x16_bf16 v[100:115], v[68:71], v[64:67], v[100:115]
    ds_read_b128 v[40:43], v20 offset:20480
    ds_read_b64_tr_b16 v[44:45], v24 offset:20480
    ds_read_b64_tr_b16 v[46:47], v24 offset:21760
    v_mfma_f32_32x32x16_bf16 v[116:131], v[72:75], v[64:67], v[116:131]
    ds_read_b64_tr_b16 v[48:49], v24 offset:20544
    ds_read_b64_tr_b16 v[50:51], v24 offset:21824
    ds_read_b64_tr_b16 v[52:53], v24 offset:20608
    v_mfma_f32_32x32x16_bf16 v[132:147], v[76:79], v[64:67], v[132:147]
    ds_read_b64_tr_b16 v[54:55], v24 offset:21888
    ds_read_b64_tr_b16 v[56:57], v24 offset:20672
    ds_read_b64_tr_b16 v[58:59], v24 offset:21952
    v_mfma_f32_32x32x16_bf16 v[148:163], v[80:83], v[64:67], v[148:163]
    ds_read_b64_tr_b16 v[60:61], v24 offset:20736
    ds_read_b64_tr_b16 v[62:63], v24 offset:22016
    v_mfma_f32_32x32x16_bf16 v[164:179], v[84:87], v[64:67], v[164:179]
    s_waitcnt lgkmcnt(0)
    v_mfma_f32_32x32x16_bf16 v[100:115], v[44:47], v[40:43], v[100:115]
    ds_read_b128 v[64:67], v21 offset:20480
    ds_read_b64_tr_b16 v[68:69], v24 offset:25600
    ds_read_b64_tr_b16 v[70:71], v24 offset:26880
    v_mfma_f32_32x32x16_bf16 v[116:131], v[48:51], v[40:43], v[116:131]
    ds_read_b64_tr_b16 v[72:73], v24 offset:25664
    ds_read_b64_tr_b16 v[74:75], v24 offset:26944
    ds_read_b64_tr_b16 v[76:77], v24 offset:25728
    v_mfma_f32_32x32x16_bf16 v[132:147], v[52:55], v[40:43], v[132:147]
    ds_read_b64_tr_b16 v[78:79], v24 offset:27008
    ds_read_b64_tr_b16 v[80:81], v24 offset:25792
    ds_read_b64_tr_b16 v[82:83], v24 offset:27072
    v_mfma_f32_32x32x16_bf16 v[148:163], v[56:59], v[40:43], v[148:163]
    ds_read_b64_tr_b16 v[84:85], v24 offset:25856
    ds_read_b64_tr_b16 v[86:87], v24 offset:27136
    v_mfma_f32_32x32x16_bf16 v[164:179], v[60:63], v[40:43], v[164:179]
    s_waitcnt lgkmcnt(0)
    v_mfma_f32_32x32x16_bf16 v[100:115], v[68:71], v[64:67], v[100:115]
    ds_read_b128 v[40:43], v22 offset:20480
    ds_read_b64_tr_b16 v[44:45], v24 offset:30720
    ds_read_b64_tr_b16 v[46:47], v24 offset:32000
    v_mfma_f32_32x32x16_bf16 v[116:131], v[72:75], v[64:67], v[116:131]
    ds_read_b64_tr_b16 v[48:49], v24 offset:30784
    ds_read_b64_tr_b16 v[50:51], v24 offset:32064
    ds_read_b64_tr_b16 v[52:53], v24 offset:30848
    v_mfma_f32_32x32x16_bf16 v[132:147], v[76:79], v[64:67], v[132:147]
    ds_read_b64_tr_b16 v[54:55], v24 offset:32128
    ds_read_b64_tr_b16 v[56:57], v24 offset:30912
    ds_read_b64_tr_b16 v[58:59], v24 offset:32192
    v_mfma_f32_32x32x16_bf16 v[148:163], v[80:83], v[64:67], v[148:163]
    ds_read_b64_tr_b16 v[60:61], v24 offset:30976
    ds_read_b64_tr_b16 v[62:63], v24 offset:32256
    v_mfma_f32_32x32x16_bf16 v[164:179], v[84:87], v[64:67], v[164:179]
    s_waitcnt lgkmcnt(0)
    v_mfma_f32_32x32x16_bf16 v[100:115], v[44:47], v[40:43], v[100:115]
    ds_read_b128 v[64:67], v23 offset:20480
    ds_read_b64_tr_b16 v[68:69], v24 offset:35840
    ds_read_b64_tr_b16 v[70:71], v24 offset:37120
    v_mfma_f32_32x32x16_bf16 v[116:131], v[48:51], v[40:43], v[116:131]
    ds_read_b64_tr_b16 v[72:73], v24 offset:35904
    ds_read_b64_tr_b16 v[74:75], v24 offset:37184
    ds_read_b64_tr_b16 v[76:77], v24 offset:35968
    v_mfma_f32_32x32x16_bf16 v[132:147], v[52:55], v[40:43], v[132:147]
    ds_read_b64_tr_b16 v[78:79], v24 offset:37248
    ds_read_b64_tr_b16 v[80:81], v24 offset:36032
    ds_read_b64_tr_b16 v[82:83], v24 offset:37312
    v_mfma_f32_32x32x16_bf16 v[148:163], v[56:59], v[40:43], v[148:163]
    ds_read_b64_tr_b16 v[84:85], v24 offset:36096
    ds_read_b64_tr_b16 v[86:87], v24 offset:37376
    v_mfma_f32_32x32x16_bf16 v[164:179], v[60:63], v[40:43], v[164:179]
    s_waitcnt lgkmcnt(0)
    v_mfma_f32_32x32x16_bf16 v[100:115], v[68:71], v[64:67], v[100:115]
    v_mfma_f32_32x32x16_bf16 v[116:131], v[72:75], v[64:67], v[116:131]
    v_mfma_f32_32x32x16_bf16 v[132:147], v[76:79], v[64:67], v[132:147]
    v_mfma_f32_32x32x16_bf16 v[148:163], v[80:83], v[64:67], v[148:163]
    v_mfma_f32_32x32x16_bf16 v[164:179], v[84:87], v[64:67], v[164:179]
    s_nop 7
    s_nop 7
    s_waitcnt vmcnt(0) lgkmcnt(0)
    v_and_b32 v1, 63, v0
    v_and_b32 v2, 31, v1
    v_lshrrev_b32 v3, 5, v1
    s_lshl_b32 s58, s26, 5
    v_add_u32 v2, s58, v2
    v_lshlrev_b32 v4, 3, v2
    ds_read_b64 v[200:201], v4 offset:0
    v_lshlrev_b32 v5, 4, v3
    s_lshl_b32 s54, s52, 7
    v_add_u32 v6, s54, v2
    v_mul_u32_u24 v6, 1280, v6
    s_sub_u32 s55, s53, 8
    s_mul_i32 s55, s55, 320
    v_lshlrev_b32 v7, 3, v3
    v_add_u32 v6, v6, v7
    v_add_u32 v6, s55, v6
    s_mov_b32 s64, 0x3fb8aa3b
    s_mov_b32 s65, 0x358637bd
    ds_read_b128 v[204:207], v5 offset:1024
    ds_read_b128 v[208:211], v5 offset:1056
    ds_read_b128 v[212:215], v5 offset:1088
    ds_read_b128 v[216:219], v5 offset:1120
    s_waitcnt lgkmcnt(0)
    v_mul_f32 v8, v201, v204
    v_fma_f32 v100, v200, v100, v8
    v_mul_f32 v8, s64, v100
    v_exp_f32 v8, v8
    v_add_f32 v9, 1.0, v100
    v_cmp_lt_f32 vcc, 0, v100
    s_nop 1
    v_cndmask_b32 v8, v8, v9, vcc
    v_add_f32 v100, s65, v8
    v_mul_f32 v8, v201, v205
    v_fma_f32 v101, v200, v101, v8
    v_mul_f32 v8, s64, v101
    v_exp_f32 v8, v8
    v_add_f32 v9, 1.0, v101
    v_cmp_lt_f32 vcc, 0, v101
    s_nop 1
    v_cndmask_b32 v8, v8, v9, vcc
    v_add_f32 v101, s65, v8
    v_mul_f32 v8, v201, v206
    v_fma_f32 v102, v200, v102, v8
    v_mul_f32 v8, s64, v102
    v_exp_f32 v8, v8
    v_add_f32 v9, 1.0, v102
    v_cmp_lt_f32 vcc, 0, v102
    s_nop 1
    v_cndmask_b32 v8, v8, v9, vcc
    v_add_f32 v102, s65, v8
    v_mul_f32 v8, v201, v207
    v_fma_f32 v103, v200, v103, v8
    v_mul_f32 v8, s64, v103
    v_exp_f32 v8, v8
    v_add_f32 v9, 1.0, v103
    v_cmp_lt_f32 vcc, 0, v103
    s_nop 1
    v_cndmask_b32 v8, v8, v9, vcc
    v_add_f32 v103, s65, v8
    v_mul_f32 v8, v201, v208
    v_fma_f32 v104, v200, v104, v8
    v_mul_f32 v8, s64, v104
    v_exp_f32 v8, v8
    v_add_f32 v9, 1.0, v104
    v_cmp_lt_f32 vcc, 0, v104
    s_nop 1
    v_cndmask_b32 v8, v8, v9, vcc
    v_add_f32 v104, s65, v8
    v_mul_f32 v8, v201, v209
    v_fma_f32 v105, v200, v105, v8
    v_mul_f32 v8, s64, v105
    v_exp_f32 v8, v8
    v_add_f32 v9, 1.0, v105
    v_cmp_lt_f32 vcc, 0, v105
    s_nop 1
    v_cndmask_b32 v8, v8, v9, vcc
    v_add_f32 v105, s65, v8
    v_mul_f32 v8, v201, v210
    v_fma_f32 v106, v200, v106, v8
    v_mul_f32 v8, s64, v106
    v_exp_f32 v8, v8
    v_add_f32 v9, 1.0, v106
    v_cmp_lt_f32 vcc, 0, v106
    s_nop 1
    v_cndmask_b32 v8, v8, v9, vcc
    v_add_f32 v106, s65, v8
    v_mul_f32 v8, v201, v211
    v_fma_f32 v107, v200, v107, v8
    v_mul_f32 v8, s64, v107
    v_exp_f32 v8, v8
    v_add_f32 v9, 1.0, v107
    v_cmp_lt_f32 vcc, 0, v107
    s_nop 1
    v_cndmask_b32 v8, v8, v9, vcc
    v_add_f32 v107, s65, v8
    v_mul_f32 v8, v201, v212
    v_fma_f32 v108, v200, v108, v8
    v_mul_f32 v8, s64, v108
    v_exp_f32 v8, v8
    v_add_f32 v9, 1.0, v108
    v_cmp_lt_f32 vcc, 0, v108
    s_nop 1
    v_cndmask_b32 v8, v8, v9, vcc
    v_add_f32 v108, s65, v8
    v_mul_f32 v8, v201, v213
    v_fma_f32 v109, v200, v109, v8
    v_mul_f32 v8, s64, v109
    v_exp_f32 v8, v8
    v_add_f32 v9, 1.0, v109
    v_cmp_lt_f32 vcc, 0, v109
    s_nop 1
    v_cndmask_b32 v8, v8, v9, vcc
    v_add_f32 v109, s65, v8
    v_mul_f32 v8, v201, v214
    v_fma_f32 v110, v200, v110, v8
    v_mul_f32 v8, s64, v110
    v_exp_f32 v8, v8
    v_add_f32 v9, 1.0, v110
    v_cmp_lt_f32 vcc, 0, v110
    s_nop 1
    v_cndmask_b32 v8, v8, v9, vcc
    v_add_f32 v110, s65, v8
    v_mul_f32 v8, v201, v215
    v_fma_f32 v111, v200, v111, v8
    v_mul_f32 v8, s64, v111
    v_exp_f32 v8, v8
    v_add_f32 v9, 1.0, v111
    v_cmp_lt_f32 vcc, 0, v111
    s_nop 1
    v_cndmask_b32 v8, v8, v9, vcc
    v_add_f32 v111, s65, v8
    v_mul_f32 v8, v201, v216
    v_fma_f32 v112, v200, v112, v8
    v_mul_f32 v8, s64, v112
    v_exp_f32 v8, v8
    v_add_f32 v9, 1.0, v112
    v_cmp_lt_f32 vcc, 0, v112
    s_nop 1
    v_cndmask_b32 v8, v8, v9, vcc
    v_add_f32 v112, s65, v8
    v_mul_f32 v8, v201, v217
    v_fma_f32 v113, v200, v113, v8
    v_mul_f32 v8, s64, v113
    v_exp_f32 v8, v8
    v_add_f32 v9, 1.0, v113
    v_cmp_lt_f32 vcc, 0, v113
    s_nop 1
    v_cndmask_b32 v8, v8, v9, vcc
    v_add_f32 v113, s65, v8
    v_mul_f32 v8, v201, v218
    v_fma_f32 v114, v200, v114, v8
    v_mul_f32 v8, s64, v114
    v_exp_f32 v8, v8
    v_add_f32 v9, 1.0, v114
    v_cmp_lt_f32 vcc, 0, v114
    s_nop 1
    v_cndmask_b32 v8, v8, v9, vcc
    v_add_f32 v114, s65, v8
    v_mul_f32 v8, v201, v219
    v_fma_f32 v115, v200, v115, v8
    v_mul_f32 v8, s64, v115
    v_exp_f32 v8, v8
    v_add_f32 v9, 1.0, v115
    v_cmp_lt_f32 vcc, 0, v115
    s_nop 1
    v_cndmask_b32 v8, v8, v9, vcc
    v_add_f32 v115, s65, v8
    v_cvt_pk_bf16_f32 v10, v100, v101
    v_cvt_pk_bf16_f32 v11, v102, v103
    v_cvt_pk_bf16_f32 v12, v104, v105
    v_cvt_pk_bf16_f32 v13, v106, v107
    v_cvt_pk_bf16_f32 v14, v108, v109
    v_cvt_pk_bf16_f32 v15, v110, v111
    v_cvt_pk_bf16_f32 v16, v112, v113
    v_cvt_pk_bf16_f32 v17, v114, v115
    buffer_store_dwordx2 v[10:11], v6, s[48:51], 0 offen offset:0
    buffer_store_dwordx2 v[12:13], v6, s[48:51], 0 offen offset:16
    buffer_store_dwordx2 v[14:15], v6, s[48:51], 0 offen offset:32
    buffer_store_dwordx2 v[16:17], v6, s[48:51], 0 offen offset:48
    s_nop 1
    ds_read_b128 v[204:207], v5 offset:1152
    ds_read_b128 v[208:211], v5 offset:1184
    ds_read_b128 v[212:215], v5 offset:1216
    ds_read_b128 v[216:219], v5 offset:1248
    s_waitcnt lgkmcnt(0)
    v_mul_f32 v8, v201, v204
    v_fma_f32 v116, v200, v116, v8
    v_mul_f32 v8, s64, v116
    v_exp_f32 v8, v8
    v_add_f32 v9, 1.0, v116
    v_cmp_lt_f32 vcc, 0, v116
    s_nop 1
    v_cndmask_b32 v8, v8, v9, vcc
    v_add_f32 v116, s65, v8
    v_mul_f32 v8, v201, v205
    v_fma_f32 v117, v200, v117, v8
    v_mul_f32 v8, s64, v117
    v_exp_f32 v8, v8
    v_add_f32 v9, 1.0, v117
    v_cmp_lt_f32 vcc, 0, v117
    s_nop 1
    v_cndmask_b32 v8, v8, v9, vcc
    v_add_f32 v117, s65, v8
    v_mul_f32 v8, v201, v206
    v_fma_f32 v118, v200, v118, v8
    v_mul_f32 v8, s64, v118
    v_exp_f32 v8, v8
    v_add_f32 v9, 1.0, v118
    v_cmp_lt_f32 vcc, 0, v118
    s_nop 1
    v_cndmask_b32 v8, v8, v9, vcc
    v_add_f32 v118, s65, v8
    v_mul_f32 v8, v201, v207
    v_fma_f32 v119, v200, v119, v8
    v_mul_f32 v8, s64, v119
    v_exp_f32 v8, v8
    v_add_f32 v9, 1.0, v119
    v_cmp_lt_f32 vcc, 0, v119
    s_nop 1
    v_cndmask_b32 v8, v8, v9, vcc
    v_add_f32 v119, s65, v8
    v_mul_f32 v8, v201, v208
    v_fma_f32 v120, v200, v120, v8
    v_mul_f32 v8, s64, v120
    v_exp_f32 v8, v8
    v_add_f32 v9, 1.0, v120
    v_cmp_lt_f32 vcc, 0, v120
    s_nop 1
    v_cndmask_b32 v8, v8, v9, vcc
    v_add_f32 v120, s65, v8
    v_mul_f32 v8, v201, v209
    v_fma_f32 v121, v200, v121, v8
    v_mul_f32 v8, s64, v121
    v_exp_f32 v8, v8
    v_add_f32 v9, 1.0, v121
    v_cmp_lt_f32 vcc, 0, v121
    s_nop 1
    v_cndmask_b32 v8, v8, v9, vcc
    v_add_f32 v121, s65, v8
    v_mul_f32 v8, v201, v210
    v_fma_f32 v122, v200, v122, v8
    v_mul_f32 v8, s64, v122
    v_exp_f32 v8, v8
    v_add_f32 v9, 1.0, v122
    v_cmp_lt_f32 vcc, 0, v122
    s_nop 1
    v_cndmask_b32 v8, v8, v9, vcc
    v_add_f32 v122, s65, v8
    v_mul_f32 v8, v201, v211
    v_fma_f32 v123, v200, v123, v8
    v_mul_f32 v8, s64, v123
    v_exp_f32 v8, v8
    v_add_f32 v9, 1.0, v123
    v_cmp_lt_f32 vcc, 0, v123
    s_nop 1
    v_cndmask_b32 v8, v8, v9, vcc
    v_add_f32 v123, s65, v8
    v_mul_f32 v8, v201, v212
    v_fma_f32 v124, v200, v124, v8
    v_mul_f32 v8, s64, v124
    v_exp_f32 v8, v8
    v_add_f32 v9, 1.0, v124
    v_cmp_lt_f32 vcc, 0, v124
    s_nop 1
    v_cndmask_b32 v8, v8, v9, vcc
    v_add_f32 v124, s65, v8
    v_mul_f32 v8, v201, v213
    v_fma_f32 v125, v200, v125, v8
    v_mul_f32 v8, s64, v125
    v_exp_f32 v8, v8
    v_add_f32 v9, 1.0, v125
    v_cmp_lt_f32 vcc, 0, v125
    s_nop 1
    v_cndmask_b32 v8, v8, v9, vcc
    v_add_f32 v125, s65, v8
    v_mul_f32 v8, v201, v214
    v_fma_f32 v126, v200, v126, v8
    v_mul_f32 v8, s64, v126
    v_exp_f32 v8, v8
    v_add_f32 v9, 1.0, v126
    v_cmp_lt_f32 vcc, 0, v126
    s_nop 1
    v_cndmask_b32 v8, v8, v9, vcc
    v_add_f32 v126, s65, v8
    v_mul_f32 v8, v201, v215
    v_fma_f32 v127, v200, v127, v8
    v_mul_f32 v8, s64, v127
    v_exp_f32 v8, v8
    v_add_f32 v9, 1.0, v127
    v_cmp_lt_f32 vcc, 0, v127
    s_nop 1
    v_cndmask_b32 v8, v8, v9, vcc
    v_add_f32 v127, s65, v8
    v_mul_f32 v8, v201, v216
    v_fma_f32 v128, v200, v128, v8
    v_mul_f32 v8, s64, v128
    v_exp_f32 v8, v8
    v_add_f32 v9, 1.0, v128
    v_cmp_lt_f32 vcc, 0, v128
    s_nop 1
    v_cndmask_b32 v8, v8, v9, vcc
    v_add_f32 v128, s65, v8
    v_mul_f32 v8, v201, v217
    v_fma_f32 v129, v200, v129, v8
    v_mul_f32 v8, s64, v129
    v_exp_f32 v8, v8
    v_add_f32 v9, 1.0, v129
    v_cmp_lt_f32 vcc, 0, v129
    s_nop 1
    v_cndmask_b32 v8, v8, v9, vcc
    v_add_f32 v129, s65, v8
    v_mul_f32 v8, v201, v218
    v_fma_f32 v130, v200, v130, v8
    v_mul_f32 v8, s64, v130
    v_exp_f32 v8, v8
    v_add_f32 v9, 1.0, v130
    v_cmp_lt_f32 vcc, 0, v130
    s_nop 1
    v_cndmask_b32 v8, v8, v9, vcc
    v_add_f32 v130, s65, v8
    v_mul_f32 v8, v201, v219
    v_fma_f32 v131, v200, v131, v8
    v_mul_f32 v8, s64, v131
    v_exp_f32 v8, v8
    v_add_f32 v9, 1.0, v131
    v_cmp_lt_f32 vcc, 0, v131
    s_nop 1
    v_cndmask_b32 v8, v8, v9, vcc
    v_add_f32 v131, s65, v8
    v_cvt_pk_bf16_f32 v10, v116, v117
    v_cvt_pk_bf16_f32 v11, v118, v119
    v_cvt_pk_bf16_f32 v12, v120, v121
    v_cvt_pk_bf16_f32 v13, v122, v123
    v_cvt_pk_bf16_f32 v14, v124, v125
    v_cvt_pk_bf16_f32 v15, v126, v127
    v_cvt_pk_bf16_f32 v16, v128, v129
    v_cvt_pk_bf16_f32 v17, v130, v131
    buffer_store_dwordx2 v[10:11], v6, s[48:51], 0 offen offset:64
    buffer_store_dwordx2 v[12:13], v6, s[48:51], 0 offen offset:80
    buffer_store_dwordx2 v[14:15], v6, s[48:51], 0 offen offset:96
    buffer_store_dwordx2 v[16:17], v6, s[48:51], 0 offen offset:112
    s_nop 1
    ds_read_b128 v[204:207], v5 offset:1280
    ds_read_b128 v[208:211], v5 offset:1312
    ds_read_b128 v[212:215], v5 offset:1344
    ds_read_b128 v[216:219], v5 offset:1376
    s_waitcnt lgkmcnt(0)
    v_mul_f32 v8, v201, v204
    v_fma_f32 v132, v200, v132, v8
    v_mul_f32 v8, s64, v132
    v_exp_f32 v8, v8
    v_add_f32 v9, 1.0, v132
    v_cmp_lt_f32 vcc, 0, v132
    s_nop 1
    v_cndmask_b32 v8, v8, v9, vcc
    v_add_f32 v132, s65, v8
    v_mul_f32 v8, v201, v205
    v_fma_f32 v133, v200, v133, v8
    v_mul_f32 v8, s64, v133
    v_exp_f32 v8, v8
    v_add_f32 v9, 1.0, v133
    v_cmp_lt_f32 vcc, 0, v133
    s_nop 1
    v_cndmask_b32 v8, v8, v9, vcc
    v_add_f32 v133, s65, v8
    v_mul_f32 v8, v201, v206
    v_fma_f32 v134, v200, v134, v8
    v_mul_f32 v8, s64, v134
    v_exp_f32 v8, v8
    v_add_f32 v9, 1.0, v134
    v_cmp_lt_f32 vcc, 0, v134
    s_nop 1
    v_cndmask_b32 v8, v8, v9, vcc
    v_add_f32 v134, s65, v8
    v_mul_f32 v8, v201, v207
    v_fma_f32 v135, v200, v135, v8
    v_mul_f32 v8, s64, v135
    v_exp_f32 v8, v8
    v_add_f32 v9, 1.0, v135
    v_cmp_lt_f32 vcc, 0, v135
    s_nop 1
    v_cndmask_b32 v8, v8, v9, vcc
    v_add_f32 v135, s65, v8
    v_mul_f32 v8, v201, v208
    v_fma_f32 v136, v200, v136, v8
    v_mul_f32 v8, s64, v136
    v_exp_f32 v8, v8
    v_add_f32 v9, 1.0, v136
    v_cmp_lt_f32 vcc, 0, v136
    s_nop 1
    v_cndmask_b32 v8, v8, v9, vcc
    v_add_f32 v136, s65, v8
    v_mul_f32 v8, v201, v209
    v_fma_f32 v137, v200, v137, v8
    v_mul_f32 v8, s64, v137
    v_exp_f32 v8, v8
    v_add_f32 v9, 1.0, v137
    v_cmp_lt_f32 vcc, 0, v137
    s_nop 1
    v_cndmask_b32 v8, v8, v9, vcc
    v_add_f32 v137, s65, v8
    v_mul_f32 v8, v201, v210
    v_fma_f32 v138, v200, v138, v8
    v_mul_f32 v8, s64, v138
    v_exp_f32 v8, v8
    v_add_f32 v9, 1.0, v138
    v_cmp_lt_f32 vcc, 0, v138
    s_nop 1
    v_cndmask_b32 v8, v8, v9, vcc
    v_add_f32 v138, s65, v8
    v_mul_f32 v8, v201, v211
    v_fma_f32 v139, v200, v139, v8
    v_mul_f32 v8, s64, v139
    v_exp_f32 v8, v8
    v_add_f32 v9, 1.0, v139
    v_cmp_lt_f32 vcc, 0, v139
    s_nop 1
    v_cndmask_b32 v8, v8, v9, vcc
    v_add_f32 v139, s65, v8
    v_mul_f32 v8, v201, v212
    v_fma_f32 v140, v200, v140, v8
    v_mul_f32 v8, s64, v140
    v_exp_f32 v8, v8
    v_add_f32 v9, 1.0, v140
    v_cmp_lt_f32 vcc, 0, v140
    s_nop 1
    v_cndmask_b32 v8, v8, v9, vcc
    v_add_f32 v140, s65, v8
    v_mul_f32 v8, v201, v213
    v_fma_f32 v141, v200, v141, v8
    v_mul_f32 v8, s64, v141
    v_exp_f32 v8, v8
    v_add_f32 v9, 1.0, v141
    v_cmp_lt_f32 vcc, 0, v141
    s_nop 1
    v_cndmask_b32 v8, v8, v9, vcc
    v_add_f32 v141, s65, v8
    v_mul_f32 v8, v201, v214
    v_fma_f32 v142, v200, v142, v8
    v_mul_f32 v8, s64, v142
    v_exp_f32 v8, v8
    v_add_f32 v9, 1.0, v142
    v_cmp_lt_f32 vcc, 0, v142
    s_nop 1
    v_cndmask_b32 v8, v8, v9, vcc
    v_add_f32 v142, s65, v8
    v_mul_f32 v8, v201, v215
    v_fma_f32 v143, v200, v143, v8
    v_mul_f32 v8, s64, v143
    v_exp_f32 v8, v8
    v_add_f32 v9, 1.0, v143
    v_cmp_lt_f32 vcc, 0, v143
    s_nop 1
    v_cndmask_b32 v8, v8, v9, vcc
    v_add_f32 v143, s65, v8
    v_mul_f32 v8, v201, v216
    v_fma_f32 v144, v200, v144, v8
    v_mul_f32 v8, s64, v144
    v_exp_f32 v8, v8
    v_add_f32 v9, 1.0, v144
    v_cmp_lt_f32 vcc, 0, v144
    s_nop 1
    v_cndmask_b32 v8, v8, v9, vcc
    v_add_f32 v144, s65, v8
    v_mul_f32 v8, v201, v217
    v_fma_f32 v145, v200, v145, v8
    v_mul_f32 v8, s64, v145
    v_exp_f32 v8, v8
    v_add_f32 v9, 1.0, v145
    v_cmp_lt_f32 vcc, 0, v145
    s_nop 1
    v_cndmask_b32 v8, v8, v9, vcc
    v_add_f32 v145, s65, v8
    v_mul_f32 v8, v201, v218
    v_fma_f32 v146, v200, v146, v8
    v_mul_f32 v8, s64, v146
    v_exp_f32 v8, v8
    v_add_f32 v9, 1.0, v146
    v_cmp_lt_f32 vcc, 0, v146
    s_nop 1
    v_cndmask_b32 v8, v8, v9, vcc
    v_add_f32 v146, s65, v8
    v_mul_f32 v8, v201, v219
    v_fma_f32 v147, v200, v147, v8
    v_mul_f32 v8, s64, v147
    v_exp_f32 v8, v8
    v_add_f32 v9, 1.0, v147
    v_cmp_lt_f32 vcc, 0, v147
    s_nop 1
    v_cndmask_b32 v8, v8, v9, vcc
    v_add_f32 v147, s65, v8
    v_cvt_pk_bf16_f32 v10, v132, v133
    v_cvt_pk_bf16_f32 v11, v134, v135
    v_cvt_pk_bf16_f32 v12, v136, v137
    v_cvt_pk_bf16_f32 v13, v138, v139
    v_cvt_pk_bf16_f32 v14, v140, v141
    v_cvt_pk_bf16_f32 v15, v142, v143
    v_cvt_pk_bf16_f32 v16, v144, v145
    v_cvt_pk_bf16_f32 v17, v146, v147
    buffer_store_dwordx2 v[10:11], v6, s[48:51], 0 offen offset:128
    buffer_store_dwordx2 v[12:13], v6, s[48:51], 0 offen offset:144
    buffer_store_dwordx2 v[14:15], v6, s[48:51], 0 offen offset:160
    buffer_store_dwordx2 v[16:17], v6, s[48:51], 0 offen offset:176
    s_nop 1
    ds_read_b128 v[204:207], v5 offset:1408
    ds_read_b128 v[208:211], v5 offset:1440
    ds_read_b128 v[212:215], v5 offset:1472
    ds_read_b128 v[216:219], v5 offset:1504
    s_waitcnt lgkmcnt(0)
    v_mul_f32 v8, v201, v204
    v_fma_f32 v148, v200, v148, v8
    v_mul_f32 v8, s64, v148
    v_exp_f32 v8, v8
    v_add_f32 v9, 1.0, v148
    v_cmp_lt_f32 vcc, 0, v148
    s_nop 1
    v_cndmask_b32 v8, v8, v9, vcc
    v_add_f32 v148, s65, v8
    v_mul_f32 v8, v201, v205
    v_fma_f32 v149, v200, v149, v8
    v_mul_f32 v8, s64, v149
    v_exp_f32 v8, v8
    v_add_f32 v9, 1.0, v149
    v_cmp_lt_f32 vcc, 0, v149
    s_nop 1
    v_cndmask_b32 v8, v8, v9, vcc
    v_add_f32 v149, s65, v8
    v_mul_f32 v8, v201, v206
    v_fma_f32 v150, v200, v150, v8
    v_mul_f32 v8, s64, v150
    v_exp_f32 v8, v8
    v_add_f32 v9, 1.0, v150
    v_cmp_lt_f32 vcc, 0, v150
    s_nop 1
    v_cndmask_b32 v8, v8, v9, vcc
    v_add_f32 v150, s65, v8
    v_mul_f32 v8, v201, v207
    v_fma_f32 v151, v200, v151, v8
    v_mul_f32 v8, s64, v151
    v_exp_f32 v8, v8
    v_add_f32 v9, 1.0, v151
    v_cmp_lt_f32 vcc, 0, v151
    s_nop 1
    v_cndmask_b32 v8, v8, v9, vcc
    v_add_f32 v151, s65, v8
    v_mul_f32 v8, v201, v208
    v_fma_f32 v152, v200, v152, v8
    v_mul_f32 v8, s64, v152
    v_exp_f32 v8, v8
    v_add_f32 v9, 1.0, v152
    v_cmp_lt_f32 vcc, 0, v152
    s_nop 1
    v_cndmask_b32 v8, v8, v9, vcc
    v_add_f32 v152, s65, v8
    v_mul_f32 v8, v201, v209
    v_fma_f32 v153, v200, v153, v8
    v_mul_f32 v8, s64, v153
    v_exp_f32 v8, v8
    v_add_f32 v9, 1.0, v153
    v_cmp_lt_f32 vcc, 0, v153
    s_nop 1
    v_cndmask_b32 v8, v8, v9, vcc
    v_add_f32 v153, s65, v8
    v_mul_f32 v8, v201, v210
    v_fma_f32 v154, v200, v154, v8
    v_mul_f32 v8, s64, v154
    v_exp_f32 v8, v8
    v_add_f32 v9, 1.0, v154
    v_cmp_lt_f32 vcc, 0, v154
    s_nop 1
    v_cndmask_b32 v8, v8, v9, vcc
    v_add_f32 v154, s65, v8
    v_mul_f32 v8, v201, v211
    v_fma_f32 v155, v200, v155, v8
    v_mul_f32 v8, s64, v155
    v_exp_f32 v8, v8
    v_add_f32 v9, 1.0, v155
    v_cmp_lt_f32 vcc, 0, v155
    s_nop 1
    v_cndmask_b32 v8, v8, v9, vcc
    v_add_f32 v155, s65, v8
    v_mul_f32 v8, v201, v212
    v_fma_f32 v156, v200, v156, v8
    v_mul_f32 v8, s64, v156
    v_exp_f32 v8, v8
    v_add_f32 v9, 1.0, v156
    v_cmp_lt_f32 vcc, 0, v156
    s_nop 1
    v_cndmask_b32 v8, v8, v9, vcc
    v_add_f32 v156, s65, v8
    v_mul_f32 v8, v201, v213
    v_fma_f32 v157, v200, v157, v8
    v_mul_f32 v8, s64, v157
    v_exp_f32 v8, v8
    v_add_f32 v9, 1.0, v157
    v_cmp_lt_f32 vcc, 0, v157
    s_nop 1
    v_cndmask_b32 v8, v8, v9, vcc
    v_add_f32 v157, s65, v8
    v_mul_f32 v8, v201, v214
    v_fma_f32 v158, v200, v158, v8
    v_mul_f32 v8, s64, v158
    v_exp_f32 v8, v8
    v_add_f32 v9, 1.0, v158
    v_cmp_lt_f32 vcc, 0, v158
    s_nop 1
    v_cndmask_b32 v8, v8, v9, vcc
    v_add_f32 v158, s65, v8
    v_mul_f32 v8, v201, v215
    v_fma_f32 v159, v200, v159, v8
    v_mul_f32 v8, s64, v159
    v_exp_f32 v8, v8
    v_add_f32 v9, 1.0, v159
    v_cmp_lt_f32 vcc, 0, v159
    s_nop 1
    v_cndmask_b32 v8, v8, v9, vcc
    v_add_f32 v159, s65, v8
    v_mul_f32 v8, v201, v216
    v_fma_f32 v160, v200, v160, v8
    v_mul_f32 v8, s64, v160
    v_exp_f32 v8, v8
    v_add_f32 v9, 1.0, v160
    v_cmp_lt_f32 vcc, 0, v160
    s_nop 1
    v_cndmask_b32 v8, v8, v9, vcc
    v_add_f32 v160, s65, v8
    v_mul_f32 v8, v201, v217
    v_fma_f32 v161, v200, v161, v8
    v_mul_f32 v8, s64, v161
    v_exp_f32 v8, v8
    v_add_f32 v9, 1.0, v161
    v_cmp_lt_f32 vcc, 0, v161
    s_nop 1
    v_cndmask_b32 v8, v8, v9, vcc
    v_add_f32 v161, s65, v8
    v_mul_f32 v8, v201, v218
    v_fma_f32 v162, v200, v162, v8
    v_mul_f32 v8, s64, v162
    v_exp_f32 v8, v8
    v_add_f32 v9, 1.0, v162
    v_cmp_lt_f32 vcc, 0, v162
    s_nop 1
    v_cndmask_b32 v8, v8, v9, vcc
    v_add_f32 v162, s65, v8
    v_mul_f32 v8, v201, v219
    v_fma_f32 v163, v200, v163, v8
    v_mul_f32 v8, s64, v163
    v_exp_f32 v8, v8
    v_add_f32 v9, 1.0, v163
    v_cmp_lt_f32 vcc, 0, v163
    s_nop 1
    v_cndmask_b32 v8, v8, v9, vcc
    v_add_f32 v163, s65, v8
    v_cvt_pk_bf16_f32 v10, v148, v149
    v_cvt_pk_bf16_f32 v11, v150, v151
    v_cvt_pk_bf16_f32 v12, v152, v153
    v_cvt_pk_bf16_f32 v13, v154, v155
    v_cvt_pk_bf16_f32 v14, v156, v157
    v_cvt_pk_bf16_f32 v15, v158, v159
    v_cvt_pk_bf16_f32 v16, v160, v161
    v_cvt_pk_bf16_f32 v17, v162, v163
    buffer_store_dwordx2 v[10:11], v6, s[48:51], 0 offen offset:192
    buffer_store_dwordx2 v[12:13], v6, s[48:51], 0 offen offset:208
    buffer_store_dwordx2 v[14:15], v6, s[48:51], 0 offen offset:224
    buffer_store_dwordx2 v[16:17], v6, s[48:51], 0 offen offset:240
    s_nop 1
    ds_read_b128 v[204:207], v5 offset:1536
    ds_read_b128 v[208:211], v5 offset:1568
    ds_read_b128 v[212:215], v5 offset:1600
    ds_read_b128 v[216:219], v5 offset:1632
    s_waitcnt lgkmcnt(0)
    v_mul_f32 v8, v201, v204
    v_fma_f32 v164, v200, v164, v8
    v_mul_f32 v8, s64, v164
    v_exp_f32 v8, v8
    v_add_f32 v9, 1.0, v164
    v_cmp_lt_f32 vcc, 0, v164
    s_nop 1
    v_cndmask_b32 v8, v8, v9, vcc
    v_add_f32 v164, s65, v8
    v_mul_f32 v8, v201, v205
    v_fma_f32 v165, v200, v165, v8
    v_mul_f32 v8, s64, v165
    v_exp_f32 v8, v8
    v_add_f32 v9, 1.0, v165
    v_cmp_lt_f32 vcc, 0, v165
    s_nop 1
    v_cndmask_b32 v8, v8, v9, vcc
    v_add_f32 v165, s65, v8
    v_mul_f32 v8, v201, v206
    v_fma_f32 v166, v200, v166, v8
    v_mul_f32 v8, s64, v166
    v_exp_f32 v8, v8
    v_add_f32 v9, 1.0, v166
    v_cmp_lt_f32 vcc, 0, v166
    s_nop 1
    v_cndmask_b32 v8, v8, v9, vcc
    v_add_f32 v166, s65, v8
    v_mul_f32 v8, v201, v207
    v_fma_f32 v167, v200, v167, v8
    v_mul_f32 v8, s64, v167
    v_exp_f32 v8, v8
    v_add_f32 v9, 1.0, v167
    v_cmp_lt_f32 vcc, 0, v167
    s_nop 1
    v_cndmask_b32 v8, v8, v9, vcc
    v_add_f32 v167, s65, v8
    v_mul_f32 v8, v201, v208
    v_fma_f32 v168, v200, v168, v8
    v_mul_f32 v8, s64, v168
    v_exp_f32 v8, v8
    v_add_f32 v9, 1.0, v168
    v_cmp_lt_f32 vcc, 0, v168
    s_nop 1
    v_cndmask_b32 v8, v8, v9, vcc
    v_add_f32 v168, s65, v8
    v_mul_f32 v8, v201, v209
    v_fma_f32 v169, v200, v169, v8
    v_mul_f32 v8, s64, v169
    v_exp_f32 v8, v8
    v_add_f32 v9, 1.0, v169
    v_cmp_lt_f32 vcc, 0, v169
    s_nop 1
    v_cndmask_b32 v8, v8, v9, vcc
    v_add_f32 v169, s65, v8
    v_mul_f32 v8, v201, v210
    v_fma_f32 v170, v200, v170, v8
    v_mul_f32 v8, s64, v170
    v_exp_f32 v8, v8
    v_add_f32 v9, 1.0, v170
    v_cmp_lt_f32 vcc, 0, v170
    s_nop 1
    v_cndmask_b32 v8, v8, v9, vcc
    v_add_f32 v170, s65, v8
    v_mul_f32 v8, v201, v211
    v_fma_f32 v171, v200, v171, v8
    v_mul_f32 v8, s64, v171
    v_exp_f32 v8, v8
    v_add_f32 v9, 1.0, v171
    v_cmp_lt_f32 vcc, 0, v171
    s_nop 1
    v_cndmask_b32 v8, v8, v9, vcc
    v_add_f32 v171, s65, v8
    v_mul_f32 v8, v201, v212
    v_fma_f32 v172, v200, v172, v8
    v_mul_f32 v8, s64, v172
    v_exp_f32 v8, v8
    v_add_f32 v9, 1.0, v172
    v_cmp_lt_f32 vcc, 0, v172
    s_nop 1
    v_cndmask_b32 v8, v8, v9, vcc
    v_add_f32 v172, s65, v8
    v_mul_f32 v8, v201, v213
    v_fma_f32 v173, v200, v173, v8
    v_mul_f32 v8, s64, v173
    v_exp_f32 v8, v8
    v_add_f32 v9, 1.0, v173
    v_cmp_lt_f32 vcc, 0, v173
    s_nop 1
    v_cndmask_b32 v8, v8, v9, vcc
    v_add_f32 v173, s65, v8
    v_mul_f32 v8, v201, v214
    v_fma_f32 v174, v200, v174, v8
    v_mul_f32 v8, s64, v174
    v_exp_f32 v8, v8
    v_add_f32 v9, 1.0, v174
    v_cmp_lt_f32 vcc, 0, v174
    s_nop 1
    v_cndmask_b32 v8, v8, v9, vcc
    v_add_f32 v174, s65, v8
    v_mul_f32 v8, v201, v215
    v_fma_f32 v175, v200, v175, v8
    v_mul_f32 v8, s64, v175
    v_exp_f32 v8, v8
    v_add_f32 v9, 1.0, v175
    v_cmp_lt_f32 vcc, 0, v175
    s_nop 1
    v_cndmask_b32 v8, v8, v9, vcc
    v_add_f32 v175, s65, v8
    v_mul_f32 v8, v201, v216
    v_fma_f32 v176, v200, v176, v8
    v_mul_f32 v8, s64, v176
    v_exp_f32 v8, v8
    v_add_f32 v9, 1.0, v176
    v_cmp_lt_f32 vcc, 0, v176
    s_nop 1
    v_cndmask_b32 v8, v8, v9, vcc
    v_add_f32 v176, s65, v8
    v_mul_f32 v8, v201, v217
    v_fma_f32 v177, v200, v177, v8
    v_mul_f32 v8, s64, v177
    v_exp_f32 v8, v8
    v_add_f32 v9, 1.0, v177
    v_cmp_lt_f32 vcc, 0, v177
    s_nop 1
    v_cndmask_b32 v8, v8, v9, vcc
    v_add_f32 v177, s65, v8
    v_mul_f32 v8, v201, v218
    v_fma_f32 v178, v200, v178, v8
    v_mul_f32 v8, s64, v178
    v_exp_f32 v8, v8
    v_add_f32 v9, 1.0, v178
    v_cmp_lt_f32 vcc, 0, v178
    s_nop 1
    v_cndmask_b32 v8, v8, v9, vcc
    v_add_f32 v178, s65, v8
    v_mul_f32 v8, v201, v219
    v_fma_f32 v179, v200, v179, v8
    v_mul_f32 v8, s64, v179
    v_exp_f32 v8, v8
    v_add_f32 v9, 1.0, v179
    v_cmp_lt_f32 vcc, 0, v179
    s_nop 1
    v_cndmask_b32 v8, v8, v9, vcc
    v_add_f32 v179, s65, v8
    v_cvt_pk_bf16_f32 v10, v164, v165
    v_cvt_pk_bf16_f32 v11, v166, v167
    v_cvt_pk_bf16_f32 v12, v168, v169
    v_cvt_pk_bf16_f32 v13, v170, v171
    v_cvt_pk_bf16_f32 v14, v172, v173
    v_cvt_pk_bf16_f32 v15, v174, v175
    v_cvt_pk_bf16_f32 v16, v176, v177
    v_cvt_pk_bf16_f32 v17, v178, v179
    buffer_store_dwordx2 v[10:11], v6, s[48:51], 0 offen offset:256
    buffer_store_dwordx2 v[12:13], v6, s[48:51], 0 offen offset:272
    buffer_store_dwordx2 v[14:15], v6, s[48:51], 0 offen offset:288
    buffer_store_dwordx2 v[16:17], v6, s[48:51], 0 offen offset:304
    s_nop 1
    s_waitcnt vmcnt(0)
K1_end:
    s_endpgm
.globl k3_l0_kernel
.p2align 8
.type k3_l0_kernel,@function
k3_l0_kernel:
    s_mov_b32 s101, 0
    s_branch K3_body
.globl k3_l1_kernel
.p2align 8
.type k3_l1_kernel,@function
k3_l1_kernel:
    s_mov_b32 s101, 1
    s_branch K3_body
.p2align 8
K3_body:
    s_load_dwordx16 s[4:19], s[0:1], 0
    s_load_dwordx4 s[20:23], s[0:1], 64
    s_load_dwordx2 s[24:25], s[0:1], 80
    s_cmp_ge_u32 s2, 216
    s_cbranch_scc1 K3_end
    s_mov_b32 s99, 0x3c4ccccd
    s_mov_b32 s100, 0x42a00000
    v_lshrrev_b32 v1, 6, v0
    s_nop 0
    v_readfirstlane_b32 s26, v1
    s_waitcnt lgkmcnt(0)
    s_mul_i32 s42, s101, 6291456
    s_add_u32 s40, s24, s42
    s_addc_u32 s41, s25, 0
    s_mov_b32 s28, s40
    s_mov_b32 s29, s41
    s_mov_b32 s30, 2621440
    s_mov_b32 s31, 0x00020000
    s_mov_b32 s32, s12
    s_mov_b32 s33, s13
    s_mov_b32 s34, 2211840
    s_mov_b32 s35, 0x00020000
    s_mul_i32 s42, s101, 262144
    s_add_u32 s42, s42, 21626880
    s_add_u32 s36, s24, s42
    s_addc_u32 s37, s25, 0
    s_mov_b32 s38, 131072
    s_mov_b32 s39, 0x00020000
    s_add_u32 s44, s24, 21250048
    s_addc_u32 s45, s25, 0
    s_mov_b32 s46, 6912
    s_mov_b32 s47, 0x00020000
    s_add_u32 s48, s24, 12582912
    s_addc_u32 s49, s25, 0
    s_mov_b32 s50, 7077888
    s_mov_b32 s51, 0x00020000
    s_mov_b32 s68, s14
    s_mov_b32 s69, s15
    s_mov_b32 s70, 3456
    s_mov_b32 s71, 0x00020000
    s_and_b32 s52, s2, 7
    s_lshr_b32 s53, s2, 3
    s_lshl_b32 s54, s52, 8
    v_add_u32 v1, s54, v0
    v_lshlrev_b32 v1, 6, v1
    buffer_load_dwordx4 v[180:183], v1, s[36:39], 0 offen offset:0
    buffer_load_dwordx4 v[184:187], v1, s[36:39], 0 offen offset:16
    buffer_load_dwordx4 v[188:191], v1, s[36:39], 0 offen offset:32
    buffer_load_dwordx4 v[192:195], v1, s[36:39], 0 offen offset:48
    s_lshl_b32 s55, s53, 8
    v_lshlrev_b32 v2, 4, v0
    v_cmp_gt_u32 vcc, 16, v0
    s_and_saveexec_b64 s[56:57], vcc
    buffer_load_dwordx4 v[196:199], v2, s[44:47], s55 offen
    s_mov_b64 exec, s[56:57]
    s_lshl_b32 s55, s53, 7
    v_cmp_gt_u32 vcc, 8, v0
    s_and_saveexec_b64 s[56:57], vcc
    buffer_load_dwordx4 v[224:227], v2, s[68:71], s55 offen
    s_mov_b64 exec, s[56:57]
    v_and_b32 v1, 63, v0
    v_lshrrev_b32 v2, 3, v1
    v_and_b32 v3, 7, v1
    s_lshl_b32 s58, s26, 6
    v_add_u32 v4, s58, v2
    v_add_u32 v4, 0, v4
    v_lshrrev_b32 v5, 1, v4
    v_and_b32 v5, 7, v5
    v_xor_b32 v5, v5, v3
    v_lshlrev_b32 v5, 4, v5
    v_mul_u32_u24 v4, 1280, v4
    v_add_u32 v10, v4, v5
    v_add_u32 v4, s58, v2
    v_add_u32 v4, 8, v4
    v_lshrrev_b32 v5, 1, v4
    v_and_b32 v5, 7, v5
    v_xor_b32 v5, v5, v3
    v_lshlrev_b32 v5, 4, v5
    v_mul_u32_u24 v4, 1280, v4
    v_add_u32 v11, v4, v5
    v_add_u32 v4, s58, v2
    v_add_u32 v4, 16, v4
    v_lshrrev_b32 v5, 1, v4
    v_and_b32 v5, 7, v5
    v_xor_b32 v5, v5, v3
    v_lshlrev_b32 v5, 4, v5
    v_mul_u32_u24 v4, 1280, v4
    v_add_u32 v12, v4, v5
    v_add_u32 v4, s58, v2
    v_add_u32 v4, 24, v4
    v_lshrrev_b32 v5, 1, v4
    v_and_b32 v5, 7, v5
    v_xor_b32 v5, v5, v3
    v_lshlrev_b32 v5, 4, v5
    v_mul_u32_u24 v4, 1280, v4
    v_add_u32 v13, v4, v5
    v_add_u32 v4, s58, v2
    v_add_u32 v4, 32, v4
    v_lshrrev_b32 v5, 1, v4
    v_and_b32 v5, 7, v5
    v_xor_b32 v5, v5, v3
    v_lshlrev_b32 v5, 4, v5
    v_mul_u32_u24 v4, 1280, v4
    v_add_u32 v14, v4, v5
    v_add_u32 v4, s58, v2
    v_add_u32 v4, 40, v4
    v_lshrrev_b32 v5, 1, v4
    v_and_b32 v5, 7, v5
    v_xor_b32 v5, v5, v3
    v_lshlrev_b32 v5, 4, v5
    v_mul_u32_u24 v4, 1280, v4
    v_add_u32 v15, v4, v5
    v_add_u32 v4, s58, v2
    v_add_u32 v4, 48, v4
    v_lshrrev_b32 v5, 1, v4
    v_and_b32 v5, 7, v5
    v_xor_b32 v5, v5, v3
    v_lshlrev_b32 v5, 4, v5
    v_mul_u32_u24 v4, 1280, v4
    v_add_u32 v16, v4, v5
    v_add_u32 v4, s58, v2
    v_add_u32 v4, 56, v4
    v_lshrrev_b32 v5, 1, v4
    v_and_b32 v5, 7, v5
    v_xor_b32 v5, v5, v3
    v_lshlrev_b32 v5, 4, v5
    v_mul_u32_u24 v4, 1280, v4
    v_add_u32 v17, v4, v5
    s_lshl_b32 s58, s26, 4
    v_add_u32 v4, s58, v2
    v_add_u32 v4, 0, v4
    v_lshrrev_b32 v5, 1, v4
    v_and_b32 v5, 1, v5
    v_lshlrev_b32 v5, 2, v5
    v_xor_b32 v5, v5, v3
    v_lshlrev_b32 v5, 4, v5
    v_mul_u32_u24 v4, 3456, v4
    v_add_u32 v18, v4, v5
    v_add_u32 v4, s58, v2
    v_add_u32 v4, 8, v4
    v_lshrrev_b32 v5, 1, v4
    v_and_b32 v5, 1, v5
    v_lshlrev_b32 v5, 2, v5
    v_xor_b32 v5, v5, v3
    v_lshlrev_b32 v5, 4, v5
    v_mul_u32_u24 v4, 3456, v4
    v_add_u32 v19, v4, v5
    s_mul_i32 s60, s52, 327680
    s_lshl_b32 s61, s53, 7
    s_lshl_b32 s62, s26, 13
    s_lshl_b32 s63, s26, 11
    v_lshrrev_b32 v3, 5, v1
    v_and_b32 v2, 31, v1
    s_lshl_b32 s58, s26, 6
    v_add_u32 v2, s58, v2
    v_add_u32 v2, 0, v2
    v_lshrrev_b32 v4, 1, v2
    v_and_b32 v4, 7, v4
    v_add_u32 v5, 0, v3
    v_xor_b32 v5, v5, v4
    v_lshlrev_b32 v5, 4, v5
    v_lshlrev_b32 v6, 7, v2
    v_add_u32 v20, v5, v6
    v_add_u32 v32, 0x8000, v20
    v_add_u32 v5, 2, v3
    v_xor_b32 v5, v5, v4
    v_lshlrev_b32 v5, 4, v5
    v_lshlrev_b32 v6, 7, v2
    v_add_u32 v21, v5, v6
    v_add_u32 v33, 0x8000, v21
    v_add_u32 v5, 4, v3
    v_xor_b32 v5, v5, v4
    v_lshlrev_b32 v5, 4, v5
    v_lshlrev_b32 v6, 7, v2
    v_add_u32 v22, v5, v6
    v_add_u32 v34, 0x8000, v22
    v_add_u32 v5, 6, v3
    v_xor_b32 v5, v5, v4
    v_lshlrev_b32 v5, 4, v5
    v_lshlrev_b32 v6, 7, v2
    v_add_u32 v23, v5, v6
    v_add_u32 v35, 0x8000, v23
    v_and_b32 v2, 31, v1
    s_lshl_b32 s58, s26, 6
    v_add_u32 v2, s58, v2
    v_add_u32 v2, 32, v2
    v_lshrrev_b32 v4, 1, v2
    v_and_b32 v4, 7, v4
    v_add_u32 v5, 0, v3
    v_xor_b32 v5, v5, v4
    v_lshlrev_b32 v5, 4, v5
    v_lshlrev_b32 v6, 7, v2
    v_add_u32 v24, v5, v6
    v_add_u32 v36, 0x8000, v24
    v_add_u32 v5, 2, v3
    v_xor_b32 v5, v5, v4
    v_lshlrev_b32 v5, 4, v5
    v_lshlrev_b32 v6, 7, v2
    v_add_u32 v25, v5, v6
    v_add_u32 v37, 0x8000, v25
    v_add_u32 v5, 4, v3
    v_xor_b32 v5, v5, v4
    v_lshlrev_b32 v5, 4, v5
    v_lshlrev_b32 v6, 7, v2
    v_add_u32 v26, v5, v6
    v_add_u32 v38, 0x8000, v26
    v_add_u32 v5, 6, v3
    v_xor_b32 v5, v5, v4
    v_lshlrev_b32 v5, 4, v5
    v_lshlrev_b32 v6, 7, v2
    v_add_u32 v27, v5, v6
    v_add_u32 v39, 0x8000, v27
    v_and_b32 v4, 15, v1
    v_lshrrev_b32 v5, 2, v4
    v_and_b32 v6, 3, v4
    v_lshlrev_b32 v7, 3, v3
    v_add_u32 v7, v5, v7
    v_lshlrev_b32 v7, 7, v7
    v_lshrrev_b32 v8, 4, v1
    v_and_b32 v8, 1, v8
    v_lshlrev_b32 v8, 5, v8
    v_add_u32 v7, v7, v8
    v_lshlrev_b32 v6, 3, v6
    v_add_u32 v7, v7, v6
    v_add_u32 v7, 102400, v7
    v_lshrrev_b32 v8, 1, v5
    v_and_b32 v8, 1, v8
    v_lshlrev_b32 v8, 6, v8
    v_add_u32 v28, v7, v8
    v_xor_b32 v8, 64, v8
    v_add_u32 v29, v7, v8
    v_mov_b32 v100, 0
    v_mov_b32 v101, 0
    v_mov_b32 v102, 0
    v_mov_b32 v103, 0
    v_mov_b32 v104, 0
    v_mov_b32 v105, 0
    v_mov_b32 v106, 0
    v_mov_b32 v107, 0
    v_mov_b32 v108, 0
    v_mov_b32 v109, 0
    v_mov_b32 v110, 0
    v_mov_b32 v111, 0
    v_mov_b32 v112, 0
    v_mov_b32 v113, 0
    v_mov_b32 v114, 0
    v_mov_b32 v115, 0
    v_mov_b32 v116, 0
    v_mov_b32 v117, 0
    v_mov_b32 v118, 0
    v_mov_b32 v119, 0
    v_mov_b32 v120, 0
    v_mov_b32 v121, 0
    v_mov_b32 v122, 0
    v_mov_b32 v123, 0
    v_mov_b32 v124, 0
    v_mov_b32 v125, 0
    v_mov_b32 v126, 0
    v_mov_b32 v127, 0
    v_mov_b32 v128, 0
    v_mov_b32 v129, 0
    v_mov_b32 v130, 0
    v_mov_b32 v131, 0
    v_mov_b32 v132, 0
    v_mov_b32 v133, 0
    v_mov_b32 v134, 0
    v_mov_b32 v135, 0
    v_mov_b32 v136, 0
    v_mov_b32 v137, 0
    v_mov_b32 v138, 0
    v_mov_b32 v139, 0
    v_mov_b32 v140, 0
    v_mov_b32 v141, 0
    v_mov_b32 v142, 0
    v_mov_b32 v143, 0
    v_mov_b32 v144, 0
    v_mov_b32 v145, 0
    v_mov_b32 v146, 0
    v_mov_b32 v147, 0
    v_mov_b32 v148, 0
    v_mov_b32 v149, 0
    v_mov_b32 v150, 0
    v_mov_b32 v151, 0
    v_mov_b32 v152, 0
    v_mov_b32 v153, 0
    v_mov_b32 v154, 0
    v_mov_b32 v155, 0
    v_mov_b32 v156, 0
    v_mov_b32 v157, 0
    v_mov_b32 v158, 0
    v_mov_b32 v159, 0
    v_mov_b32 v160, 0
    v_mov_b32 v161, 0
    v_mov_b32 v162, 0
    v_mov_b32 v163, 0
    s_add_u32 m0, s62, 4096
    s_nop 0
    buffer_load_dwordx4 v10, s[28:31], s60 offen lds
    s_add_u32 m0, s62, 5120
    s_nop 0
    buffer_load_dwordx4 v11, s[28:31], s60 offen lds
    s_add_u32 m0, s62, 6144
    s_nop 0
    buffer_load_dwordx4 v12, s[28:31], s60 offen lds
    s_add_u32 m0, s62, 7168
    s_nop 0
    buffer_load_dwordx4 v13, s[28:31], s60 offen lds
    s_add_u32 m0, s62, 8192
    s_nop 0
    buffer_load_dwordx4 v14, s[28:31], s60 offen lds
    s_add_u32 m0, s62, 9216
    s_nop 0
    buffer_load_dwordx4 v15, s[28:31], s60 offen lds
    s_add_u32 m0, s62, 10240
    s_nop 0
    buffer_load_dwordx4 v16, s[28:31], s60 offen lds
    s_add_u32 m0, s62, 11264
    s_nop 0
    buffer_load_dwordx4 v17, s[28:31], s60 offen lds
    s_add_u32 s60, s60, 128
    s_add_u32 m0, s63, 102400
    s_nop 0
    buffer_load_dwordx4 v18, s[32:35], s61 offen lds
    s_add_u32 m0, s63, 103424
    s_nop 0
    buffer_load_dwordx4 v19, s[32:35], s61 offen lds
    s_add_u32 s61, s61, 221184
    s_add_u32 m0, s62, 36864
    s_nop 0
    buffer_load_dwordx4 v10, s[28:31], s60 offen lds
    s_add_u32 m0, s62, 37888
    s_nop 0
    buffer_load_dwordx4 v11, s[28:31], s60 offen lds
    s_add_u32 m0, s62, 38912
    s_nop 0
    buffer_load_dwordx4 v12, s[28:31], s60 offen lds
    s_add_u32 m0, s62, 39936
    s_nop 0
    buffer_load_dwordx4 v13, s[28:31], s60 offen lds
    s_add_u32 m0, s62, 40960
    s_nop 0
    buffer_load_dwordx4 v14, s[28:31], s60 offen lds
    s_add_u32 m0, s62, 41984
    s_nop 0
    buffer_load_dwordx4 v15, s[28:31], s60 offen lds
    s_add_u32 m0, s62, 43008
    s_nop 0
    buffer_load_dwordx4 v16, s[28:31], s60 offen lds
    s_add_u32 m0, s62, 44032
    s_nop 0
    buffer_load_dwordx4 v17, s[28:31], s60 offen lds
    s_add_u32 s60, s60, 128
    s_add_u32 m0, s63, 110592
    s_nop 0
    buffer_load_dwordx4 v18, s[32:35], s61 offen lds
    s_add_u32 m0, s63, 111616
    s_nop 0
    buffer_load_dwordx4 v19, s[32:35], s61 offen lds
    s_add_u32 s61, s61, 221184
    s_waitcnt vmcnt(10)
    s_barrier
    v_add_f32 v202, v180, v182
    v_add_f32 v202, v202, v184
    v_add_f32 v202, v202, v186
    v_add_f32 v202, v202, v188
    v_add_f32 v202, v202, v190
    v_add_f32 v202, v202, v192
    v_add_f32 v202, v202, v194
    v_mul_f32 v202, 986500301, v202
    v_add_f32 v203, v181, v183
    v_add_f32 v203, v203, v185
    v_add_f32 v203, v203, v187
    v_add_f32 v203, v203, v189
    v_add_f32 v203, v203, v191
    v_add_f32 v203, v203, v193
    v_add_f32 v203, v203, v195
    v_fma_f32 v204, v180, s99, -v202
    v_mul_f32 v205, v204, v204
    v_fma_f32 v203, v205, s100, v203
    v_fma_f32 v204, v182, s99, -v202
    v_mul_f32 v205, v204, v204
    v_fma_f32 v203, v205, s100, v203
    v_fma_f32 v204, v184, s99, -v202
    v_mul_f32 v205, v204, v204
    v_fma_f32 v203, v205, s100, v203
    v_fma_f32 v204, v186, s99, -v202
    v_mul_f32 v205, v204, v204
    v_fma_f32 v203, v205, s100, v203
    v_fma_f32 v204, v188, s99, -v202
    v_mul_f32 v205, v204, v204
    v_fma_f32 v203, v205, s100, v203
    v_fma_f32 v204, v190, s99, -v202
    v_mul_f32 v205, v204, v204
    v_fma_f32 v203, v205, s100, v203
    v_fma_f32 v204, v192, s99, -v202
    v_mul_f32 v205, v204, v204
    v_fma_f32 v203, v205, s100, v203
    v_fma_f32 v204, v194, s99, -v202
    v_mul_f32 v205, v204, v204
    v_fma_f32 v203, v205, s100, v203
    v_mul_f32 v203, 986500301, v203
    v_add_f32 v203, 925353388, v203
    v_rsq_f32 v200, v203
    s_nop 0
    v_mul_f32 v201, v200, v202
    v_sub_f32 v201, 0, v201
    v_lshlrev_b32 v202, 3, v0
    ds_write_b64 v202, v[200:201] offset:0
    v_cmp_gt_u32 vcc, 16, v0
    s_and_saveexec_b64 s[56:57], vcc
    v_lshlrev_b32 v202, 4, v0
    ds_write_b128 v202, v[196:199] offset:2048
    s_mov_b64 exec, s[56:57]
    v_cmp_gt_u32 vcc, 8, v0
    s_and_saveexec_b64 s[56:57], vcc
    v_lshlrev_b32 v208, 16, v224
    v_and_b32 v209, 0xffff0000, v224
    v_lshlrev_b32 v210, 16, v225
    v_and_b32 v211, 0xffff0000, v225
    v_lshlrev_b32 v212, 16, v226
    v_and_b32 v213, 0xffff0000, v226
    v_lshlrev_b32 v214, 16, v227
    v_and_b32 v215, 0xffff0000, v227
    v_lshlrev_b32 v202, 5, v0
    ds_write_b128 v202, v[208:211] offset:2304
    ds_write_b128 v202, v[212:215] offset:2320
    s_mov_b64 exec, s[56:57]
    ds_read_b128 v[40:43], v20 offset:4096
    ds_read_b128 v[44:47], v24 offset:4096
    ds_read_b64_tr_b16 v[48:49], v28 offset:0
    ds_read_b64_tr_b16 v[50:51], v28 offset:512
    ds_read_b64_tr_b16 v[52:53], v29 offset:0
    ds_read_b64_tr_b16 v[54:55], v29 offset:512
    s_waitcnt lgkmcnt(0)
    v_mfma_f32_32x32x16_bf16 v[100:115], v[48:51], v[40:43], v[100:115]
    ds_read_b128 v[60:63], v21 offset:4096
    ds_read_b128 v[64:67], v25 offset:4096
    v_mfma_f32_32x32x16_bf16 v[116:131], v[52:55], v[40:43], v[116:131]
    ds_read_b64_tr_b16 v[68:69], v28 offset:2048
    ds_read_b64_tr_b16 v[70:71], v28 offset:2560
    s_add_u32 m0, s62, 69632
    s_nop 0
    buffer_load_dwordx4 v10, s[28:31], s60 offen lds
    v_mfma_f32_32x32x16_bf16 v[132:147], v[48:51], v[44:47], v[132:147]
    ds_read_b64_tr_b16 v[72:73], v29 offset:2048
    ds_read_b64_tr_b16 v[74:75], v29 offset:2560
    s_add_u32 m0, s62, 70656
    s_nop 0
    buffer_load_dwordx4 v11, s[28:31], s60 offen lds
    v_mfma_f32_32x32x16_bf16 v[148:163], v[52:55], v[44:47], v[148:163]
    s_add_u32 m0, s62, 71680
    s_nop 0
    buffer_load_dwordx4 v12, s[28:31], s60 offen lds
    s_waitcnt lgkmcnt(0)
    v_mfma_f32_32x32x16_bf16 v[100:115], v[68:71], v[60:63], v[100:115]
    ds_read_b128 v[40:43], v22 offset:4096
    ds_read_b128 v[44:47], v26 offset:4096
    v_mfma_f32_32x32x16_bf16 v[116:131], v[72:75], v[60:63], v[116:131]
    ds_read_b64_tr_b16 v[48:49], v28 offset:4096
    ds_read_b64_tr_b16 v[50:51], v28 offset:4608
    s_add_u32 m0, s62, 72704
    s_nop 0
    buffer_load_dwordx4 v13, s[28:31], s60 offen lds
    v_mfma_f32_32x32x16_bf16 v[132:147], v[68:71], v[64:67], v[132:147]
    ds_read_b64_tr_b16 v[52:53], v29 offset:4096
    ds_read_b64_tr_b16 v[54:55], v29 offset:4608
    s_add_u32 m0, s62, 73728
    s_nop 0
    buffer_load_dwordx4 v14, s[28:31], s60 offen lds
    v_mfma_f32_32x32x16_bf16 v[148:163], v[72:75], v[64:67], v[148:163]
    s_add_u32 m0, s62, 74752
    s_nop 0
    buffer_load_dwordx4 v15, s[28:31], s60 offen lds
    s_waitcnt lgkmcnt(0)
    v_mfma_f32_32x32x16_bf16 v[100:115], v[48:51], v[40:43], v[100:115]
    ds_read_b128 v[60:63], v23 offset:4096
    ds_read_b128 v[64:67], v27 offset:4096
    v_mfma_f32_32x32x16_bf16 v[116:131], v[52:55], v[40:43], v[116:131]
    ds_read_b64_tr_b16 v[68:69], v28 offset:6144
    ds_read_b64_tr_b16 v[70:71], v28 offset:6656
    s_add_u32 m0, s62, 75776
    s_nop 0
    buffer_load_dwordx4 v16, s[28:31], s60 offen lds
    v_mfma_f32_32x32x16_bf16 v[132:147], v[48:51], v[44:47], v[132:147]
    ds_read_b64_tr_b16 v[72:73], v29 offset:6144
    ds_read_b64_tr_b16 v[74:75], v29 offset:6656
    s_add_u32 m0, s62, 76800
    s_nop 0
    buffer_load_dwordx4 v17, s[28:31], s60 offen lds
    s_add_u32 s60, s60, 128
    v_mfma_f32_32x32x16_bf16 v[148:163], v[52:55], v[44:47], v[148:163]
    s_waitcnt lgkmcnt(0)
    s_add_u32 m0, s63, 118784
    s_nop 0
    buffer_load_dwordx4 v18, s[32:35], s61 offen lds
    s_add_u32 m0, s63, 119808
    s_nop 0
    buffer_load_dwordx4 v19, s[32:35], s61 offen lds
    s_add_u32 s61, s61, 221184
    s_waitcnt vmcnt(10)
    s_barrier
    v_mfma_f32_32x32x16_bf16 v[100:115], v[68:71], v[60:63], v[100:115]
    ds_read_b128 v[40:43], v20 offset:36864
    ds_read_b128 v[44:47], v24 offset:36864
    v_mfma_f32_32x32x16_bf16 v[116:131], v[72:75], v[60:63], v[116:131]
    ds_read_b64_tr_b16 v[48:49], v28 offset:8192
    ds_read_b64_tr_b16 v[50:51], v28 offset:8704
    s_add_u32 m0, s62, 4096
    s_nop 0
    buffer_load_dwordx4 v10, s[28:31], s60 offen lds
    s_add_u32 m0, s62, 5120
    s_nop 0
    buffer_load_dwordx4 v11, s[28:31], s60 offen lds
    s_add_u32 m0, s62, 6144
    s_nop 0
    buffer_load_dwordx4 v12, s[28:31], s60 offen lds
    s_add_u32 m0, s62, 7168
    s_nop 0
    buffer_load_dwordx4 v13, s[28:31], s60 offen lds
    v_mfma_f32_32x32x16_bf16 v[132:147], v[68:71], v[64:67], v[132:147]
    ds_read_b64_tr_b16 v[52:53], v29 offset:8192
    ds_read_b64_tr_b16 v[54:55], v29 offset:8704
    s_add_u32 m0, s62, 8192
    s_nop 0
    buffer_load_dwordx4 v14, s[28:31], s60 offen lds
    s_add_u32 m0, s62, 9216
    s_nop 0
    buffer_load_dwordx4 v15, s[28:31], s60 offen lds
    s_add_u32 m0, s62, 10240
    s_nop 0
    buffer_load_dwordx4 v16, s[28:31], s60 offen lds
    v_mfma_f32_32x32x16_bf16 v[148:163], v[72:75], v[64:67], v[148:163]
    s_add_u32 m0, s62, 11264
    s_nop 0
    buffer_load_dwordx4 v17, s[28:31], s60 offen lds
    s_add_u32 s60, s60, 128
    s_add_u32 m0, s63, 102400
    s_nop 0
    buffer_load_dwordx4 v18, s[32:35], s61 offen lds
    s_add_u32 m0, s63, 103424
    s_nop 0
    buffer_load_dwordx4 v19, s[32:35], s61 offen lds
    s_add_u32 s61, s61, 221184
    s_waitcnt lgkmcnt(0)
    v_mfma_f32_32x32x16_bf16 v[100:115], v[48:51], v[40:43], v[100:115]
    ds_read_b128 v[60:63], v21 offset:36864
    ds_read_b128 v[64:67], v25 offset:36864
    v_mfma_f32_32x32x16_bf16 v[116:131], v[52:55], v[40:43], v[116:131]
    ds_read_b64_tr_b16 v[68:69], v28 offset:10240
    ds_read_b64_tr_b16 v[70:71], v28 offset:10752
    v_mfma_f32_32x32x16_bf16 v[132:147], v[48:51], v[44:47], v[132:147]
    ds_read_b64_tr_b16 v[72:73], v29 offset:10240
    ds_read_b64_tr_b16 v[74:75], v29 offset:10752
    v_mfma_f32_32x32x16_bf16 v[148:163], v[52:55], v[44:47], v[148:163]
    s_waitcnt lgkmcnt(0)
    v_mfma_f32_32x32x16_bf16 v[100:115], v[68:71], v[60:63], v[100:115]
    ds_read_b128 v[40:43], v22 offset:36864
    ds_read_b128 v[44:47], v26 offset:36864
    v_mfma_f32_32x32x16_bf16 v[116:131], v[72:75], v[60:63], v[116:131]
    ds_read_b64_tr_b16 v[48:49], v28 offset:12288
    ds_read_b64_tr_b16 v[50:51], v28 offset:12800
    v_mfma_f32_32x32x16_bf16 v[132:147], v[68:71], v[64:67], v[132:147]
    ds_read_b64_tr_b16 v[52:53], v29 offset:12288
    ds_read_b64_tr_b16 v[54:55], v29 offset:12800
    v_mfma_f32_32x32x16_bf16 v[148:163], v[72:75], v[64:67], v[148:163]
    s_waitcnt lgkmcnt(0)
    v_mfma_f32_32x32x16_bf16 v[100:115], v[48:51], v[40:43], v[100:115]
    ds_read_b128 v[60:63], v23 offset:36864
    ds_read_b128 v[64:67], v27 offset:36864
    v_mfma_f32_32x32x16_bf16 v[116:131], v[52:55], v[40:43], v[116:131]
    ds_read_b64_tr_b16 v[68:69], v28 offset:14336
    ds_read_b64_tr_b16 v[70:71], v28 offset:14848
    v_mfma_f32_32x32x16_bf16 v[132:147], v[48:51], v[44:47], v[132:147]
    ds_read_b64_tr_b16 v[72:73], v29 offset:14336
    ds_read_b64_tr_b16 v[74:75], v29 offset:14848
    v_mfma_f32_32x32x16_bf16 v[148:163], v[52:55], v[44:47], v[148:163]
    s_waitcnt lgkmcnt(0)
    s_waitcnt vmcnt(10)
    s_barrier
    v_mfma_f32_32x32x16_bf16 v[100:115], v[68:71], v[60:63], v[100:115]
    ds_read_b128 v[40:43], v32 offset:36864
    ds_read_b128 v[44:47], v36 offset:36864
    v_mfma_f32_32x32x16_bf16 v[116:131], v[72:75], v[60:63], v[116:131]
    ds_read_b64_tr_b16 v[48:49], v28 offset:16384
    ds_read_b64_tr_b16 v[50:51], v28 offset:16896
    s_add_u32 m0, s62, 36864
    s_nop 0
    buffer_load_dwordx4 v10, s[28:31], s60 offen lds
    s_add_u32 m0, s62, 37888
    s_nop 0
    buffer_load_dwordx4 v11, s[28:31], s60 offen lds
    s_add_u32 m0, s62, 38912
    s_nop 0
    buffer_load_dwordx4 v12, s[28:31], s60 offen lds
    s_add_u32 m0, s62, 39936
    s_nop 0
    buffer_load_dwordx4 v13, s[28:31], s60 offen lds
    v_mfma_f32_32x32x16_bf16 v[132:147], v[68:71], v[64:67], v[132:147]
    ds_read_b64_tr_b16 v[52:53], v29 offset:16384
    ds_read_b64_tr_b16 v[54:55], v29 offset:16896
    s_add_u32 m0, s62, 40960
    s_nop 0
    buffer_load_dwordx4 v14, s[28:31], s60 offen lds
    s_add_u32 m0, s62, 41984
    s_nop 0
    buffer_load_dwordx4 v15, s[28:31], s60 offen lds
    s_add_u32 m0, s62, 43008
    s_nop 0
    buffer_load_dwordx4 v16, s[28:31], s60 offen lds
    v_mfma_f32_32x32x16_bf16 v[148:163], v[72:75], v[64:67], v[148:163]
    s_add_u32 m0, s62, 44032
    s_nop 0
    buffer_load_dwordx4 v17, s[28:31], s60 offen lds
    s_add_u32 s60, s60, 128
    s_add_u32 m0, s63, 110592
    s_nop 0
    buffer_load_dwordx4 v18, s[32:35], s61 offen lds
    s_add_u32 m0, s63, 111616
    s_nop 0
    buffer_load_dwordx4 v19, s[32:35], s61 offen lds
    s_add_u32 s61, s61, 221184
    s_waitcnt lgkmcnt(0)
    v_mfma_f32_32x32x16_bf16 v[100:115], v[48:51], v[40:43], v[100:115]
    ds_read_b128 v[60:63], v33 offset:36864
    ds_read_b128 v[64:67], v37 offset:36864
    v_mfma_f32_32x32x16_bf16 v[116:131], v[52:55], v[40:43], v[116:131]
    ds_read_b64_tr_b16 v[68:69], v28 offset:18432
    ds_read_b64_tr_b16 v[70:71], v28 offset:18944
    v_mfma_f32_32x32x16_bf16 v[132:147], v[48:51], v[44:47], v[132:147]
    ds_read_b64_tr_b16 v[72:73], v29 offset:18432
    ds_read_b64_tr_b16 v[74:75], v29 offset:18944
    v_mfma_f32_32x32x16_bf16 v[148:163], v[52:55], v[44:47], v[148:163]
    s_waitcnt lgkmcnt(0)
    v_mfma_f32_32x32x16_bf16 v[100:115], v[68:71], v[60:63], v[100:115]
    ds_read_b128 v[40:43], v34 offset:36864
    ds_read_b128 v[44:47], v38 offset:36864
    v_mfma_f32_32x32x16_bf16 v[116:131], v[72:75], v[60:63], v[116:131]
    ds_read_b64_tr_b16 v[48:49], v28 offset:20480
    ds_read_b64_tr_b16 v[50:51], v28 offset:20992
    v_mfma_f32_32x32x16_bf16 v[132:147], v[68:71], v[64:67], v[132:147]
    ds_read_b64_tr_b16 v[52:53], v29 offset:20480
    ds_read_b64_tr_b16 v[54:55], v29 offset:20992
    v_mfma_f32_32x32x16_bf16 v[148:163], v[72:75], v[64:67], v[148:163]
    s_waitcnt lgkmcnt(0)
    v_mfma_f32_32x32x16_bf16 v[100:115], v[48:51], v[40:43], v[100:115]
    ds_read_b128 v[60:63], v35 offset:36864
    ds_read_b128 v[64:67], v39 offset:36864
    v_mfma_f32_32x32x16_bf16 v[116:131], v[52:55], v[40:43], v[116:131]
    ds_read_b64_tr_b16 v[68:69], v28 offset:22528
    ds_read_b64_tr_b16 v[70:71], v28 offset:23040
    v_mfma_f32_32x32x16_bf16 v[132:147], v[48:51], v[44:47], v[132:147]
    ds_read_b64_tr_b16 v[72:73], v29 offset:22528
    ds_read_b64_tr_b16 v[74:75], v29 offset:23040
    v_mfma_f32_32x32x16_bf16 v[148:163], v[52:55], v[44:47], v[148:163]
    s_waitcnt lgkmcnt(0)
    s_waitcnt vmcnt(10)
    s_barrier
    v_mfma_f32_32x32x16_bf16 v[100:115], v[68:71], v[60:63], v[100:115]
    ds_read_b128 v[40:43], v20 offset:4096
    ds_read_b128 v[44:47], v24 offset:4096
    v_mfma_f32_32x32x16_bf16 v[116:131], v[72:75], v[60:63], v[116:131]
    ds_read_b64_tr_b16 v[48:49], v28 offset:0
    ds_read_b64_tr_b16 v[50:51], v28 offset:512
    s_add_u32 m0, s62, 69632
    s_nop 0
    buffer_load_dwordx4 v10, s[28:31], s60 offen lds
    s_add_u32 m0, s62, 70656
    s_nop 0
    buffer_load_dwordx4 v11, s[28:31], s60 offen lds
    s_add_u32 m0, s62, 71680
    s_nop 0
    buffer_load_dwordx4 v12, s[28:31], s60 offen lds
    s_add_u32 m0, s62, 72704
    s_nop 0
    buffer_load_dwordx4 v13, s[28:31], s60 offen lds
    v_mfma_f32_32x32x16_bf16 v[132:147], v[68:71], v[64:67], v[132:147]
    ds_read_b64_tr_b16 v[52:53], v29 offset:0
    ds_read_b64_tr_b16 v[54:55], v29 offset:512
    s_add_u32 m0, s62, 73728
    s_nop 0
    buffer_load_dwordx4 v14, s[28:31], s60 offen lds
    s_add_u32 m0, s62, 74752
    s_nop 0
    buffer_load_dwordx4 v15, s[28:31], s60 offen lds
    s_add_u32 m0, s62, 75776
    s_nop 0
    buffer_load_dwordx4 v16, s[28:31], s60 offen lds
    v_mfma_f32_32x32x16_bf16 v[148:163], v[72:75], v[64:67], v[148:163]
    s_add_u32 m0, s62, 76800
    s_nop 0
    buffer_load_dwordx4 v17, s[28:31], s60 offen lds
    s_add_u32 s60, s60, 128
    s_add_u32 m0, s63, 118784
    s_nop 0
    buffer_load_dwordx4 v18, s[32:35], s61 offen lds
    s_add_u32 m0, s63, 119808
    s_nop 0
    buffer_load_dwordx4 v19, s[32:35], s61 offen lds
    s_add_u32 s61, s61, 221184
    s_waitcnt lgkmcnt(0)
    v_mfma_f32_32x32x16_bf16 v[100:115], v[48:51], v[40:43], v[100:115]
    ds_read_b128 v[60:63], v21 offset:4096
    ds_read_b128 v[64:67], v25 offset:4096
    v_mfma_f32_32x32x16_bf16 v[116:131], v[52:55], v[40:43], v[116:131]
    ds_read_b64_tr_b16 v[68:69], v28 offset:2048
    ds_read_b64_tr_b16 v[70:71], v28 offset:2560
    v_mfma_f32_32x32x16_bf16 v[132:147], v[48:51], v[44:47], v[132:147]
    ds_read_b64_tr_b16 v[72:73], v29 offset:2048
    ds_read_b64_tr_b16 v[74:75], v29 offset:2560
    v_mfma_f32_32x32x16_bf16 v[148:163], v[52:55], v[44:47], v[148:163]
    s_waitcnt lgkmcnt(0)
    v_mfma_f32_32x32x16_bf16 v[100:115], v[68:71], v[60:63], v[100:115]
    ds_read_b128 v[40:43], v22 offset:4096
    ds_read_b128 v[44:47], v26 offset:4096
    v_mfma_f32_32x32x16_bf16 v[116:131], v[72:75], v[60:63], v[116:131]
    ds_read_b64_tr_b16 v[48:49], v28 offset:4096
    ds_read_b64_tr_b16 v[50:51], v28 offset:4608
    v_mfma_f32_32x32x16_bf16 v[132:147], v[68:71], v[64:67], v[132:147]
    ds_read_b64_tr_b16 v[52:53], v29 offset:4096
    ds_read_b64_tr_b16 v[54:55], v29 offset:4608
    v_mfma_f32_32x32x16_bf16 v[148:163], v[72:75], v[64:67], v[148:163]
    s_waitcnt lgkmcnt(0)
    v_mfma_f32_32x32x16_bf16 v[100:115], v[48:51], v[40:43], v[100:115]
    ds_read_b128 v[60:63], v23 offset:4096
    ds_read_b128 v[64:67], v27 offset:4096
    v_mfma_f32_32x32x16_bf16 v[116:131], v[52:55], v[40:43], v[116:131]
    ds_read_b64_tr_b16 v[68:69], v28 offset:6144
    ds_read_b64_tr_b16 v[70:71], v28 offset:6656
    v_mfma_f32_32x32x16_bf16 v[132:147], v[48:51], v[44:47], v[132:147]
    ds_read_b64_tr_b16 v[72:73], v29 offset:6144
    ds_read_b64_tr_b16 v[74:75], v29 offset:6656
    v_mfma_f32_32x32x16_bf16 v[148:163], v[52:55], v[44:47], v[148:163]
    s_waitcnt lgkmcnt(0)
    s_waitcnt vmcnt(10)
    s_barrier
    v_mfma_f32_32x32x16_bf16 v[100:115], v[68:71], v[60:63], v[100:115]
    ds_read_b128 v[40:43], v20 offset:36864
    ds_read_b128 v[44:47], v24 offset:36864
    v_mfma_f32_32x32x16_bf16 v[116:131], v[72:75], v[60:63], v[116:131]
    ds_read_b64_tr_b16 v[48:49], v28 offset:8192
    ds_read_b64_tr_b16 v[50:51], v28 offset:8704
    s_add_u32 m0, s62, 4096
    s_nop 0
    buffer_load_dwordx4 v10, s[28:31], s60 offen lds
    s_add_u32 m0, s62, 5120
    s_nop 0
    buffer_load_dwordx4 v11, s[28:31], s60 offen lds
    s_add_u32 m0, s62, 6144
    s_nop 0
    buffer_load_dwordx4 v12, s[28:31], s60 offen lds
    s_add_u32 m0, s62, 7168
    s_nop 0
    buffer_load_dwordx4 v13, s[28:31], s60 offen lds
    v_mfma_f32_32x32x16_bf16 v[132:147], v[68:71], v[64:67], v[132:147]
    ds_read_b64_tr_b16 v[52:53], v29 offset:8192
    ds_read_b64_tr_b16 v[54:55], v29 offset:8704
    s_add_u32 m0, s62, 8192
    s_nop 0
    buffer_load_dwordx4 v14, s[28:31], s60 offen lds
    s_add_u32 m0, s62, 9216
    s_nop 0
    buffer_load_dwordx4 v15, s[28:31], s60 offen lds
    s_add_u32 m0, s62, 10240
    s_nop 0
    buffer_load_dwordx4 v16, s[28:31], s60 offen lds
    v_mfma_f32_32x32x16_bf16 v[148:163], v[72:75], v[64:67], v[148:163]
    s_add_u32 m0, s62, 11264
    s_nop 0
    buffer_load_dwordx4 v17, s[28:31], s60 offen lds
    s_add_u32 s60, s60, 128
    s_add_u32 m0, s63, 102400
    s_nop 0
    buffer_load_dwordx4 v18, s[32:35], s61 offen lds
    s_add_u32 m0, s63, 103424
    s_nop 0
    buffer_load_dwordx4 v19, s[32:35], s61 offen lds
    s_add_u32 s61, s61, 221184
    s_waitcnt lgkmcnt(0)
    v_mfma_f32_32x32x16_bf16 v[100:115], v[48:51], v[40:43], v[100:115]
    ds_read_b128 v[60:63], v21 offset:36864
    ds_read_b128 v[64:67], v25 offset:36864
    v_mfma_f32_32x32x16_bf16 v[116:131], v[52:55], v[40:43], v[116:131]
    ds_read_b64_tr_b16 v[68:69], v28 offset:10240
    ds_read_b64_tr_b16 v[70:71], v28 offset:10752
    v_mfma_f32_32x32x16_bf16 v[132:147], v[48:51], v[44:47], v[132:147]
    ds_read_b64_tr_b16 v[72:73], v29 offset:10240
    ds_read_b64_tr_b16 v[74:75], v29 offset:10752
    v_mfma_f32_32x32x16_bf16 v[148:163], v[52:55], v[44:47], v[148:163]
    s_waitcnt lgkmcnt(0)
    v_mfma_f32_32x32x16_bf16 v[100:115], v[68:71], v[60:63], v[100:115]
    ds_read_b128 v[40:43], v22 offset:36864
    ds_read_b128 v[44:47], v26 offset:36864
    v_mfma_f32_32x32x16_bf16 v[116:131], v[72:75], v[60:63], v[116:131]
    ds_read_b64_tr_b16 v[48:49], v28 offset:12288
    ds_read_b64_tr_b16 v[50:51], v28 offset:12800
    v_mfma_f32_32x32x16_bf16 v[132:147], v[68:71], v[64:67], v[132:147]
    ds_read_b64_tr_b16 v[52:53], v29 offset:12288
    ds_read_b64_tr_b16 v[54:55], v29 offset:12800
    v_mfma_f32_32x32x16_bf16 v[148:163], v[72:75], v[64:67], v[148:163]
    s_waitcnt lgkmcnt(0)
    v_mfma_f32_32x32x16_bf16 v[100:115], v[48:51], v[40:43], v[100:115]
    ds_read_b128 v[60:63], v23 offset:36864
    ds_read_b128 v[64:67], v27 offset:36864
    v_mfma_f32_32x32x16_bf16 v[116:131], v[52:55], v[40:43], v[116:131]
    ds_read_b64_tr_b16 v[68:69], v28 offset:14336
    ds_read_b64_tr_b16 v[70:71], v28 offset:14848
    v_mfma_f32_32x32x16_bf16 v[132:147], v[48:51], v[44:47], v[132:147]
    ds_read_b64_tr_b16 v[72:73], v29 offset:14336
    ds_read_b64_tr_b16 v[74:75], v29 offset:14848
    v_mfma_f32_32x32x16_bf16 v[148:163], v[52:55], v[44:47], v[148:163]
    s_waitcnt lgkmcnt(0)
    s_waitcnt vmcnt(10)
    s_barrier
    v_mfma_f32_32x32x16_bf16 v[100:115], v[68:71], v[60:63], v[100:115]
    ds_read_b128 v[40:43], v32 offset:36864
    ds_read_b128 v[44:47], v36 offset:36864
    v_mfma_f32_32x32x16_bf16 v[116:131], v[72:75], v[60:63], v[116:131]
    ds_read_b64_tr_b16 v[48:49], v28 offset:16384
    ds_read_b64_tr_b16 v[50:51], v28 offset:16896
    s_add_u32 m0, s62, 36864
    s_nop 0
    buffer_load_dwordx4 v10, s[28:31], s60 offen lds
    s_add_u32 m0, s62, 37888
    s_nop 0
    buffer_load_dwordx4 v11, s[28:31], s60 offen lds
    s_add_u32 m0, s62, 38912
    s_nop 0
    buffer_load_dwordx4 v12, s[28:31], s60 offen lds
    s_add_u32 m0, s62, 39936
    s_nop 0
    buffer_load_dwordx4 v13, s[28:31], s60 offen lds
    v_mfma_f32_32x32x16_bf16 v[132:147], v[68:71], v[64:67], v[132:147]
    ds_read_b64_tr_b16 v[52:53], v29 offset:16384
    ds_read_b64_tr_b16 v[54:55], v29 offset:16896
    s_add_u32 m0, s62, 40960
    s_nop 0
    buffer_load_dwordx4 v14, s[28:31], s60 offen lds
    s_add_u32 m0, s62, 41984
    s_nop 0
    buffer_load_dwordx4 v15, s[28:31], s60 offen lds
    s_add_u32 m0, s62, 43008
    s_nop 0
    buffer_load_dwordx4 v16, s[28:31], s60 offen lds
    v_mfma_f32_32x32x16_bf16 v[148:163], v[72:75], v[64:67], v[148:163]
    s_add_u32 m0, s62, 44032
    s_nop 0
    buffer_load_dwordx4 v17, s[28:31], s60 offen lds
    s_add_u32 s60, s60, 128
    s_add_u32 m0, s63, 110592
    s_nop 0
    buffer_load_dwordx4 v18, s[32:35], s61 offen lds
    s_add_u32 m0, s63, 111616
    s_nop 0
    buffer_load_dwordx4 v19, s[32:35], s61 offen lds
    s_add_u32 s61, s61, 221184
    s_waitcnt lgkmcnt(0)
    v_mfma_f32_32x32x16_bf16 v[100:115], v[48:51], v[40:43], v[100:115]
    ds_read_b128 v[60:63], v33 offset:36864
    ds_read_b128 v[64:67], v37 offset:36864
    v_mfma_f32_32x32x16_bf16 v[116:131], v[52:55], v[40:43], v[116:131]
    ds_read_b64_tr_b16 v[68:69], v28 offset:18432
    ds_read_b64_tr_b16 v[70:71], v28 offset:18944
    v_mfma_f32_32x32x16_bf16 v[132:147], v[48:51], v[44:47], v[132:147]
    ds_read_b64_tr_b16 v[72:73], v29 offset:18432
    ds_read_b64_tr_b16 v[74:75], v29 offset:18944
    v_mfma_f32_32x32x16_bf16 v[148:163], v[52:55], v[44:47], v[148:163]
    s_waitcnt lgkmcnt(0)
    v_mfma_f32_32x32x16_bf16 v[100:115], v[68:71], v[60:63], v[100:115]
    ds_read_b128 v[40:43], v34 offset:36864
    ds_read_b128 v[44:47], v38 offset:36864
    v_mfma_f32_32x32x16_bf16 v[116:131], v[72:75], v[60:63], v[116:131]
    ds_read_b64_tr_b16 v[48:49], v28 offset:20480
    ds_read_b64_tr_b16 v[50:51], v28 offset:20992
    v_mfma_f32_32x32x16_bf16 v[132:147], v[68:71], v[64:67], v[132:147]
    ds_read_b64_tr_b16 v[52:53], v29 offset:20480
    ds_read_b64_tr_b16 v[54:55], v29 offset:20992
    v_mfma_f32_32x32x16_bf16 v[148:163], v[72:75], v[64:67], v[148:163]
    s_waitcnt lgkmcnt(0)
    v_mfma_f32_32x32x16_bf16 v[100:115], v[48:51], v[40:43], v[100:115]
    ds_read_b128 v[60:63], v35 offset:36864
    ds_read_b128 v[64:67], v39 offset:36864
    v_mfma_f32_32x32x16_bf16 v[116:131], v[52:55], v[40:43], v[116:131]
    ds_read_b64_tr_b16 v[68:69], v28 offset:22528
    ds_read_b64_tr_b16 v[70:71], v28 offset:23040
    v_mfma_f32_32x32x16_bf16 v[132:147], v[48:51], v[44:47], v[132:147]
    ds_read_b64_tr_b16 v[72:73], v29 offset:22528
    ds_read_b64_tr_b16 v[74:75], v29 offset:23040
    v_mfma_f32_32x32x16_bf16 v[148:163], v[52:55], v[44:47], v[148:163]
    s_waitcnt lgkmcnt(0)
    s_waitcnt vmcnt(10)
    s_barrier
    v_mfma_f32_32x32x16_bf16 v[100:115], v[68:71], v[60:63], v[100:115]
    ds_read_b128 v[40:43], v20 offset:4096
    ds_read_b128 v[44:47], v24 offset:4096
    v_mfma_f32_32x32x16_bf16 v[116:131], v[72:75], v[60:63], v[116:131]
    ds_read_b64_tr_b16 v[48:49], v28 offset:0
    ds_read_b64_tr_b16 v[50:51], v28 offset:512
    s_add_u32 m0, s62, 69632
    s_nop 0
    buffer_load_dwordx4 v10, s[28:31], s60 offen lds
    s_add_u32 m0, s62, 70656
    s_nop 0
    buffer_load_dwordx4 v11, s[28:31], s60 offen lds
    s_add_u32 m0, s62, 71680
    s_nop 0
    buffer_load_dwordx4 v12, s[28:31], s60 offen lds
    s_add_u32 m0, s62, 72704
    s_nop 0
    buffer_load_dwordx4 v13, s[28:31], s60 offen lds
    v_mfma_f32_32x32x16_bf16 v[132:147], v[68:71], v[64:67], v[132:147]
    ds_read_b64_tr_b16 v[52:53], v29 offset:0
    ds_read_b64_tr_b16 v[54:55], v29 offset:512
    s_add_u32 m0, s62, 73728
    s_nop 0
    buffer_load_dwordx4 v14, s[28:31], s60 offen lds
    s_add_u32 m0, s62, 74752
    s_nop 0
    buffer_load_dwordx4 v15, s[28:31], s60 offen lds
    s_add_u32 m0, s62, 75776
    s_nop 0
    buffer_load_dwordx4 v16, s[28:31], s60 offen lds
    v_mfma_f32_32x32x16_bf16 v[148:163], v[72:75], v[64:67], v[148:163]
    s_add_u32 m0, s62, 76800
    s_nop 0
    buffer_load_dwordx4 v17, s[28:31], s60 offen lds
    s_add_u32 s60, s60, 128
    s_add_u32 m0, s63, 118784
    s_nop 0
    buffer_load_dwordx4 v18, s[32:35], s61 offen lds
    s_add_u32 m0, s63, 119808
    s_nop 0
    buffer_load_dwordx4 v19, s[32:35], s61 offen lds
    s_add_u32 s61, s61, 221184
    s_waitcnt lgkmcnt(0)
    v_mfma_f32_32x32x16_bf16 v[100:115], v[48:51], v[40:43], v[100:115]
    ds_read_b128 v[60:63], v21 offset:4096
    ds_read_b128 v[64:67], v25 offset:4096
    v_mfma_f32_32x32x16_bf16 v[116:131], v[52:55], v[40:43], v[116:131]
    ds_read_b64_tr_b16 v[68:69], v28 offset:2048
    ds_read_b64_tr_b16 v[70:71], v28 offset:2560
    v_mfma_f32_32x32x16_bf16 v[132:147], v[48:51], v[44:47], v[132:147]
    ds_read_b64_tr_b16 v[72:73], v29 offset:2048
    ds_read_b64_tr_b16 v[74:75], v29 offset:2560
    v_mfma_f32_32x32x16_bf16 v[148:163], v[52:55], v[44:47], v[148:163]
    s_waitcnt lgkmcnt(0)
    v_mfma_f32_32x32x16_bf16 v[100:115], v[68:71], v[60:63], v[100:115]
    ds_read_b128 v[40:43], v22 offset:4096
    ds_read_b128 v[44:47], v26 offset:4096
    v_mfma_f32_32x32x16_bf16 v[116:131], v[72:75], v[60:63], v[116:131]
    ds_read_b64_tr_b16 v[48:49], v28 offset:4096
    ds_read_b64_tr_b16 v[50:51], v28 offset:4608
    v_mfma_f32_32x32x16_bf16 v[132:147], v[68:71], v[64:67], v[132:147]
    ds_read_b64_tr_b16 v[52:53], v29 offset:4096
    ds_read_b64_tr_b16 v[54:55], v29 offset:4608
    v_mfma_f32_32x32x16_bf16 v[148:163], v[72:75], v[64:67], v[148:163]
    s_waitcnt lgkmcnt(0)
    v_mfma_f32_32x32x16_bf16 v[100:115], v[48:51], v[40:43], v[100:115]
    ds_read_b128 v[60:63], v23 offset:4096
    ds_read_b128 v[64:67], v27 offset:4096
    v_mfma_f32_32x32x16_bf16 v[116:131], v[52:55], v[40:43], v[116:131]
    ds_read_b64_tr_b16 v[68:69], v28 offset:6144
    ds_read_b64_tr_b16 v[70:71], v28 offset:6656
    v_mfma_f32_32x32x16_bf16 v[132:147], v[48:51], v[44:47], v[132:147]
    ds_read_b64_tr_b16 v[72:73], v29 offset:6144
    ds_read_b64_tr_b16 v[74:75], v29 offset:6656
    v_mfma_f32_32x32x16_bf16 v[148:163], v[52:55], v[44:47], v[148:163]
    s_waitcnt lgkmcnt(0)
    s_waitcnt vmcnt(10)
    s_barrier
    v_mfma_f32_32x32x16_bf16 v[100:115], v[68:71], v[60:63], v[100:115]
    ds_read_b128 v[40:43], v20 offset:36864
    ds_read_b128 v[44:47], v24 offset:36864
    v_mfma_f32_32x32x16_bf16 v[116:131], v[72:75], v[60:63], v[116:131]
    ds_read_b64_tr_b16 v[48:49], v28 offset:8192
    ds_read_b64_tr_b16 v[50:51], v28 offset:8704
    s_add_u32 m0, s62, 4096
    s_nop 0
    buffer_load_dwordx4 v10, s[28:31], s60 offen lds
    s_add_u32 m0, s62, 5120
    s_nop 0
    buffer_load_dwordx4 v11, s[28:31], s60 offen lds
    s_add_u32 m0, s62, 6144
    s_nop 0
    buffer_load_dwordx4 v12, s[28:31], s60 offen lds
    s_add_u32 m0, s62, 7168
    s_nop 0
    buffer_load_dwordx4 v13, s[28:31], s60 offen lds
    v_mfma_f32_32x32x16_bf16 v[132:147], v[68:71], v[64:67], v[132:147]
    ds_read_b64_tr_b16 v[52:53], v29 offset:8192
    ds_read_b64_tr_b16 v[54:55], v29 offset:8704
    s_add_u32 m0, s62, 8192
    s_nop 0
    buffer_load_dwordx4 v14, s[28:31], s60 offen lds
    s_add_u32 m0, s62, 9216
    s_nop 0
    buffer_load_dwordx4 v15, s[28:31], s60 offen lds
    s_add_u32 m0, s62, 10240
    s_nop 0
    buffer_load_dwordx4 v16, s[28:31], s60 offen lds
    v_mfma_f32_32x32x16_bf16 v[148:163], v[72:75], v[64:67], v[148:163]
    s_add_u32 m0, s62, 11264
    s_nop 0
    buffer_load_dwordx4 v17, s[28:31], s60 offen lds
    s_add_u32 s60, s60, 128
    s_add_u32 m0, s63, 102400
    s_nop 0
    buffer_load_dwordx4 v18, s[32:35], s61 offen lds
    s_add_u32 m0, s63, 103424
    s_nop 0
    buffer_load_dwordx4 v19, s[32:35], s61 offen lds
    s_add_u32 s61, s61, 221184
    s_waitcnt lgkmcnt(0)
    v_mfma_f32_32x32x16_bf16 v[100:115], v[48:51], v[40:43], v[100:115]
    ds_read_b128 v[60:63], v21 offset:36864
    ds_read_b128 v[64:67], v25 offset:36864
    v_mfma_f32_32x32x16_bf16 v[116:131], v[52:55], v[40:43], v[116:131]
    ds_read_b64_tr_b16 v[68:69], v28 offset:10240
    ds_read_b64_tr_b16 v[70:71], v28 offset:10752
    v_mfma_f32_32x32x16_bf16 v[132:147], v[48:51], v[44:47], v[132:147]
    ds_read_b64_tr_b16 v[72:73], v29 offset:10240
    ds_read_b64_tr_b16 v[74:75], v29 offset:10752
    v_mfma_f32_32x32x16_bf16 v[148:163], v[52:55], v[44:47], v[148:163]
    s_waitcnt lgkmcnt(0)
    v_mfma_f32_32x32x16_bf16 v[100:115], v[68:71], v[60:63], v[100:115]
    ds_read_b128 v[40:43], v22 offset:36864
    ds_read_b128 v[44:47], v26 offset:36864
    v_mfma_f32_32x32x16_bf16 v[116:131], v[72:75], v[60:63], v[116:131]
    ds_read_b64_tr_b16 v[48:49], v28 offset:12288
    ds_read_b64_tr_b16 v[50:51], v28 offset:12800
    v_mfma_f32_32x32x16_bf16 v[132:147], v[68:71], v[64:67], v[132:147]
    ds_read_b64_tr_b16 v[52:53], v29 offset:12288
    ds_read_b64_tr_b16 v[54:55], v29 offset:12800
    v_mfma_f32_32x32x16_bf16 v[148:163], v[72:75], v[64:67], v[148:163]
    s_waitcnt lgkmcnt(0)
    v_mfma_f32_32x32x16_bf16 v[100:115], v[48:51], v[40:43], v[100:115]
    ds_read_b128 v[60:63], v23 offset:36864
    ds_read_b128 v[64:67], v27 offset:36864
    v_mfma_f32_32x32x16_bf16 v[116:131], v[52:55], v[40:43], v[116:131]
    ds_read_b64_tr_b16 v[68:69], v28 offset:14336
    ds_read_b64_tr_b16 v[70:71], v28 offset:14848
    v_mfma_f32_32x32x16_bf16 v[132:147], v[48:51], v[44:47], v[132:147]
    ds_read_b64_tr_b16 v[72:73], v29 offset:14336
    ds_read_b64_tr_b16 v[74:75], v29 offset:14848
    v_mfma_f32_32x32x16_bf16 v[148:163], v[52:55], v[44:47], v[148:163]
    s_waitcnt lgkmcnt(0)
    s_waitcnt vmcnt(10)
    s_barrier
    v_mfma_f32_32x32x16_bf16 v[100:115], v[68:71], v[60:63], v[100:115]
    ds_read_b128 v[40:43], v32 offset:36864
    ds_read_b128 v[44:47], v36 offset:36864
    v_mfma_f32_32x32x16_bf16 v[116:131], v[72:75], v[60:63], v[116:131]
    ds_read_b64_tr_b16 v[48:49], v28 offset:16384
    ds_read_b64_tr_b16 v[50:51], v28 offset:16896
    v_mfma_f32_32x32x16_bf16 v[132:147], v[68:71], v[64:67], v[132:147]
    ds_read_b64_tr_b16 v[52:53], v29 offset:16384
    ds_read_b64_tr_b16 v[54:55], v29 offset:16896
    v_mfma_f32_32x32x16_bf16 v[148:163], v[72:75], v[64:67], v[148:163]
    s_waitcnt lgkmcnt(0)
    v_mfma_f32_32x32x16_bf16 v[100:115], v[48:51], v[40:43], v[100:115]
    ds_read_b128 v[60:63], v33 offset:36864
    ds_read_b128 v[64:67], v37 offset:36864
    v_mfma_f32_32x32x16_bf16 v[116:131], v[52:55], v[40:43], v[116:131]
    ds_read_b64_tr_b16 v[68:69], v28 offset:18432
    ds_read_b64_tr_b16 v[70:71], v28 offset:18944
    v_mfma_f32_32x32x16_bf16 v[132:147], v[48:51], v[44:47], v[132:147]
    ds_read_b64_tr_b16 v[72:73], v29 offset:18432
    ds_read_b64_tr_b16 v[74:75], v29 offset:18944
    v_mfma_f32_32x32x16_bf16 v[148:163], v[52:55], v[44:47], v[148:163]
    s_waitcnt lgkmcnt(0)
    v_mfma_f32_32x32x16_bf16 v[100:115], v[68:71], v[60:63], v[100:115]
    ds_read_b128 v[40:43], v34 offset:36864
    ds_read_b128 v[44:47], v38 offset:36864
    v_mfma_f32_32x32x16_bf16 v[116:131], v[72:75], v[60:63], v[116:131]
    ds_read_b64_tr_b16 v[48:49], v28 offset:20480
    ds_read_b64_tr_b16 v[50:51], v28 offset:20992
    v_mfma_f32_32x32x16_bf16 v[132:147], v[68:71], v[64:67], v[132:147]
    ds_read_b64_tr_b16 v[52:53], v29 offset:20480
    ds_read_b64_tr_b16 v[54:55], v29 offset:20992
    v_mfma_f32_32x32x16_bf16 v[148:163], v[72:75], v[64:67], v[148:163]
    s_waitcnt lgkmcnt(0)
    v_mfma_f32_32x32x16_bf16 v[100:115], v[48:51], v[40:43], v[100:115]
    ds_read_b128 v[60:63], v35 offset:36864
    ds_read_b128 v[64:67], v39 offset:36864
    v_mfma_f32_32x32x16_bf16 v[116:131], v[52:55], v[40:43], v[116:131]
    ds_read_b64_tr_b16 v[68:69], v28 offset:22528
    ds_read_b64_tr_b16 v[70:71], v28 offset:23040
    v_mfma_f32_32x32x16_bf16 v[132:147], v[48:51], v[44:47], v[132:147]
    ds_read_b64_tr_b16 v[72:73], v29 offset:22528
    ds_read_b64_tr_b16 v[74:75], v29 offset:23040
    v_mfma_f32_32x32x16_bf16 v[148:163], v[52:55], v[44:47], v[148:163]
    s_waitcnt lgkmcnt(0)
    s_waitcnt vmcnt(0)
    s_barrier
    v_mfma_f32_32x32x16_bf16 v[100:115], v[68:71], v[60:63], v[100:115]
    ds_read_b128 v[40:43], v20 offset:4096
    ds_read_b128 v[44:47], v24 offset:4096
    v_mfma_f32_32x32x16_bf16 v[116:131], v[72:75], v[60:63], v[116:131]
    ds_read_b64_tr_b16 v[48:49], v28 offset:0
    ds_read_b64_tr_b16 v[50:51], v28 offset:512
    v_mfma_f32_32x32x16_bf16 v[132:147], v[68:71], v[64:67], v[132:147]
    ds_read_b64_tr_b16 v[52:53], v29 offset:0
    ds_read_b64_tr_b16 v[54:55], v29 offset:512
    v_mfma_f32_32x32x16_bf16 v[148:163], v[72:75], v[64:67], v[148:163]
    s_waitcnt lgkmcnt(0)
    v_mfma_f32_32x32x16_bf16 v[100:115], v[48:51], v[40:43], v[100:115]
    ds_read_b128 v[60:63], v21 offset:4096
    ds_read_b128 v[64:67], v25 offset:4096
    v_mfma_f32_32x32x16_bf16 v[116:131], v[52:55], v[40:43], v[116:131]
    ds_read_b64_tr_b16 v[68:69], v28 offset:2048
    ds_read_b64_tr_b16 v[70:71], v28 offset:2560
    v_mfma_f32_32x32x16_bf16 v[132:147], v[48:51], v[44:47], v[132:147]
    ds_read_b64_tr_b16 v[72:73], v29 offset:2048
    ds_read_b64_tr_b16 v[74:75], v29 offset:2560
    v_mfma_f32_32x32x16_bf16 v[148:163], v[52:55], v[44:47], v[148:163]
    s_waitcnt lgkmcnt(0)
    v_mfma_f32_32x32x16_bf16 v[100:115], v[68:71], v[60:63], v[100:115]
    ds_read_b128 v[40:43], v22 offset:4096
    ds_read_b128 v[44:47], v26 offset:4096
    v_mfma_f32_32x32x16_bf16 v[116:131], v[72:75], v[60:63], v[116:131]
    ds_read_b64_tr_b16 v[48:49], v28 offset:4096
    ds_read_b64_tr_b16 v[50:51], v28 offset:4608
    v_mfma_f32_32x32x16_bf16 v[132:147], v[68:71], v[64:67], v[132:147]
    ds_read_b64_tr_b16 v[52:53], v29 offset:4096
    ds_read_b64_tr_b16 v[54:55], v29 offset:4608
    v_mfma_f32_32x32x16_bf16 v[148:163], v[72:75], v[64:67], v[148:163]
    s_waitcnt lgkmcnt(0)
    v_mfma_f32_32x32x16_bf16 v[100:115], v[48:51], v[40:43], v[100:115]
    ds_read_b128 v[60:63], v23 offset:4096
    ds_read_b128 v[64:67], v27 offset:4096
    v_mfma_f32_32x32x16_bf16 v[116:131], v[52:55], v[40:43], v[116:131]
    ds_read_b64_tr_b16 v[68:69], v28 offset:6144
    ds_read_b64_tr_b16 v[70:71], v28 offset:6656
    v_mfma_f32_32x32x16_bf16 v[132:147], v[48:51], v[44:47], v[132:147]
    ds_read_b64_tr_b16 v[72:73], v29 offset:6144
    ds_read_b64_tr_b16 v[74:75], v29 offset:6656
    v_mfma_f32_32x32x16_bf16 v[148:163], v[52:55], v[44:47], v[148:163]
    s_waitcnt lgkmcnt(0)
    v_mfma_f32_32x32x16_bf16 v[100:115], v[68:71], v[60:63], v[100:115]
    v_mfma_f32_32x32x16_bf16 v[116:131], v[72:75], v[60:63], v[116:131]
    v_mfma_f32_32x32x16_bf16 v[132:147], v[68:71], v[64:67], v[132:147]
    v_mfma_f32_32x32x16_bf16 v[148:163], v[72:75], v[64:67], v[148:163]
    s_nop 7
    s_nop 7
    s_waitcnt vmcnt(0) lgkmcnt(0)
    v_and_b32 v1, 63, v0
    v_lshrrev_b32 v3, 5, v1
    v_lshlrev_b32 v5, 4, v3
    s_mov_b32 s64, 0xc0135761
    s_mov_b32 s65, 0xbdd2d3e8
    ds_read_b128 v[204:207], v5 offset:2048
    ds_read_b128 v[220:223], v5 offset:2304
    ds_read_b128 v[208:211], v5 offset:2080
    ds_read_b128 v[224:227], v5 offset:2336
    ds_read_b128 v[212:215], v5 offset:2112
    ds_read_b128 v[228:231], v5 offset:2368
    ds_read_b128 v[216:219], v5 offset:2144
    ds_read_b128 v[232:235], v5 offset:2400
    v_and_b32 v2, 31, v1
    s_lshl_b32 s58, s26, 6
    v_add_u32 v2, s58, v2
    v_add_u32 v2, 0, v2
    v_lshlrev_b32 v4, 3, v2
    ds_read_b64 v[200:201], v4 offset:0
    s_lshl_b32 s54, s52, 8
    v_add_u32 v6, s54, v2
    v_mul_u32_u24 v6, 3456, v6
    s_lshl_b32 s55, s53, 7
    v_lshlrev_b32 v7, 3, v3
    v_add_u32 v6, v6, v7
    v_add_u32 v6, s55, v6
    s_waitcnt lgkmcnt(0)
    v_fma_f32 v8, v201, v204, v220
    v_fma_f32 v100, v200, v100, v8
    v_mul_f32 v8, v100, v100
    v_mov_b32 v9, s64
    v_fma_f32 v8, v8, s65, v9
    v_mul_f32 v8, v8, v100
    v_exp_f32 v8, v8
    s_nop 0
    v_add_f32 v8, 1.0, v8
    v_rcp_f32 v8, v8
    s_nop 0
    v_mul_f32 v100, v100, v8
    v_fma_f32 v8, v201, v205, v221
    v_fma_f32 v101, v200, v101, v8
    v_mul_f32 v8, v101, v101
    v_mov_b32 v9, s64
    v_fma_f32 v8, v8, s65, v9
    v_mul_f32 v8, v8, v101
    v_exp_f32 v8, v8
    s_nop 0
    v_add_f32 v8, 1.0, v8
    v_rcp_f32 v8, v8
    s_nop 0
    v_mul_f32 v101, v101, v8
    v_fma_f32 v8, v201, v206, v222
    v_fma_f32 v102, v200, v102, v8
    v_mul_f32 v8, v102, v102
    v_mov_b32 v9, s64
    v_fma_f32 v8, v8, s65, v9
    v_mul_f32 v8, v8, v102
    v_exp_f32 v8, v8
    s_nop 0
    v_add_f32 v8, 1.0, v8
    v_rcp_f32 v8, v8
    s_nop 0
    v_mul_f32 v102, v102, v8
    v_fma_f32 v8, v201, v207, v223
    v_fma_f32 v103, v200, v103, v8
    v_mul_f32 v8, v103, v103
    v_mov_b32 v9, s64
    v_fma_f32 v8, v8, s65, v9
    v_mul_f32 v8, v8, v103
    v_exp_f32 v8, v8
    s_nop 0
    v_add_f32 v8, 1.0, v8
    v_rcp_f32 v8, v8
    s_nop 0
    v_mul_f32 v103, v103, v8
    v_fma_f32 v8, v201, v208, v224
    v_fma_f32 v104, v200, v104, v8
    v_mul_f32 v8, v104, v104
    v_mov_b32 v9, s64
    v_fma_f32 v8, v8, s65, v9
    v_mul_f32 v8, v8, v104
    v_exp_f32 v8, v8
    s_nop 0
    v_add_f32 v8, 1.0, v8
    v_rcp_f32 v8, v8
    s_nop 0
    v_mul_f32 v104, v104, v8
    v_fma_f32 v8, v201, v209, v225
    v_fma_f32 v105, v200, v105, v8
    v_mul_f32 v8, v105, v105
    v_mov_b32 v9, s64
    v_fma_f32 v8, v8, s65, v9
    v_mul_f32 v8, v8, v105
    v_exp_f32 v8, v8
    s_nop 0
    v_add_f32 v8, 1.0, v8
    v_rcp_f32 v8, v8
    s_nop 0
    v_mul_f32 v105, v105, v8
    v_fma_f32 v8, v201, v210, v226
    v_fma_f32 v106, v200, v106, v8
    v_mul_f32 v8, v106, v106
    v_mov_b32 v9, s64
    v_fma_f32 v8, v8, s65, v9
    v_mul_f32 v8, v8, v106
    v_exp_f32 v8, v8
    s_nop 0
    v_add_f32 v8, 1.0, v8
    v_rcp_f32 v8, v8
    s_nop 0
    v_mul_f32 v106, v106, v8
    v_fma_f32 v8, v201, v211, v227
    v_fma_f32 v107, v200, v107, v8
    v_mul_f32 v8, v107, v107
    v_mov_b32 v9, s64
    v_fma_f32 v8, v8, s65, v9
    v_mul_f32 v8, v8, v107
    v_exp_f32 v8, v8
    s_nop 0
    v_add_f32 v8, 1.0, v8
    v_rcp_f32 v8, v8
    s_nop 0
    v_mul_f32 v107, v107, v8
    v_fma_f32 v8, v201, v212, v228
    v_fma_f32 v108, v200, v108, v8
    v_mul_f32 v8, v108, v108
    v_mov_b32 v9, s64
    v_fma_f32 v8, v8, s65, v9
    v_mul_f32 v8, v8, v108
    v_exp_f32 v8, v8
    s_nop 0
    v_add_f32 v8, 1.0, v8
    v_rcp_f32 v8, v8
    s_nop 0
    v_mul_f32 v108, v108, v8
    v_fma_f32 v8, v201, v213, v229
    v_fma_f32 v109, v200, v109, v8
    v_mul_f32 v8, v109, v109
    v_mov_b32 v9, s64
    v_fma_f32 v8, v8, s65, v9
    v_mul_f32 v8, v8, v109
    v_exp_f32 v8, v8
    s_nop 0
    v_add_f32 v8, 1.0, v8
    v_rcp_f32 v8, v8
    s_nop 0
    v_mul_f32 v109, v109, v8
    v_fma_f32 v8, v201, v214, v230
    v_fma_f32 v110, v200, v110, v8
    v_mul_f32 v8, v110, v110
    v_mov_b32 v9, s64
    v_fma_f32 v8, v8, s65, v9
    v_mul_f32 v8, v8, v110
    v_exp_f32 v8, v8
    s_nop 0
    v_add_f32 v8, 1.0, v8
    v_rcp_f32 v8, v8
    s_nop 0
    v_mul_f32 v110, v110, v8
    v_fma_f32 v8, v201, v215, v231
    v_fma_f32 v111, v200, v111, v8
    v_mul_f32 v8, v111, v111
    v_mov_b32 v9, s64
    v_fma_f32 v8, v8, s65, v9
    v_mul_f32 v8, v8, v111
    v_exp_f32 v8, v8
    s_nop 0
    v_add_f32 v8, 1.0, v8
    v_rcp_f32 v8, v8
    s_nop 0
    v_mul_f32 v111, v111, v8
    v_fma_f32 v8, v201, v216, v232
    v_fma_f32 v112, v200, v112, v8
    v_mul_f32 v8, v112, v112
    v_mov_b32 v9, s64
    v_fma_f32 v8, v8, s65, v9
    v_mul_f32 v8, v8, v112
    v_exp_f32 v8, v8
    s_nop 0
    v_add_f32 v8, 1.0, v8
    v_rcp_f32 v8, v8
    s_nop 0
    v_mul_f32 v112, v112, v8
    v_fma_f32 v8, v201, v217, v233
    v_fma_f32 v113, v200, v113, v8
    v_mul_f32 v8, v113, v113
    v_mov_b32 v9, s64
    v_fma_f32 v8, v8, s65, v9
    v_mul_f32 v8, v8, v113
    v_exp_f32 v8, v8
    s_nop 0
    v_add_f32 v8, 1.0, v8
    v_rcp_f32 v8, v8
    s_nop 0
    v_mul_f32 v113, v113, v8
    v_fma_f32 v8, v201, v218, v234
    v_fma_f32 v114, v200, v114, v8
    v_mul_f32 v8, v114, v114
    v_mov_b32 v9, s64
    v_fma_f32 v8, v8, s65, v9
    v_mul_f32 v8, v8, v114
    v_exp_f32 v8, v8
    s_nop 0
    v_add_f32 v8, 1.0, v8
    v_rcp_f32 v8, v8
    s_nop 0
    v_mul_f32 v114, v114, v8
    v_fma_f32 v8, v201, v219, v235
    v_fma_f32 v115, v200, v115, v8
    v_mul_f32 v8, v115, v115
    v_mov_b32 v9, s64
    v_fma_f32 v8, v8, s65, v9
    v_mul_f32 v8, v8, v115
    v_exp_f32 v8, v8
    s_nop 0
    v_add_f32 v8, 1.0, v8
    v_rcp_f32 v8, v8
    s_nop 0
    v_mul_f32 v115, v115, v8
    v_cvt_pk_bf16_f32 v10, v100, v101
    v_cvt_pk_bf16_f32 v11, v102, v103
    v_cvt_pk_bf16_f32 v12, v104, v105
    v_cvt_pk_bf16_f32 v13, v106, v107
    v_cvt_pk_bf16_f32 v14, v108, v109
    v_cvt_pk_bf16_f32 v15, v110, v111
    v_cvt_pk_bf16_f32 v16, v112, v113
    v_cvt_pk_bf16_f32 v17, v114, v115
    buffer_store_dwordx2 v[10:11], v6, s[48:51], 0 offen offset:0
    buffer_store_dwordx2 v[12:13], v6, s[48:51], 0 offen offset:16
    buffer_store_dwordx2 v[14:15], v6, s[48:51], 0 offen offset:32
    buffer_store_dwordx2 v[16:17], v6, s[48:51], 0 offen offset:48
    s_nop 1
    v_and_b32 v2, 31, v1
    s_lshl_b32 s58, s26, 6
    v_add_u32 v2, s58, v2
    v_add_u32 v2, 32, v2
    v_lshlrev_b32 v4, 3, v2
    ds_read_b64 v[200:201], v4 offset:0
    s_lshl_b32 s54, s52, 8
    v_add_u32 v6, s54, v2
    v_mul_u32_u24 v6, 3456, v6
    s_lshl_b32 s55, s53, 7
    v_lshlrev_b32 v7, 3, v3
    v_add_u32 v6, v6, v7
    v_add_u32 v6, s55, v6
    s_waitcnt lgkmcnt(0)
    v_fma_f32 v8, v201, v204, v220
    v_fma_f32 v132, v200, v132, v8
    v_mul_f32 v8, v132, v132
    v_mov_b32 v9, s64
    v_fma_f32 v8, v8, s65, v9
    v_mul_f32 v8, v8, v132
    v_exp_f32 v8, v8
    s_nop 0
    v_add_f32 v8, 1.0, v8
    v_rcp_f32 v8, v8
    s_nop 0
    v_mul_f32 v132, v132, v8
    v_fma_f32 v8, v201, v205, v221
    v_fma_f32 v133, v200, v133, v8
    v_mul_f32 v8, v133, v133
    v_mov_b32 v9, s64
    v_fma_f32 v8, v8, s65, v9
    v_mul_f32 v8, v8, v133
    v_exp_f32 v8, v8
    s_nop 0
    v_add_f32 v8, 1.0, v8
    v_rcp_f32 v8, v8
    s_nop 0
    v_mul_f32 v133, v133, v8
    v_fma_f32 v8, v201, v206, v222
    v_fma_f32 v134, v200, v134, v8
    v_mul_f32 v8, v134, v134
    v_mov_b32 v9, s64
    v_fma_f32 v8, v8, s65, v9
    v_mul_f32 v8, v8, v134
    v_exp_f32 v8, v8
    s_nop 0
    v_add_f32 v8, 1.0, v8
    v_rcp_f32 v8, v8
    s_nop 0
    v_mul_f32 v134, v134, v8
    v_fma_f32 v8, v201, v207, v223
    v_fma_f32 v135, v200, v135, v8
    v_mul_f32 v8, v135, v135
    v_mov_b32 v9, s64
    v_fma_f32 v8, v8, s65, v9
    v_mul_f32 v8, v8, v135
    v_exp_f32 v8, v8
    s_nop 0
    v_add_f32 v8, 1.0, v8
    v_rcp_f32 v8, v8
    s_nop 0
    v_mul_f32 v135, v135, v8
    v_fma_f32 v8, v201, v208, v224
    v_fma_f32 v136, v200, v136, v8
    v_mul_f32 v8, v136, v136
    v_mov_b32 v9, s64
    v_fma_f32 v8, v8, s65, v9
    v_mul_f32 v8, v8, v136
    v_exp_f32 v8, v8
    s_nop 0
    v_add_f32 v8, 1.0, v8
    v_rcp_f32 v8, v8
    s_nop 0
    v_mul_f32 v136, v136, v8
    v_fma_f32 v8, v201, v209, v225
    v_fma_f32 v137, v200, v137, v8
    v_mul_f32 v8, v137, v137
    v_mov_b32 v9, s64
    v_fma_f32 v8, v8, s65, v9
    v_mul_f32 v8, v8, v137
    v_exp_f32 v8, v8
    s_nop 0
    v_add_f32 v8, 1.0, v8
    v_rcp_f32 v8, v8
    s_nop 0
    v_mul_f32 v137, v137, v8
    v_fma_f32 v8, v201, v210, v226
    v_fma_f32 v138, v200, v138, v8
    v_mul_f32 v8, v138, v138
    v_mov_b32 v9, s64
    v_fma_f32 v8, v8, s65, v9
    v_mul_f32 v8, v8, v138
    v_exp_f32 v8, v8
    s_nop 0
    v_add_f32 v8, 1.0, v8
    v_rcp_f32 v8, v8
    s_nop 0
    v_mul_f32 v138, v138, v8
    v_fma_f32 v8, v201, v211, v227
    v_fma_f32 v139, v200, v139, v8
    v_mul_f32 v8, v139, v139
    v_mov_b32 v9, s64
    v_fma_f32 v8, v8, s65, v9
    v_mul_f32 v8, v8, v139
    v_exp_f32 v8, v8
    s_nop 0
    v_add_f32 v8, 1.0, v8
    v_rcp_f32 v8, v8
    s_nop 0
    v_mul_f32 v139, v139, v8
    v_fma_f32 v8, v201, v212, v228
    v_fma_f32 v140, v200, v140, v8
    v_mul_f32 v8, v140, v140
    v_mov_b32 v9, s64
    v_fma_f32 v8, v8, s65, v9
    v_mul_f32 v8, v8, v140
    v_exp_f32 v8, v8
    s_nop 0
    v_add_f32 v8, 1.0, v8
    v_rcp_f32 v8, v8
    s_nop 0
    v_mul_f32 v140, v140, v8
    v_fma_f32 v8, v201, v213, v229
    v_fma_f32 v141, v200, v141, v8
    v_mul_f32 v8, v141, v141
    v_mov_b32 v9, s64
    v_fma_f32 v8, v8, s65, v9
    v_mul_f32 v8, v8, v141
    v_exp_f32 v8, v8
    s_nop 0
    v_add_f32 v8, 1.0, v8
    v_rcp_f32 v8, v8
    s_nop 0
    v_mul_f32 v141, v141, v8
    v_fma_f32 v8, v201, v214, v230
    v_fma_f32 v142, v200, v142, v8
    v_mul_f32 v8, v142, v142
    v_mov_b32 v9, s64
    v_fma_f32 v8, v8, s65, v9
    v_mul_f32 v8, v8, v142
    v_exp_f32 v8, v8
    s_nop 0
    v_add_f32 v8, 1.0, v8
    v_rcp_f32 v8, v8
    s_nop 0
    v_mul_f32 v142, v142, v8
    v_fma_f32 v8, v201, v215, v231
    v_fma_f32 v143, v200, v143, v8
    v_mul_f32 v8, v143, v143
    v_mov_b32 v9, s64
    v_fma_f32 v8, v8, s65, v9
    v_mul_f32 v8, v8, v143
    v_exp_f32 v8, v8
    s_nop 0
    v_add_f32 v8, 1.0, v8
    v_rcp_f32 v8, v8
    s_nop 0
    v_mul_f32 v143, v143, v8
    v_fma_f32 v8, v201, v216, v232
    v_fma_f32 v144, v200, v144, v8
    v_mul_f32 v8, v144, v144
    v_mov_b32 v9, s64
    v_fma_f32 v8, v8, s65, v9
    v_mul_f32 v8, v8, v144
    v_exp_f32 v8, v8
    s_nop 0
    v_add_f32 v8, 1.0, v8
    v_rcp_f32 v8, v8
    s_nop 0
    v_mul_f32 v144, v144, v8
    v_fma_f32 v8, v201, v217, v233
    v_fma_f32 v145, v200, v145, v8
    v_mul_f32 v8, v145, v145
    v_mov_b32 v9, s64
    v_fma_f32 v8, v8, s65, v9
    v_mul_f32 v8, v8, v145
    v_exp_f32 v8, v8
    s_nop 0
    v_add_f32 v8, 1.0, v8
    v_rcp_f32 v8, v8
    s_nop 0
    v_mul_f32 v145, v145, v8
    v_fma_f32 v8, v201, v218, v234
    v_fma_f32 v146, v200, v146, v8
    v_mul_f32 v8, v146, v146
    v_mov_b32 v9, s64
    v_fma_f32 v8, v8, s65, v9
    v_mul_f32 v8, v8, v146
    v_exp_f32 v8, v8
    s_nop 0
    v_add_f32 v8, 1.0, v8
    v_rcp_f32 v8, v8
    s_nop 0
    v_mul_f32 v146, v146, v8
    v_fma_f32 v8, v201, v219, v235
    v_fma_f32 v147, v200, v147, v8
    v_mul_f32 v8, v147, v147
    v_mov_b32 v9, s64
    v_fma_f32 v8, v8, s65, v9
    v_mul_f32 v8, v8, v147
    v_exp_f32 v8, v8
    s_nop 0
    v_add_f32 v8, 1.0, v8
    v_rcp_f32 v8, v8
    s_nop 0
    v_mul_f32 v147, v147, v8
    v_cvt_pk_bf16_f32 v10, v132, v133
    v_cvt_pk_bf16_f32 v11, v134, v135
    v_cvt_pk_bf16_f32 v12, v136, v137
    v_cvt_pk_bf16_f32 v13, v138, v139
    v_cvt_pk_bf16_f32 v14, v140, v141
    v_cvt_pk_bf16_f32 v15, v142, v143
    v_cvt_pk_bf16_f32 v16, v144, v145
    v_cvt_pk_bf16_f32 v17, v146, v147
    buffer_store_dwordx2 v[10:11], v6, s[48:51], 0 offen offset:0
    buffer_store_dwordx2 v[12:13], v6, s[48:51], 0 offen offset:16
    buffer_store_dwordx2 v[14:15], v6, s[48:51], 0 offen offset:32
    buffer_store_dwordx2 v[16:17], v6, s[48:51], 0 offen offset:48
    s_nop 1
    ds_read_b128 v[204:207], v5 offset:2176
    ds_read_b128 v[220:223], v5 offset:2432
    ds_read_b128 v[208:211], v5 offset:2208
    ds_read_b128 v[224:227], v5 offset:2464
    ds_read_b128 v[212:215], v5 offset:2240
    ds_read_b128 v[228:231], v5 offset:2496
    ds_read_b128 v[216:219], v5 offset:2272
    ds_read_b128 v[232:235], v5 offset:2528
    v_and_b32 v2, 31, v1
    s_lshl_b32 s58, s26, 6
    v_add_u32 v2, s58, v2
    v_add_u32 v2, 0, v2
    v_lshlrev_b32 v4, 3, v2
    ds_read_b64 v[200:201], v4 offset:0
    s_lshl_b32 s54, s52, 8
    v_add_u32 v6, s54, v2
    v_mul_u32_u24 v6, 3456, v6
    s_lshl_b32 s55, s53, 7
    v_lshlrev_b32 v7, 3, v3
    v_add_u32 v6, v6, v7
    v_add_u32 v6, s55, v6
    s_waitcnt lgkmcnt(0)
    v_fma_f32 v8, v201, v204, v220
    v_fma_f32 v116, v200, v116, v8
    v_mul_f32 v8, v116, v116
    v_mov_b32 v9, s64
    v_fma_f32 v8, v8, s65, v9
    v_mul_f32 v8, v8, v116
    v_exp_f32 v8, v8
    s_nop 0
    v_add_f32 v8, 1.0, v8
    v_rcp_f32 v8, v8
    s_nop 0
    v_mul_f32 v116, v116, v8
    v_fma_f32 v8, v201, v205, v221
    v_fma_f32 v117, v200, v117, v8
    v_mul_f32 v8, v117, v117
    v_mov_b32 v9, s64
    v_fma_f32 v8, v8, s65, v9
    v_mul_f32 v8, v8, v117
    v_exp_f32 v8, v8
    s_nop 0
    v_add_f32 v8, 1.0, v8
    v_rcp_f32 v8, v8
    s_nop 0
    v_mul_f32 v117, v117, v8
    v_fma_f32 v8, v201, v206, v222
    v_fma_f32 v118, v200, v118, v8
    v_mul_f32 v8, v118, v118
    v_mov_b32 v9, s64
    v_fma_f32 v8, v8, s65, v9
    v_mul_f32 v8, v8, v118
    v_exp_f32 v8, v8
    s_nop 0
    v_add_f32 v8, 1.0, v8
    v_rcp_f32 v8, v8
    s_nop 0
    v_mul_f32 v118, v118, v8
    v_fma_f32 v8, v201, v207, v223
    v_fma_f32 v119, v200, v119, v8
    v_mul_f32 v8, v119, v119
    v_mov_b32 v9, s64
    v_fma_f32 v8, v8, s65, v9
    v_mul_f32 v8, v8, v119
    v_exp_f32 v8, v8
    s_nop 0
    v_add_f32 v8, 1.0, v8
    v_rcp_f32 v8, v8
    s_nop 0
    v_mul_f32 v119, v119, v8
    v_fma_f32 v8, v201, v208, v224
    v_fma_f32 v120, v200, v120, v8
    v_mul_f32 v8, v120, v120
    v_mov_b32 v9, s64
    v_fma_f32 v8, v8, s65, v9
    v_mul_f32 v8, v8, v120
    v_exp_f32 v8, v8
    s_nop 0
    v_add_f32 v8, 1.0, v8
    v_rcp_f32 v8, v8
    s_nop 0
    v_mul_f32 v120, v120, v8
    v_fma_f32 v8, v201, v209, v225
    v_fma_f32 v121, v200, v121, v8
    v_mul_f32 v8, v121, v121
    v_mov_b32 v9, s64
    v_fma_f32 v8, v8, s65, v9
    v_mul_f32 v8, v8, v121
    v_exp_f32 v8, v8
    s_nop 0
    v_add_f32 v8, 1.0, v8
    v_rcp_f32 v8, v8
    s_nop 0
    v_mul_f32 v121, v121, v8
    v_fma_f32 v8, v201, v210, v226
    v_fma_f32 v122, v200, v122, v8
    v_mul_f32 v8, v122, v122
    v_mov_b32 v9, s64
    v_fma_f32 v8, v8, s65, v9
    v_mul_f32 v8, v8, v122
    v_exp_f32 v8, v8
    s_nop 0
    v_add_f32 v8, 1.0, v8
    v_rcp_f32 v8, v8
    s_nop 0
    v_mul_f32 v122, v122, v8
    v_fma_f32 v8, v201, v211, v227
    v_fma_f32 v123, v200, v123, v8
    v_mul_f32 v8, v123, v123
    v_mov_b32 v9, s64
    v_fma_f32 v8, v8, s65, v9
    v_mul_f32 v8, v8, v123
    v_exp_f32 v8, v8
    s_nop 0
    v_add_f32 v8, 1.0, v8
    v_rcp_f32 v8, v8
    s_nop 0
    v_mul_f32 v123, v123, v8
    v_fma_f32 v8, v201, v212, v228
    v_fma_f32 v124, v200, v124, v8
    v_mul_f32 v8, v124, v124
    v_mov_b32 v9, s64
    v_fma_f32 v8, v8, s65, v9
    v_mul_f32 v8, v8, v124
    v_exp_f32 v8, v8
    s_nop 0
    v_add_f32 v8, 1.0, v8
    v_rcp_f32 v8, v8
    s_nop 0
    v_mul_f32 v124, v124, v8
    v_fma_f32 v8, v201, v213, v229
    v_fma_f32 v125, v200, v125, v8
    v_mul_f32 v8, v125, v125
    v_mov_b32 v9, s64
    v_fma_f32 v8, v8, s65, v9
    v_mul_f32 v8, v8, v125
    v_exp_f32 v8, v8
    s_nop 0
    v_add_f32 v8, 1.0, v8
    v_rcp_f32 v8, v8
    s_nop 0
    v_mul_f32 v125, v125, v8
    v_fma_f32 v8, v201, v214, v230
    v_fma_f32 v126, v200, v126, v8
    v_mul_f32 v8, v126, v126
    v_mov_b32 v9, s64
    v_fma_f32 v8, v8, s65, v9
    v_mul_f32 v8, v8, v126
    v_exp_f32 v8, v8
    s_nop 0
    v_add_f32 v8, 1.0, v8
    v_rcp_f32 v8, v8
    s_nop 0
    v_mul_f32 v126, v126, v8
    v_fma_f32 v8, v201, v215, v231
    v_fma_f32 v127, v200, v127, v8
    v_mul_f32 v8, v127, v127
    v_mov_b32 v9, s64
    v_fma_f32 v8, v8, s65, v9
    v_mul_f32 v8, v8, v127
    v_exp_f32 v8, v8
    s_nop 0
    v_add_f32 v8, 1.0, v8
    v_rcp_f32 v8, v8
    s_nop 0
    v_mul_f32 v127, v127, v8
    v_fma_f32 v8, v201, v216, v232
    v_fma_f32 v128, v200, v128, v8
    v_mul_f32 v8, v128, v128
    v_mov_b32 v9, s64
    v_fma_f32 v8, v8, s65, v9
    v_mul_f32 v8, v8, v128
    v_exp_f32 v8, v8
    s_nop 0
    v_add_f32 v8, 1.0, v8
    v_rcp_f32 v8, v8
    s_nop 0
    v_mul_f32 v128, v128, v8
    v_fma_f32 v8, v201, v217, v233
    v_fma_f32 v129, v200, v129, v8
    v_mul_f32 v8, v129, v129
    v_mov_b32 v9, s64
    v_fma_f32 v8, v8, s65, v9
    v_mul_f32 v8, v8, v129
    v_exp_f32 v8, v8
    s_nop 0
    v_add_f32 v8, 1.0, v8
    v_rcp_f32 v8, v8
    s_nop 0
    v_mul_f32 v129, v129, v8
    v_fma_f32 v8, v201, v218, v234
    v_fma_f32 v130, v200, v130, v8
    v_mul_f32 v8, v130, v130
    v_mov_b32 v9, s64
    v_fma_f32 v8, v8, s65, v9
    v_mul_f32 v8, v8, v130
    v_exp_f32 v8, v8
    s_nop 0
    v_add_f32 v8, 1.0, v8
    v_rcp_f32 v8, v8
    s_nop 0
    v_mul_f32 v130, v130, v8
    v_fma_f32 v8, v201, v219, v235
    v_fma_f32 v131, v200, v131, v8
    v_mul_f32 v8, v131, v131
    v_mov_b32 v9, s64
    v_fma_f32 v8, v8, s65, v9
    v_mul_f32 v8, v8, v131
    v_exp_f32 v8, v8
    s_nop 0
    v_add_f32 v8, 1.0, v8
    v_rcp_f32 v8, v8
    s_nop 0
    v_mul_f32 v131, v131, v8
    v_cvt_pk_bf16_f32 v10, v116, v117
    v_cvt_pk_bf16_f32 v11, v118, v119
    v_cvt_pk_bf16_f32 v12, v120, v121
    v_cvt_pk_bf16_f32 v13, v122, v123
    v_cvt_pk_bf16_f32 v14, v124, v125
    v_cvt_pk_bf16_f32 v15, v126, v127
    v_cvt_pk_bf16_f32 v16, v128, v129
    v_cvt_pk_bf16_f32 v17, v130, v131
    buffer_store_dwordx2 v[10:11], v6, s[48:51], 0 offen offset:64
    buffer_store_dwordx2 v[12:13], v6, s[48:51], 0 offen offset:80
    buffer_store_dwordx2 v[14:15], v6, s[48:51], 0 offen offset:96
    buffer_store_dwordx2 v[16:17], v6, s[48:51], 0 offen offset:112
    s_nop 1
    v_and_b32 v2, 31, v1
    s_lshl_b32 s58, s26, 6
    v_add_u32 v2, s58, v2
    v_add_u32 v2, 32, v2
    v_lshlrev_b32 v4, 3, v2
    ds_read_b64 v[200:201], v4 offset:0
    s_lshl_b32 s54, s52, 8
    v_add_u32 v6, s54, v2
    v_mul_u32_u24 v6, 3456, v6
    s_lshl_b32 s55, s53, 7
    v_lshlrev_b32 v7, 3, v3
    v_add_u32 v6, v6, v7
    v_add_u32 v6, s55, v6
    s_waitcnt lgkmcnt(0)
    v_fma_f32 v8, v201, v204, v220
    v_fma_f32 v148, v200, v148, v8
    v_mul_f32 v8, v148, v148
    v_mov_b32 v9, s64
    v_fma_f32 v8, v8, s65, v9
    v_mul_f32 v8, v8, v148
    v_exp_f32 v8, v8
    s_nop 0
    v_add_f32 v8, 1.0, v8
    v_rcp_f32 v8, v8
    s_nop 0
    v_mul_f32 v148, v148, v8
    v_fma_f32 v8, v201, v205, v221
    v_fma_f32 v149, v200, v149, v8
    v_mul_f32 v8, v149, v149
    v_mov_b32 v9, s64
    v_fma_f32 v8, v8, s65, v9
    v_mul_f32 v8, v8, v149
    v_exp_f32 v8, v8
    s_nop 0
    v_add_f32 v8, 1.0, v8
    v_rcp_f32 v8, v8
    s_nop 0
    v_mul_f32 v149, v149, v8
    v_fma_f32 v8, v201, v206, v222
    v_fma_f32 v150, v200, v150, v8
    v_mul_f32 v8, v150, v150
    v_mov_b32 v9, s64
    v_fma_f32 v8, v8, s65, v9
    v_mul_f32 v8, v8, v150
    v_exp_f32 v8, v8
    s_nop 0
    v_add_f32 v8, 1.0, v8
    v_rcp_f32 v8, v8
    s_nop 0
    v_mul_f32 v150, v150, v8
    v_fma_f32 v8, v201, v207, v223
    v_fma_f32 v151, v200, v151, v8
    v_mul_f32 v8, v151, v151
    v_mov_b32 v9, s64
    v_fma_f32 v8, v8, s65, v9
    v_mul_f32 v8, v8, v151
    v_exp_f32 v8, v8
    s_nop 0
    v_add_f32 v8, 1.0, v8
    v_rcp_f32 v8, v8
    s_nop 0
    v_mul_f32 v151, v151, v8
    v_fma_f32 v8, v201, v208, v224
    v_fma_f32 v152, v200, v152, v8
    v_mul_f32 v8, v152, v152
    v_mov_b32 v9, s64
    v_fma_f32 v8, v8, s65, v9
    v_mul_f32 v8, v8, v152
    v_exp_f32 v8, v8
    s_nop 0
    v_add_f32 v8, 1.0, v8
    v_rcp_f32 v8, v8
    s_nop 0
    v_mul_f32 v152, v152, v8
    v_fma_f32 v8, v201, v209, v225
    v_fma_f32 v153, v200, v153, v8
    v_mul_f32 v8, v153, v153
    v_mov_b32 v9, s64
    v_fma_f32 v8, v8, s65, v9
    v_mul_f32 v8, v8, v153
    v_exp_f32 v8, v8
    s_nop 0
    v_add_f32 v8, 1.0, v8
    v_rcp_f32 v8, v8
    s_nop 0
    v_mul_f32 v153, v153, v8
    v_fma_f32 v8, v201, v210, v226
    v_fma_f32 v154, v200, v154, v8
    v_mul_f32 v8, v154, v154
    v_mov_b32 v9, s64
    v_fma_f32 v8, v8, s65, v9
    v_mul_f32 v8, v8, v154
    v_exp_f32 v8, v8
    s_nop 0
    v_add_f32 v8, 1.0, v8
    v_rcp_f32 v8, v8
    s_nop 0
    v_mul_f32 v154, v154, v8
    v_fma_f32 v8, v201, v211, v227
    v_fma_f32 v155, v200, v155, v8
    v_mul_f32 v8, v155, v155
    v_mov_b32 v9, s64
    v_fma_f32 v8, v8, s65, v9
    v_mul_f32 v8, v8, v155
    v_exp_f32 v8, v8
    s_nop 0
    v_add_f32 v8, 1.0, v8
    v_rcp_f32 v8, v8
    s_nop 0
    v_mul_f32 v155, v155, v8
    v_fma_f32 v8, v201, v212, v228
    v_fma_f32 v156, v200, v156, v8
    v_mul_f32 v8, v156, v156
    v_mov_b32 v9, s64
    v_fma_f32 v8, v8, s65, v9
    v_mul_f32 v8, v8, v156
    v_exp_f32 v8, v8
    s_nop 0
    v_add_f32 v8, 1.0, v8
    v_rcp_f32 v8, v8
    s_nop 0
    v_mul_f32 v156, v156, v8
    v_fma_f32 v8, v201, v213, v229
    v_fma_f32 v157, v200, v157, v8
    v_mul_f32 v8, v157, v157
    v_mov_b32 v9, s64
    v_fma_f32 v8, v8, s65, v9
    v_mul_f32 v8, v8, v157
    v_exp_f32 v8, v8
    s_nop 0
    v_add_f32 v8, 1.0, v8
    v_rcp_f32 v8, v8
    s_nop 0
    v_mul_f32 v157, v157, v8
    v_fma_f32 v8, v201, v214, v230
    v_fma_f32 v158, v200, v158, v8
    v_mul_f32 v8, v158, v158
    v_mov_b32 v9, s64
    v_fma_f32 v8, v8, s65, v9
    v_mul_f32 v8, v8, v158
    v_exp_f32 v8, v8
    s_nop 0
    v_add_f32 v8, 1.0, v8
    v_rcp_f32 v8, v8
    s_nop 0
    v_mul_f32 v158, v158, v8
    v_fma_f32 v8, v201, v215, v231
    v_fma_f32 v159, v200, v159, v8
    v_mul_f32 v8, v159, v159
    v_mov_b32 v9, s64
    v_fma_f32 v8, v8, s65, v9
    v_mul_f32 v8, v8, v159
    v_exp_f32 v8, v8
    s_nop 0
    v_add_f32 v8, 1.0, v8
    v_rcp_f32 v8, v8
    s_nop 0
    v_mul_f32 v159, v159, v8
    v_fma_f32 v8, v201, v216, v232
    v_fma_f32 v160, v200, v160, v8
    v_mul_f32 v8, v160, v160
    v_mov_b32 v9, s64
    v_fma_f32 v8, v8, s65, v9
    v_mul_f32 v8, v8, v160
    v_exp_f32 v8, v8
    s_nop 0
    v_add_f32 v8, 1.0, v8
    v_rcp_f32 v8, v8
    s_nop 0
    v_mul_f32 v160, v160, v8
    v_fma_f32 v8, v201, v217, v233
    v_fma_f32 v161, v200, v161, v8
    v_mul_f32 v8, v161, v161
    v_mov_b32 v9, s64
    v_fma_f32 v8, v8, s65, v9
    v_mul_f32 v8, v8, v161
    v_exp_f32 v8, v8
    s_nop 0
    v_add_f32 v8, 1.0, v8
    v_rcp_f32 v8, v8
    s_nop 0
    v_mul_f32 v161, v161, v8
    v_fma_f32 v8, v201, v218, v234
    v_fma_f32 v162, v200, v162, v8
    v_mul_f32 v8, v162, v162
    v_mov_b32 v9, s64
    v_fma_f32 v8, v8, s65, v9
    v_mul_f32 v8, v8, v162
    v_exp_f32 v8, v8
    s_nop 0
    v_add_f32 v8, 1.0, v8
    v_rcp_f32 v8, v8
    s_nop 0
    v_mul_f32 v162, v162, v8
    v_fma_f32 v8, v201, v219, v235
    v_fma_f32 v163, v200, v163, v8
    v_mul_f32 v8, v163, v163
    v_mov_b32 v9, s64
    v_fma_f32 v8, v8, s65, v9
    v_mul_f32 v8, v8, v163
    v_exp_f32 v8, v8
    s_nop 0
    v_add_f32 v8, 1.0, v8
    v_rcp_f32 v8, v8
    s_nop 0
    v_mul_f32 v163, v163, v8
    v_cvt_pk_bf16_f32 v10, v148, v149
    v_cvt_pk_bf16_f32 v11, v150, v151
    v_cvt_pk_bf16_f32 v12, v152, v153
    v_cvt_pk_bf16_f32 v13, v154, v155
    v_cvt_pk_bf16_f32 v14, v156, v157
    v_cvt_pk_bf16_f32 v15, v158, v159
    v_cvt_pk_bf16_f32 v16, v160, v161
    v_cvt_pk_bf16_f32 v17, v162, v163
    buffer_store_dwordx2 v[10:11], v6, s[48:51], 0 offen offset:64
    buffer_store_dwordx2 v[12:13], v6, s[48:51], 0 offen offset:80
    buffer_store_dwordx2 v[14:15], v6, s[48:51], 0 offen offset:96
    buffer_store_dwordx2 v[16:17], v6, s[48:51], 0 offen offset:112
    s_nop 1
    s_waitcnt vmcnt(0)
K3_end:
    s_endpgm
.globl k2_l0_kernel
.p2align 8
.type k2_l0_kernel,@function
k2_l0_kernel:
    s_mov_b32 s101, 0
    s_branch K2_body
.globl k2_l1_kernel
.p2align 8
.type k2_l1_kernel,@function
k2_l1_kernel:
    s_mov_b32 s101, 1
    s_branch K2_body
.p2align 8
K2_body:
    s_load_dwordx16 s[4:19], s[0:1], 0
    s_load_dwordx4 s[20:23], s[0:1], 64
    s_load_dwordx2 s[24:25], s[0:1], 80
    s_cmp_ge_u32 s2, 256
    s_cbranch_scc1 K2_end
    v_lshrrev_b32 v1, 6, v0
    s_nop 0
    v_readfirstlane_b32 s26, v1
    s_waitcnt lgkmcnt(0)
    s_and_b32 s52, s2, 31
    s_lshr_b32 s53, s2, 5
    s_add_u32 s40, s24, 3145728
    s_addc_u32 s41, s25, 0
    s_cmp_eq_u32 s101, 0
    s_cselect_b32 s40, s4, s40
    s_cselect_b32 s41, s5, s41
    s_mov_b32 s36, s40
    s_mov_b32 s37, s41
    s_mov_b32 s38, 2621440
    s_mov_b32 s39, 0x00020000
    s_mul_i32 s42, s101, 6291456
    s_add_u32 s40, s24, s42
    s_addc_u32 s41, s25, 0
    s_mov_b32 s44, s40
    s_mov_b32 s45, s41
    s_mov_b32 s46, 2621440
    s_mov_b32 s47, 0x00020000
    s_mul_i32 s42, s101, 262144
    s_add_u32 s42, s42, 21626880
    s_mov_b32 s32, s8
    s_mov_b32 s33, s9
    s_mov_b32 s34, 819200
    s_mov_b32 s35, 0x00020000
    s_add_u32 s28, s24, 9437184
    s_addc_u32 s29, s25, 0
    s_mov_b32 s30, 2621440
    s_mov_b32 s31, 0x00020000
    s_mul_i32 s43, s101, 131072
    s_add_u32 s43, s43, 20971520
    s_add_u32 s68, s24, s43
    s_addc_u32 s69, s25, 0
    s_mov_b32 s70, 131072
    s_mov_b32 s71, 0x00020000
    s_add_u32 s48, s24, s42
    s_addc_u32 s49, s25, 0
    s_mov_b32 s50, 131072
    s_mov_b32 s51, 0x00020000
    v_and_b32 v1, 63, v0
    v_and_b32 v2, 15, v1
    v_lshrrev_b32 v3, 4, v1
    s_lshl_b32 s54, s52, 6
    s_lshl_b32 s58, s26, 4
    s_add_u32 s54, s54, s58
    v_add_u32 v4, s54, v2
    v_mul_u32_u24 v5, 1280, v4
    s_mul_i32 s55, s53, 160
    v_lshlrev_b32 v6, 3, v3
    v_add_u32 v5, v5, v6
    v_add_u32 v30, s55, v5
    s_mul_i32 s58, s26, 320
    v_add_u32 v4, s58, v1
    v_add_u32 v4, 0, v4
    v_mov_b32 v7, 1639
    v_mul_u32_u24 v5, v7, v4
    v_lshrrev_b32 v5, 14, v5
    v_mul_u32_u24 v7, 10, v5
    v_sub_u32 v6, v4, v7
    v_and_b32 v7, 0x73, v5
    v_and_b32 v8, 4, v5
    v_lshlrev_b32 v8, 1, v8
    v_or_b32 v7, v7, v8
    v_and_b32 v8, 8, v5
    v_lshrrev_b32 v8, 1, v8
    v_or_b32 v7, v7, v8
    v_mul_u32_u24 v7, 1280, v7
    v_lshlrev_b32 v6, 4, v6
    v_add_u32 v14, v7, v6
    v_add_u32 v4, s58, v1
    v_add_u32 v4, 64, v4
    v_mov_b32 v7, 1639
    v_mul_u32_u24 v5, v7, v4
    v_lshrrev_b32 v5, 14, v5
    v_mul_u32_u24 v7, 10, v5
    v_sub_u32 v6, v4, v7
    v_and_b32 v7, 0x73, v5
    v_and_b32 v8, 4, v5
    v_lshlrev_b32 v8, 1, v8
    v_or_b32 v7, v7, v8
    v_and_b32 v8, 8, v5
    v_lshrrev_b32 v8, 1, v8
    v_or_b32 v7, v7, v8
    v_mul_u32_u24 v7, 1280, v7
    v_lshlrev_b32 v6, 4, v6
    v_add_u32 v15, v7, v6
    v_add_u32 v4, s58, v1
    v_add_u32 v4, 128, v4
    v_mov_b32 v7, 1639
    v_mul_u32_u24 v5, v7, v4
    v_lshrrev_b32 v5, 14, v5
    v_mul_u32_u24 v7, 10, v5
    v_sub_u32 v6, v4, v7
    v_and_b32 v7, 0x73, v5
    v_and_b32 v8, 4, v5
    v_lshlrev_b32 v8, 1, v8
    v_or_b32 v7, v7, v8
    v_and_b32 v8, 8, v5
    v_lshrrev_b32 v8, 1, v8
    v_or_b32 v7, v7, v8
    v_mul_u32_u24 v7, 1280, v7
    v_lshlrev_b32 v6, 4, v6
    v_add_u32 v16, v7, v6
    v_add_u32 v4, s58, v1
    v_add_u32 v4, 192, v4
    v_mov_b32 v7, 1639
    v_mul_u32_u24 v5, v7, v4
    v_lshrrev_b32 v5, 14, v5
    v_mul_u32_u24 v7, 10, v5
    v_sub_u32 v6, v4, v7
    v_and_b32 v7, 0x73, v5
    v_and_b32 v8, 4, v5
    v_lshlrev_b32 v8, 1, v8
    v_or_b32 v7, v7, v8
    v_and_b32 v8, 8, v5
    v_lshrrev_b32 v8, 1, v8
    v_or_b32 v7, v7, v8
    v_mul_u32_u24 v7, 1280, v7
    v_lshlrev_b32 v6, 4, v6
    v_add_u32 v17, v7, v6
    v_add_u32 v4, s58, v1
    v_add_u32 v4, 256, v4
    v_mov_b32 v7, 1639
    v_mul_u32_u24 v5, v7, v4
    v_lshrrev_b32 v5, 14, v5
    v_mul_u32_u24 v7, 10, v5
    v_sub_u32 v6, v4, v7
    v_and_b32 v7, 0x73, v5
    v_and_b32 v8, 4, v5
    v_lshlrev_b32 v8, 1, v8
    v_or_b32 v7, v7, v8
    v_and_b32 v8, 8, v5
    v_lshrrev_b32 v8, 1, v8
    v_or_b32 v7, v7, v8
    v_mul_u32_u24 v7, 1280, v7
    v_lshlrev_b32 v6, 4, v6
    v_add_u32 v18, v7, v6
    s_mul_i32 s60, s52, 81920
    s_mul_i32 s61, s53, 160
    s_lshl_b32 s62, s26, 12
    s_mul_i32 s63, s26, 5120
    s_lshl_b32 s58, s26, 4
    v_add_u32 v4, s58, v2
    v_and_b32 v5, 15, v4
    v_add_u32 v6, 0, v3
    v_xor_b32 v6, v6, v5
    v_lshlrev_b32 v6, 4, v6
    v_lshlrev_b32 v7, 8, v4
    v_add_u32 v20, v6, v7
    v_add_u32 v32, 0x8000, v20
    v_add_u32 v6, 4, v3
    v_xor_b32 v6, v6, v5
    v_lshlrev_b32 v6, 4, v6
    v_lshlrev_b32 v7, 8, v4
    v_add_u32 v21, v6, v7
    v_add_u32 v33, 0x8000, v21
    v_add_u32 v6, 8, v3
    v_xor_b32 v6, v6, v5
    v_lshlrev_b32 v6, 4, v6
    v_lshlrev_b32 v7, 8, v4
    v_add_u32 v22, v6, v7
    v_add_u32 v34, 0x8000, v22
    v_add_u32 v6, 12, v3
    v_xor_b32 v6, v6, v5
    v_lshlrev_b32 v6, 4, v6
    v_lshlrev_b32 v7, 8, v4
    v_add_u32 v23, v6, v7
    v_add_u32 v35, 0x8000, v23
    v_lshrrev_b32 v4, 2, v2
    v_and_b32 v5, 3, v2
    v_lshrrev_b32 v6, 1, v3
    v_lshlrev_b32 v6, 4, v6
    v_and_b32 v7, 1, v3
    v_lshlrev_b32 v7, 2, v7
    v_add_u32 v4, v4, v6
    v_add_u32 v4, v4, v7
    v_mul_u32_u24 v4, 160, v4
    v_lshlrev_b32 v5, 3, v5
    v_add_u32 v4, v4, v5
    v_add_u32 v24, 81920, v4
    v_add_u32 v25, 122880, v4
    s_lshl_b32 s58, s26, 15
    v_lshlrev_b32 v4, 7, v2
    v_lshlrev_b32 v5, 5, v3
    v_add_u32 v4, v4, v5
    v_add_u32 v4, s58, v4
    s_lshl_b32 s54, s52, 6
    v_add_u32 v5, s54, v2
    v_mul_u32_u24 v5, 1280, v5
    v_lshlrev_b32 v6, 4, v3
    v_add_u32 v5, v5, v6
    s_mul_i32 s59, s26, 320
    v_add_u32 v5, s59, v5
    v_cmp_gt_u32 s[72:73], 3, v3
    v_cmp_gt_u32 s[74:75], 2, v3
    buffer_load_dwordx4 v[40:43], v4, s[68:71], 0 offen offset:0
    buffer_load_dwordx4 v[44:47], v4, s[68:71], 0 offen offset:16
    buffer_load_dwordx4 v[48:51], v4, s[68:71], 0 offen offset:2048
    buffer_load_dwordx4 v[52:55], v4, s[68:71], 0 offen offset:2064
    s_mov_b32 s59, 0
    buffer_load_dwordx4 v[56:59], v5, s[28:31], s59 offen
    s_mov_b32 s59, 20480
    buffer_load_dwordx4 v[60:63], v5, s[28:31], s59 offen
    s_mov_b32 s59, 40960
    buffer_load_dwordx4 v[64:67], v5, s[28:31], s59 offen
    s_mov_b32 s59, 61440
    buffer_load_dwordx4 v[68:71], v5, s[28:31], s59 offen
    v_add_u32 v4, 4096, v4
    v_add_u32 v5, 40, v5
    buffer_load_dwordx4 v[72:75], v4, s[68:71], 0 offen offset:0
    buffer_load_dwordx4 v[76:79], v4, s[68:71], 0 offen offset:16
    buffer_load_dwordx4 v[80:83], v4, s[68:71], 0 offen offset:2048
    buffer_load_dwordx4 v[84:87], v4, s[68:71], 0 offen offset:2064
    s_mov_b32 s59, 0
    buffer_load_dwordx4 v[88:91], v5, s[28:31], s59 offen
    s_mov_b32 s59, 20480
    buffer_load_dwordx4 v[92:95], v5, s[28:31], s59 offen
    s_mov_b32 s59, 40960
    buffer_load_dwordx4 v[96:99], v5, s[28:31], s59 offen
    s_mov_b32 s59, 61440
    buffer_load_dwordx4 v[100:103], v5, s[28:31], s59 offen
    v_add_u32 v4, 4096, v4
    v_add_u32 v5, 40, v5
    buffer_load_dwordx4 v[104:107], v4, s[68:71], 0 offen offset:0
    buffer_load_dwordx4 v[108:111], v4, s[68:71], 0 offen offset:16
    buffer_load_dwordx4 v[112:115], v4, s[68:71], 0 offen offset:2048
    buffer_load_dwordx4 v[116:119], v4, s[68:71], 0 offen offset:2064
    s_mov_b32 s59, 0
    buffer_load_dwordx4 v[120:123], v5, s[28:31], s59 offen
    s_mov_b32 s59, 20480
    buffer_load_dwordx4 v[124:127], v5, s[28:31], s59 offen
    s_mov_b32 s59, 40960
    buffer_load_dwordx4 v[128:131], v5, s[28:31], s59 offen
    s_mov_b32 s59, 61440
    buffer_load_dwordx4 v[132:135], v5, s[28:31], s59 offen
    v_add_u32 v4, 4096, v4
    v_add_u32 v5, 40, v5
    buffer_load_dwordx4 v[136:139], v4, s[68:71], 0 offen offset:0
    buffer_load_dwordx4 v[140:143], v4, s[68:71], 0 offen offset:16
    buffer_load_dwordx4 v[144:147], v4, s[68:71], 0 offen offset:2048
    buffer_load_dwordx4 v[148:151], v4, s[68:71], 0 offen offset:2064
    s_mov_b32 s59, 0
    buffer_load_dwordx4 v[152:155], v5, s[28:31], s59 offen
    s_mov_b32 s59, 20480
    buffer_load_dwordx4 v[156:159], v5, s[28:31], s59 offen
    s_mov_b32 s59, 40960
    buffer_load_dwordx4 v[160:163], v5, s[28:31], s59 offen
    s_mov_b32 s59, 61440
    buffer_load_dwordx4 v[164:167], v5, s[28:31], s59 offen
    v_add_u32 v4, 4096, v4
    v_add_u32 v5, 40, v5
    buffer_load_dwordx4 v[168:171], v4, s[68:71], 0 offen offset:0
    buffer_load_dwordx4 v[172:175], v4, s[68:71], 0 offen offset:16
    buffer_load_dwordx4 v[176:179], v4, s[68:71], 0 offen offset:2048
    buffer_load_dwordx4 v[180:183], v4, s[68:71], 0 offen offset:2064
    s_mov_b32 s59, 0
    buffer_load_dwordx4 v[184:187], v5, s[28:31], s59 offen
    s_mov_b32 s59, 20480
    buffer_load_dwordx4 v[188:191], v5, s[28:31], s59 offen
    s_mov_b32 s59, 40960
    buffer_load_dwordx4 v[192:195], v5, s[28:31], s59 offen
    s_mov_b32 s59, 61440
    buffer_load_dwordx4 v[196:199], v5, s[28:31], s59 offen
    v_add_u32 v4, 4096, v4
    v_add_u32 v5, 40, v5
    s_waitcnt vmcnt(32)
    v_cvt_pk_bf16_f32 v200, v40, v41
    v_cvt_pk_bf16_f32 v201, v42, v43
    v_cvt_pk_bf16_f32 v202, v44, v45
    v_cvt_pk_bf16_f32 v203, v46, v47
    v_cvt_pk_bf16_f32 v204, v48, v49
    v_cvt_pk_bf16_f32 v205, v50, v51
    v_cvt_pk_bf16_f32 v206, v52, v53
    v_cvt_pk_bf16_f32 v207, v54, v55
    v_cndmask_b32 v56, 0, v56, s[72:73]
    v_cndmask_b32 v57, 0, v57, s[72:73]
    v_cndmask_b32 v58, 0, v58, s[74:75]
    v_cndmask_b32 v59, 0, v59, s[74:75]
    v_cndmask_b32 v60, 0, v60, s[72:73]
    v_cndmask_b32 v61, 0, v61, s[72:73]
    v_cndmask_b32 v62, 0, v62, s[74:75]
    v_cndmask_b32 v63, 0, v63, s[74:75]
    v_cndmask_b32 v64, 0, v64, s[72:73]
    v_cndmask_b32 v65, 0, v65, s[72:73]
    v_cndmask_b32 v66, 0, v66, s[74:75]
    v_cndmask_b32 v67, 0, v67, s[74:75]
    v_cndmask_b32 v68, 0, v68, s[72:73]
    v_cndmask_b32 v69, 0, v69, s[72:73]
    v_cndmask_b32 v70, 0, v70, s[74:75]
    v_cndmask_b32 v71, 0, v71, s[74:75]
    v_mov_b32 v208, 0
    v_mov_b32 v209, 0
    v_mov_b32 v210, 0
    v_mov_b32 v211, 0
    v_mov_b32 v212, 0
    v_mov_b32 v213, 0
    v_mov_b32 v214, 0
    v_mov_b32 v215, 0
    v_mov_b32 v216, 0
    v_mov_b32 v217, 0
    v_mov_b32 v218, 0
    v_mov_b32 v219, 0
    v_mov_b32 v220, 0
    v_mov_b32 v221, 0
    v_mov_b32 v222, 0
    v_mov_b32 v223, 0
    v_mov_b32 v224, 0
    v_mov_b32 v225, 0
    v_mov_b32 v226, 0
    v_mov_b32 v227, 0
    v_mov_b32 v228, 0
    v_mov_b32 v229, 0
    v_mov_b32 v230, 0
    v_mov_b32 v231, 0
    v_mov_b32 v232, 0
    v_mov_b32 v233, 0
    v_mov_b32 v234, 0
    v_mov_b32 v235, 0
    v_mov_b32 v236, 0
    v_mov_b32 v237, 0
    v_mov_b32 v238, 0
    v_mov_b32 v239, 0
    s_nop 1
    v_mfma_f32_16x16x32_bf16 v[208:211], v[200:203], v[56:59], v[208:211]
    v_mfma_f32_16x16x32_bf16 v[212:215], v[204:207], v[56:59], v[212:215]
    v_mfma_f32_16x16x32_bf16 v[216:219], v[200:203], v[60:63], v[216:219]
    v_mfma_f32_16x16x32_bf16 v[220:223], v[204:207], v[60:63], v[220:223]
    v_mfma_f32_16x16x32_bf16 v[224:227], v[200:203], v[64:67], v[224:227]
    v_mfma_f32_16x16x32_bf16 v[228:231], v[204:207], v[64:67], v[228:231]
    v_mfma_f32_16x16x32_bf16 v[232:235], v[200:203], v[68:71], v[232:235]
    v_mfma_f32_16x16x32_bf16 v[236:239], v[204:207], v[68:71], v[236:239]
    buffer_load_dwordx4 v[40:43], v4, s[68:71], 0 offen offset:0
    buffer_load_dwordx4 v[44:47], v4, s[68:71], 0 offen offset:16
    buffer_load_dwordx4 v[48:51], v4, s[68:71], 0 offen offset:2048
    buffer_load_dwordx4 v[52:55], v4, s[68:71], 0 offen offset:2064
    s_mov_b32 s59, 0
    buffer_load_dwordx4 v[56:59], v5, s[28:31], s59 offen
    s_mov_b32 s59, 20480
    buffer_load_dwordx4 v[60:63], v5, s[28:31], s59 offen
    s_mov_b32 s59, 40960
    buffer_load_dwordx4 v[64:67], v5, s[28:31], s59 offen
    s_mov_b32 s59, 61440
    buffer_load_dwordx4 v[68:71], v5, s[28:31], s59 offen
    v_add_u32 v4, 4096, v4
    v_add_u32 v5, 40, v5
    s_nop 3
    v_lshlrev_b32 v6, 2, v2
    v_add_u32 v6, 64, v6
    ds_bpermute_b32 v240, v6, v212
    ds_bpermute_b32 v241, v6, v220
    ds_bpermute_b32 v242, v6, v228
    ds_bpermute_b32 v243, v6, v236
    s_waitcnt lgkmcnt(0)
    v_add_f32 v240, 897988541, v240
    v_rcp_f32 v240, v240
    v_add_f32 v241, 897988541, v241
    v_rcp_f32 v241, v241
    v_add_f32 v242, 897988541, v242
    v_rcp_f32 v242, v242
    v_add_f32 v243, 897988541, v243
    v_rcp_f32 v243, v243
    s_nop 0
    s_mul_i32 s59, s26, 160
    s_add_u32 s59, s59, 0
    v_lshlrev_b32 v7, 2, v3
    v_add_u32 v7, s59, v7
    v_lshrrev_b32 v8, 7, v7
    v_lshlrev_b32 v8, 14, v8
    v_and_b32 v9, 127, v7
    v_lshrrev_b32 v9, 3, v9
    v_and_b32 v7, 7, v7
    v_lshlrev_b32 v7, 1, v7
    v_add_u32 v8, v8, v7
    v_xor_b32 v246, v9, v2
    v_lshlrev_b32 v246, 4, v246
    v_lshlrev_b32 v247, 8, v2
    v_add3_u32 v246, v246, v247, v8
    v_mul_f32 v208, v208, v240
    v_mul_f32 v209, v209, v240
    v_mul_f32 v210, v210, v240
    v_mul_f32 v211, v211, v240
    v_cvt_pk_bf16_f32 v244, v208, v209
    v_cvt_pk_bf16_f32 v245, v210, v211
    ds_write_b64 v246, v[244:245] offset:0
    v_mul_f32 v216, v216, v241
    v_mul_f32 v217, v217, v241
    v_mul_f32 v218, v218, v241
    v_mul_f32 v219, v219, v241
    v_cvt_pk_bf16_f32 v244, v216, v217
    v_cvt_pk_bf16_f32 v245, v218, v219
    ds_write_b64 v246, v[244:245] offset:4096
    v_mul_f32 v224, v224, v242
    v_mul_f32 v225, v225, v242
    v_mul_f32 v226, v226, v242
    v_mul_f32 v227, v227, v242
    v_cvt_pk_bf16_f32 v244, v224, v225
    v_cvt_pk_bf16_f32 v245, v226, v227
    ds_write_b64 v246, v[244:245] offset:8192
    v_mul_f32 v232, v232, v243
    v_mul_f32 v233, v233, v243
    v_mul_f32 v234, v234, v243
    v_mul_f32 v235, v235, v243
    v_cvt_pk_bf16_f32 v244, v232, v233
    v_cvt_pk_bf16_f32 v245, v234, v235
    ds_write_b64 v246, v[244:245] offset:12288
    v_lshlrev_b32 v7, 2, v3
    v_add_u32 v7, s59, v7
    v_add_u32 v7, 16, v7
    v_lshrrev_b32 v8, 7, v7
    v_lshlrev_b32 v8, 14, v8
    v_and_b32 v9, 127, v7
    v_lshrrev_b32 v9, 3, v9
    v_and_b32 v7, 7, v7
    v_lshlrev_b32 v7, 1, v7
    v_add_u32 v8, v8, v7
    v_xor_b32 v246, v9, v2
    v_lshlrev_b32 v246, 4, v246
    v_lshlrev_b32 v247, 8, v2
    v_add3_u32 v246, v246, v247, v8
    v_mul_f32 v212, v212, v240
    v_mul_f32 v213, v213, v240
    v_mul_f32 v214, v214, v240
    v_mul_f32 v215, v215, v240
    v_cvt_pk_bf16_f32 v244, v212, v213
    v_cvt_pk_bf16_f32 v245, v214, v215
    v_cmp_eq_u32 vcc, 0, v3
    s_and_saveexec_b64 s[56:57], vcc
    ds_write_b64 v246, v[244:245] offset:0
    s_mov_b64 exec, s[56:57]
    v_mul_f32 v220, v220, v241
    v_mul_f32 v221, v221, v241
    v_mul_f32 v222, v222, v241
    v_mul_f32 v223, v223, v241
    v_cvt_pk_bf16_f32 v244, v220, v221
    v_cvt_pk_bf16_f32 v245, v222, v223
    v_cmp_eq_u32 vcc, 0, v3
    s_and_saveexec_b64 s[56:57], vcc
    ds_write_b64 v246, v[244:245] offset:4096
    s_mov_b64 exec, s[56:57]
    v_mul_f32 v228, v228, v242
    v_mul_f32 v229, v229, v242
    v_mul_f32 v230, v230, v242
    v_mul_f32 v231, v231, v242
    v_cvt_pk_bf16_f32 v244, v228, v229
    v_cvt_pk_bf16_f32 v245, v230, v231
    v_cmp_eq_u32 vcc, 0, v3
    s_and_saveexec_b64 s[56:57], vcc
    ds_write_b64 v246, v[244:245] offset:8192
    s_mov_b64 exec, s[56:57]
    v_mul_f32 v236, v236, v243
    v_mul_f32 v237, v237, v243
    v_mul_f32 v238, v238, v243
    v_mul_f32 v239, v239, v243
    v_cvt_pk_bf16_f32 v244, v236, v237
    v_cvt_pk_bf16_f32 v245, v238, v239
    v_cmp_eq_u32 vcc, 0, v3
    s_and_saveexec_b64 s[56:57], vcc
    ds_write_b64 v246, v[244:245] offset:12288
    s_mov_b64 exec, s[56:57]
    s_waitcnt vmcnt(32)
    v_cvt_pk_bf16_f32 v200, v72, v73
    v_cvt_pk_bf16_f32 v201, v74, v75
    v_cvt_pk_bf16_f32 v202, v76, v77
    v_cvt_pk_bf16_f32 v203, v78, v79
    v_cvt_pk_bf16_f32 v204, v80, v81
    v_cvt_pk_bf16_f32 v205, v82, v83
    v_cvt_pk_bf16_f32 v206, v84, v85
    v_cvt_pk_bf16_f32 v207, v86, v87
    v_cndmask_b32 v88, 0, v88, s[72:73]
    v_cndmask_b32 v89, 0, v89, s[72:73]
    v_cndmask_b32 v90, 0, v90, s[74:75]
    v_cndmask_b32 v91, 0, v91, s[74:75]
    v_cndmask_b32 v92, 0, v92, s[72:73]
    v_cndmask_b32 v93, 0, v93, s[72:73]
    v_cndmask_b32 v94, 0, v94, s[74:75]
    v_cndmask_b32 v95, 0, v95, s[74:75]
    v_cndmask_b32 v96, 0, v96, s[72:73]
    v_cndmask_b32 v97, 0, v97, s[72:73]
    v_cndmask_b32 v98, 0, v98, s[74:75]
    v_cndmask_b32 v99, 0, v99, s[74:75]
    v_cndmask_b32 v100, 0, v100, s[72:73]
    v_cndmask_b32 v101, 0, v101, s[72:73]
    v_cndmask_b32 v102, 0, v102, s[74:75]
    v_cndmask_b32 v103, 0, v103, s[74:75]
    v_mov_b32 v208, 0
    v_mov_b32 v209, 0
    v_mov_b32 v210, 0
    v_mov_b32 v211, 0
    v_mov_b32 v212, 0
    v_mov_b32 v213, 0
    v_mov_b32 v214, 0
    v_mov_b32 v215, 0
    v_mov_b32 v216, 0
    v_mov_b32 v217, 0
    v_mov_b32 v218, 0
    v_mov_b32 v219, 0
    v_mov_b32 v220, 0
    v_mov_b32 v221, 0
    v_mov_b32 v222, 0
    v_mov_b32 v223, 0
    v_mov_b32 v224, 0
    v_mov_b32 v225, 0
    v_mov_b32 v226, 0
    v_mov_b32 v227, 0
    v_mov_b32 v228, 0
    v_mov_b32 v229, 0
    v_mov_b32 v230, 0
    v_mov_b32 v231, 0
    v_mov_b32 v232, 0
    v_mov_b32 v233, 0
    v_mov_b32 v234, 0
    v_mov_b32 v235, 0
    v_mov_b32 v236, 0
    v_mov_b32 v237, 0
    v_mov_b32 v238, 0
    v_mov_b32 v239, 0
    s_nop 1
    v_mfma_f32_16x16x32_bf16 v[208:211], v[200:203], v[88:91], v[208:211]
    v_mfma_f32_16x16x32_bf16 v[212:215], v[204:207], v[88:91], v[212:215]
    v_mfma_f32_16x16x32_bf16 v[216:219], v[200:203], v[92:95], v[216:219]
    v_mfma_f32_16x16x32_bf16 v[220:223], v[204:207], v[92:95], v[220:223]
    v_mfma_f32_16x16x32_bf16 v[224:227], v[200:203], v[96:99], v[224:227]
    v_mfma_f32_16x16x32_bf16 v[228:231], v[204:207], v[96:99], v[228:231]
    v_mfma_f32_16x16x32_bf16 v[232:235], v[200:203], v[100:103], v[232:235]
    v_mfma_f32_16x16x32_bf16 v[236:239], v[204:207], v[100:103], v[236:239]
    buffer_load_dwordx4 v[72:75], v4, s[68:71], 0 offen offset:0
    buffer_load_dwordx4 v[76:79], v4, s[68:71], 0 offen offset:16
    buffer_load_dwordx4 v[80:83], v4, s[68:71], 0 offen offset:2048
    buffer_load_dwordx4 v[84:87], v4, s[68:71], 0 offen offset:2064
    s_mov_b32 s59, 0
    buffer_load_dwordx4 v[88:91], v5, s[28:31], s59 offen
    s_mov_b32 s59, 20480
    buffer_load_dwordx4 v[92:95], v5, s[28:31], s59 offen
    s_mov_b32 s59, 40960
    buffer_load_dwordx4 v[96:99], v5, s[28:31], s59 offen
    s_mov_b32 s59, 61440
    buffer_load_dwordx4 v[100:103], v5, s[28:31], s59 offen
    v_add_u32 v4, 4096, v4
    v_add_u32 v5, 40, v5
    s_nop 3
    v_lshlrev_b32 v6, 2, v2
    v_add_u32 v6, 64, v6
    ds_bpermute_b32 v240, v6, v212
    ds_bpermute_b32 v241, v6, v220
    ds_bpermute_b32 v242, v6, v228
    ds_bpermute_b32 v243, v6, v236
    s_waitcnt lgkmcnt(0)
    v_add_f32 v240, 897988541, v240
    v_rcp_f32 v240, v240
    v_add_f32 v241, 897988541, v241
    v_rcp_f32 v241, v241
    v_add_f32 v242, 897988541, v242
    v_rcp_f32 v242, v242
    v_add_f32 v243, 897988541, v243
    v_rcp_f32 v243, v243
    s_nop 0
    s_mul_i32 s59, s26, 160
    s_add_u32 s59, s59, 20
    v_lshlrev_b32 v7, 2, v3
    v_add_u32 v7, s59, v7
    v_lshrrev_b32 v8, 7, v7
    v_lshlrev_b32 v8, 14, v8
    v_and_b32 v9, 127, v7
    v_lshrrev_b32 v9, 3, v9
    v_and_b32 v7, 7, v7
    v_lshlrev_b32 v7, 1, v7
    v_add_u32 v8, v8, v7
    v_xor_b32 v246, v9, v2
    v_lshlrev_b32 v246, 4, v246
    v_lshlrev_b32 v247, 8, v2
    v_add3_u32 v246, v246, v247, v8
    v_mul_f32 v208, v208, v240
    v_mul_f32 v209, v209, v240
    v_mul_f32 v210, v210, v240
    v_mul_f32 v211, v211, v240
    v_cvt_pk_bf16_f32 v244, v208, v209
    v_cvt_pk_bf16_f32 v245, v210, v211
    ds_write_b64 v246, v[244:245] offset:0
    v_mul_f32 v216, v216, v241
    v_mul_f32 v217, v217, v241
    v_mul_f32 v218, v218, v241
    v_mul_f32 v219, v219, v241
    v_cvt_pk_bf16_f32 v244, v216, v217
    v_cvt_pk_bf16_f32 v245, v218, v219
    ds_write_b64 v246, v[244:245] offset:4096
    v_mul_f32 v224, v224, v242
    v_mul_f32 v225, v225, v242
    v_mul_f32 v226, v226, v242
    v_mul_f32 v227, v227, v242
    v_cvt_pk_bf16_f32 v244, v224, v225
    v_cvt_pk_bf16_f32 v245, v226, v227
    ds_write_b64 v246, v[244:245] offset:8192
    v_mul_f32 v232, v232, v243
    v_mul_f32 v233, v233, v243
    v_mul_f32 v234, v234, v243
    v_mul_f32 v235, v235, v243
    v_cvt_pk_bf16_f32 v244, v232, v233
    v_cvt_pk_bf16_f32 v245, v234, v235
    ds_write_b64 v246, v[244:245] offset:12288
    v_lshlrev_b32 v7, 2, v3
    v_add_u32 v7, s59, v7
    v_add_u32 v7, 16, v7
    v_lshrrev_b32 v8, 7, v7
    v_lshlrev_b32 v8, 14, v8
    v_and_b32 v9, 127, v7
    v_lshrrev_b32 v9, 3, v9
    v_and_b32 v7, 7, v7
    v_lshlrev_b32 v7, 1, v7
    v_add_u32 v8, v8, v7
    v_xor_b32 v246, v9, v2
    v_lshlrev_b32 v246, 4, v246
    v_lshlrev_b32 v247, 8, v2
    v_add3_u32 v246, v246, v247, v8
    v_mul_f32 v212, v212, v240
    v_mul_f32 v213, v213, v240
    v_mul_f32 v214, v214, v240
    v_mul_f32 v215, v215, v240
    v_cvt_pk_bf16_f32 v244, v212, v213
    v_cvt_pk_bf16_f32 v245, v214, v215
    v_cmp_eq_u32 vcc, 0, v3
    s_and_saveexec_b64 s[56:57], vcc
    ds_write_b64 v246, v[244:245] offset:0
    s_mov_b64 exec, s[56:57]
    v_mul_f32 v220, v220, v241
    v_mul_f32 v221, v221, v241
    v_mul_f32 v222, v222, v241
    v_mul_f32 v223, v223, v241
    v_cvt_pk_bf16_f32 v244, v220, v221
    v_cvt_pk_bf16_f32 v245, v222, v223
    v_cmp_eq_u32 vcc, 0, v3
    s_and_saveexec_b64 s[56:57], vcc
    ds_write_b64 v246, v[244:245] offset:4096
    s_mov_b64 exec, s[56:57]
    v_mul_f32 v228, v228, v242
    v_mul_f32 v229, v229, v242
    v_mul_f32 v230, v230, v242
    v_mul_f32 v231, v231, v242
    v_cvt_pk_bf16_f32 v244, v228, v229
    v_cvt_pk_bf16_f32 v245, v230, v231
    v_cmp_eq_u32 vcc, 0, v3
    s_and_saveexec_b64 s[56:57], vcc
    ds_write_b64 v246, v[244:245] offset:8192
    s_mov_b64 exec, s[56:57]
    v_mul_f32 v236, v236, v243
    v_mul_f32 v237, v237, v243
    v_mul_f32 v238, v238, v243
    v_mul_f32 v239, v239, v243
    v_cvt_pk_bf16_f32 v244, v236, v237
    v_cvt_pk_bf16_f32 v245, v238, v239
    v_cmp_eq_u32 vcc, 0, v3
    s_and_saveexec_b64 s[56:57], vcc
    ds_write_b64 v246, v[244:245] offset:12288
    s_mov_b64 exec, s[56:57]
    s_waitcnt vmcnt(32)
    v_cvt_pk_bf16_f32 v200, v104, v105
    v_cvt_pk_bf16_f32 v201, v106, v107
    v_cvt_pk_bf16_f32 v202, v108, v109
    v_cvt_pk_bf16_f32 v203, v110, v111
    v_cvt_pk_bf16_f32 v204, v112, v113
    v_cvt_pk_bf16_f32 v205, v114, v115
    v_cvt_pk_bf16_f32 v206, v116, v117
    v_cvt_pk_bf16_f32 v207, v118, v119
    v_cndmask_b32 v120, 0, v120, s[72:73]
    v_cndmask_b32 v121, 0, v121, s[72:73]
    v_cndmask_b32 v122, 0, v122, s[74:75]
    v_cndmask_b32 v123, 0, v123, s[74:75]
    v_cndmask_b32 v124, 0, v124, s[72:73]
    v_cndmask_b32 v125, 0, v125, s[72:73]
    v_cndmask_b32 v126, 0, v126, s[74:75]
    v_cndmask_b32 v127, 0, v127, s[74:75]
    v_cndmask_b32 v128, 0, v128, s[72:73]
    v_cndmask_b32 v129, 0, v129, s[72:73]
    v_cndmask_b32 v130, 0, v130, s[74:75]
    v_cndmask_b32 v131, 0, v131, s[74:75]
    v_cndmask_b32 v132, 0, v132, s[72:73]
    v_cndmask_b32 v133, 0, v133, s[72:73]
    v_cndmask_b32 v134, 0, v134, s[74:75]
    v_cndmask_b32 v135, 0, v135, s[74:75]
    v_mov_b32 v208, 0
    v_mov_b32 v209, 0
    v_mov_b32 v210, 0
    v_mov_b32 v211, 0
    v_mov_b32 v212, 0
    v_mov_b32 v213, 0
    v_mov_b32 v214, 0
    v_mov_b32 v215, 0
    v_mov_b32 v216, 0
    v_mov_b32 v217, 0
    v_mov_b32 v218, 0
    v_mov_b32 v219, 0
    v_mov_b32 v220, 0
    v_mov_b32 v221, 0
    v_mov_b32 v222, 0
    v_mov_b32 v223, 0
    v_mov_b32 v224, 0
    v_mov_b32 v225, 0
    v_mov_b32 v226, 0
    v_mov_b32 v227, 0
    v_mov_b32 v228, 0
    v_mov_b32 v229, 0
    v_mov_b32 v230, 0
    v_mov_b32 v231, 0
    v_mov_b32 v232, 0
    v_mov_b32 v233, 0
    v_mov_b32 v234, 0
    v_mov_b32 v235, 0
    v_mov_b32 v236, 0
    v_mov_b32 v237, 0
    v_mov_b32 v238, 0
    v_mov_b32 v239, 0
    s_nop 1
    v_mfma_f32_16x16x32_bf16 v[208:211], v[200:203], v[120:123], v[208:211]
    v_mfma_f32_16x16x32_bf16 v[212:215], v[204:207], v[120:123], v[212:215]
    v_mfma_f32_16x16x32_bf16 v[216:219], v[200:203], v[124:127], v[216:219]
    v_mfma_f32_16x16x32_bf16 v[220:223], v[204:207], v[124:127], v[220:223]
    v_mfma_f32_16x16x32_bf16 v[224:227], v[200:203], v[128:131], v[224:227]
    v_mfma_f32_16x16x32_bf16 v[228:231], v[204:207], v[128:131], v[228:231]
    v_mfma_f32_16x16x32_bf16 v[232:235], v[200:203], v[132:135], v[232:235]
    v_mfma_f32_16x16x32_bf16 v[236:239], v[204:207], v[132:135], v[236:239]
    buffer_load_dwordx4 v[104:107], v4, s[68:71], 0 offen offset:0
    buffer_load_dwordx4 v[108:111], v4, s[68:71], 0 offen offset:16
    buffer_load_dwordx4 v[112:115], v4, s[68:71], 0 offen offset:2048
    buffer_load_dwordx4 v[116:119], v4, s[68:71], 0 offen offset:2064
    s_mov_b32 s59, 0
    buffer_load_dwordx4 v[120:123], v5, s[28:31], s59 offen
    s_mov_b32 s59, 20480
    buffer_load_dwordx4 v[124:127], v5, s[28:31], s59 offen
    s_mov_b32 s59, 40960
    buffer_load_dwordx4 v[128:131], v5, s[28:31], s59 offen
    s_mov_b32 s59, 61440
    buffer_load_dwordx4 v[132:135], v5, s[28:31], s59 offen
    v_add_u32 v4, 4096, v4
    v_add_u32 v5, 40, v5
    s_nop 3
    v_lshlrev_b32 v6, 2, v2
    v_add_u32 v6, 64, v6
    ds_bpermute_b32 v240, v6, v212
    ds_bpermute_b32 v241, v6, v220
    ds_bpermute_b32 v242, v6, v228
    ds_bpermute_b32 v243, v6, v236
    s_waitcnt lgkmcnt(0)
    v_add_f32 v240, 897988541, v240
    v_rcp_f32 v240, v240
    v_add_f32 v241, 897988541, v241
    v_rcp_f32 v241, v241
    v_add_f32 v242, 897988541, v242
    v_rcp_f32 v242, v242
    v_add_f32 v243, 897988541, v243
    v_rcp_f32 v243, v243
    s_nop 0
    s_mul_i32 s59, s26, 160
    s_add_u32 s59, s59, 40
    v_lshlrev_b32 v7, 2, v3
    v_add_u32 v7, s59, v7
    v_lshrrev_b32 v8, 7, v7
    v_lshlrev_b32 v8, 14, v8
    v_and_b32 v9, 127, v7
    v_lshrrev_b32 v9, 3, v9
    v_and_b32 v7, 7, v7
    v_lshlrev_b32 v7, 1, v7
    v_add_u32 v8, v8, v7
    v_xor_b32 v246, v9, v2
    v_lshlrev_b32 v246, 4, v246
    v_lshlrev_b32 v247, 8, v2
    v_add3_u32 v246, v246, v247, v8
    v_mul_f32 v208, v208, v240
    v_mul_f32 v209, v209, v240
    v_mul_f32 v210, v210, v240
    v_mul_f32 v211, v211, v240
    v_cvt_pk_bf16_f32 v244, v208, v209
    v_cvt_pk_bf16_f32 v245, v210, v211
    ds_write_b64 v246, v[244:245] offset:0
    v_mul_f32 v216, v216, v241
    v_mul_f32 v217, v217, v241
    v_mul_f32 v218, v218, v241
    v_mul_f32 v219, v219, v241
    v_cvt_pk_bf16_f32 v244, v216, v217
    v_cvt_pk_bf16_f32 v245, v218, v219
    ds_write_b64 v246, v[244:245] offset:4096
    v_mul_f32 v224, v224, v242
    v_mul_f32 v225, v225, v242
    v_mul_f32 v226, v226, v242
    v_mul_f32 v227, v227, v242
    v_cvt_pk_bf16_f32 v244, v224, v225
    v_cvt_pk_bf16_f32 v245, v226, v227
    ds_write_b64 v246, v[244:245] offset:8192
    v_mul_f32 v232, v232, v243
    v_mul_f32 v233, v233, v243
    v_mul_f32 v234, v234, v243
    v_mul_f32 v235, v235, v243
    v_cvt_pk_bf16_f32 v244, v232, v233
    v_cvt_pk_bf16_f32 v245, v234, v235
    ds_write_b64 v246, v[244:245] offset:12288
    v_lshlrev_b32 v7, 2, v3
    v_add_u32 v7, s59, v7
    v_add_u32 v7, 16, v7
    v_lshrrev_b32 v8, 7, v7
    v_lshlrev_b32 v8, 14, v8
    v_and_b32 v9, 127, v7
    v_lshrrev_b32 v9, 3, v9
    v_and_b32 v7, 7, v7
    v_lshlrev_b32 v7, 1, v7
    v_add_u32 v8, v8, v7
    v_xor_b32 v246, v9, v2
    v_lshlrev_b32 v246, 4, v246
    v_lshlrev_b32 v247, 8, v2
    v_add3_u32 v246, v246, v247, v8
    v_mul_f32 v212, v212, v240
    v_mul_f32 v213, v213, v240
    v_mul_f32 v214, v214, v240
    v_mul_f32 v215, v215, v240
    v_cvt_pk_bf16_f32 v244, v212, v213
    v_cvt_pk_bf16_f32 v245, v214, v215
    v_cmp_eq_u32 vcc, 0, v3
    s_and_saveexec_b64 s[56:57], vcc
    ds_write_b64 v246, v[244:245] offset:0
    s_mov_b64 exec, s[56:57]
    v_mul_f32 v220, v220, v241
    v_mul_f32 v221, v221, v241
    v_mul_f32 v222, v222, v241
    v_mul_f32 v223, v223, v241
    v_cvt_pk_bf16_f32 v244, v220, v221
    v_cvt_pk_bf16_f32 v245, v222, v223
    v_cmp_eq_u32 vcc, 0, v3
    s_and_saveexec_b64 s[56:57], vcc
    ds_write_b64 v246, v[244:245] offset:4096
    s_mov_b64 exec, s[56:57]
    v_mul_f32 v228, v228, v242
    v_mul_f32 v229, v229, v242
    v_mul_f32 v230, v230, v242
    v_mul_f32 v231, v231, v242
    v_cvt_pk_bf16_f32 v244, v228, v229
    v_cvt_pk_bf16_f32 v245, v230, v231
    v_cmp_eq_u32 vcc, 0, v3
    s_and_saveexec_b64 s[56:57], vcc
    ds_write_b64 v246, v[244:245] offset:8192
    s_mov_b64 exec, s[56:57]
    v_mul_f32 v236, v236, v243
    v_mul_f32 v237, v237, v243
    v_mul_f32 v238, v238, v243
    v_mul_f32 v239, v239, v243
    v_cvt_pk_bf16_f32 v244, v236, v237
    v_cvt_pk_bf16_f32 v245, v238, v239
    v_cmp_eq_u32 vcc, 0, v3
    s_and_saveexec_b64 s[56:57], vcc
    ds_write_b64 v246, v[244:245] offset:12288
    s_mov_b64 exec, s[56:57]
    s_waitcnt vmcnt(32)
    v_cvt_pk_bf16_f32 v200, v136, v137
    v_cvt_pk_bf16_f32 v201, v138, v139
    v_cvt_pk_bf16_f32 v202, v140, v141
    v_cvt_pk_bf16_f32 v203, v142, v143
    v_cvt_pk_bf16_f32 v204, v144, v145
    v_cvt_pk_bf16_f32 v205, v146, v147
    v_cvt_pk_bf16_f32 v206, v148, v149
    v_cvt_pk_bf16_f32 v207, v150, v151
    v_cndmask_b32 v152, 0, v152, s[72:73]
    v_cndmask_b32 v153, 0, v153, s[72:73]
    v_cndmask_b32 v154, 0, v154, s[74:75]
    v_cndmask_b32 v155, 0, v155, s[74:75]
    v_cndmask_b32 v156, 0, v156, s[72:73]
    v_cndmask_b32 v157, 0, v157, s[72:73]
    v_cndmask_b32 v158, 0, v158, s[74:75]
    v_cndmask_b32 v159, 0, v159, s[74:75]
    v_cndmask_b32 v160, 0, v160, s[72:73]
    v_cndmask_b32 v161, 0, v161, s[72:73]
    v_cndmask_b32 v162, 0, v162, s[74:75]
    v_cndmask_b32 v163, 0, v163, s[74:75]
    v_cndmask_b32 v164, 0, v164, s[72:73]
    v_cndmask_b32 v165, 0, v165, s[72:73]
    v_cndmask_b32 v166, 0, v166, s[74:75]
    v_cndmask_b32 v167, 0, v167, s[74:75]
    v_mov_b32 v208, 0
    v_mov_b32 v209, 0
    v_mov_b32 v210, 0
    v_mov_b32 v211, 0
    v_mov_b32 v212, 0
    v_mov_b32 v213, 0
    v_mov_b32 v214, 0
    v_mov_b32 v215, 0
    v_mov_b32 v216, 0
    v_mov_b32 v217, 0
    v_mov_b32 v218, 0
    v_mov_b32 v219, 0
    v_mov_b32 v220, 0
    v_mov_b32 v221, 0
    v_mov_b32 v222, 0
    v_mov_b32 v223, 0
    v_mov_b32 v224, 0
    v_mov_b32 v225, 0
    v_mov_b32 v226, 0
    v_mov_b32 v227, 0
    v_mov_b32 v228, 0
    v_mov_b32 v229, 0
    v_mov_b32 v230, 0
    v_mov_b32 v231, 0
    v_mov_b32 v232, 0
    v_mov_b32 v233, 0
    v_mov_b32 v234, 0
    v_mov_b32 v235, 0
    v_mov_b32 v236, 0
    v_mov_b32 v237, 0
    v_mov_b32 v238, 0
    v_mov_b32 v239, 0
    s_nop 1
    v_mfma_f32_16x16x32_bf16 v[208:211], v[200:203], v[152:155], v[208:211]
    v_mfma_f32_16x16x32_bf16 v[212:215], v[204:207], v[152:155], v[212:215]
    v_mfma_f32_16x16x32_bf16 v[216:219], v[200:203], v[156:159], v[216:219]
    v_mfma_f32_16x16x32_bf16 v[220:223], v[204:207], v[156:159], v[220:223]
    v_mfma_f32_16x16x32_bf16 v[224:227], v[200:203], v[160:163], v[224:227]
    v_mfma_f32_16x16x32_bf16 v[228:231], v[204:207], v[160:163], v[228:231]
    v_mfma_f32_16x16x32_bf16 v[232:235], v[200:203], v[164:167], v[232:235]
    v_mfma_f32_16x16x32_bf16 v[236:239], v[204:207], v[164:167], v[236:239]
    s_nop 7
    s_nop 1
    s_nop 3
    v_lshlrev_b32 v6, 2, v2
    v_add_u32 v6, 64, v6
    ds_bpermute_b32 v240, v6, v212
    ds_bpermute_b32 v241, v6, v220
    ds_bpermute_b32 v242, v6, v228
    ds_bpermute_b32 v243, v6, v236
    s_waitcnt lgkmcnt(0)
    v_add_f32 v240, 897988541, v240
    v_rcp_f32 v240, v240
    v_add_f32 v241, 897988541, v241
    v_rcp_f32 v241, v241
    v_add_f32 v242, 897988541, v242
    v_rcp_f32 v242, v242
    v_add_f32 v243, 897988541, v243
    v_rcp_f32 v243, v243
    s_nop 0
    s_mul_i32 s59, s26, 160
    s_add_u32 s59, s59, 60
    v_lshlrev_b32 v7, 2, v3
    v_add_u32 v7, s59, v7
    v_lshrrev_b32 v8, 7, v7
    v_lshlrev_b32 v8, 14, v8
    v_and_b32 v9, 127, v7
    v_lshrrev_b32 v9, 3, v9
    v_and_b32 v7, 7, v7
    v_lshlrev_b32 v7, 1, v7
    v_add_u32 v8, v8, v7
    v_xor_b32 v246, v9, v2
    v_lshlrev_b32 v246, 4, v246
    v_lshlrev_b32 v247, 8, v2
    v_add3_u32 v246, v246, v247, v8
    v_mul_f32 v208, v208, v240
    v_mul_f32 v209, v209, v240
    v_mul_f32 v210, v210, v240
    v_mul_f32 v211, v211, v240
    v_cvt_pk_bf16_f32 v244, v208, v209
    v_cvt_pk_bf16_f32 v245, v210, v211
    ds_write_b64 v246, v[244:245] offset:0
    v_mul_f32 v216, v216, v241
    v_mul_f32 v217, v217, v241
    v_mul_f32 v218, v218, v241
    v_mul_f32 v219, v219, v241
    v_cvt_pk_bf16_f32 v244, v216, v217
    v_cvt_pk_bf16_f32 v245, v218, v219
    ds_write_b64 v246, v[244:245] offset:4096
    v_mul_f32 v224, v224, v242
    v_mul_f32 v225, v225, v242
    v_mul_f32 v226, v226, v242
    v_mul_f32 v227, v227, v242
    v_cvt_pk_bf16_f32 v244, v224, v225
    v_cvt_pk_bf16_f32 v245, v226, v227
    ds_write_b64 v246, v[244:245] offset:8192
    v_mul_f32 v232, v232, v243
    v_mul_f32 v233, v233, v243
    v_mul_f32 v234, v234, v243
    v_mul_f32 v235, v235, v243
    v_cvt_pk_bf16_f32 v244, v232, v233
    v_cvt_pk_bf16_f32 v245, v234, v235
    ds_write_b64 v246, v[244:245] offset:12288
    v_lshlrev_b32 v7, 2, v3
    v_add_u32 v7, s59, v7
    v_add_u32 v7, 16, v7
    v_lshrrev_b32 v8, 7, v7
    v_lshlrev_b32 v8, 14, v8
    v_and_b32 v9, 127, v7
    v_lshrrev_b32 v9, 3, v9
    v_and_b32 v7, 7, v7
    v_lshlrev_b32 v7, 1, v7
    v_add_u32 v8, v8, v7
    v_xor_b32 v246, v9, v2
    v_lshlrev_b32 v246, 4, v246
    v_lshlrev_b32 v247, 8, v2
    v_add3_u32 v246, v246, v247, v8
    v_mul_f32 v212, v212, v240
    v_mul_f32 v213, v213, v240
    v_mul_f32 v214, v214, v240
    v_mul_f32 v215, v215, v240
    v_cvt_pk_bf16_f32 v244, v212, v213
    v_cvt_pk_bf16_f32 v245, v214, v215
    v_cmp_eq_u32 vcc, 0, v3
    s_and_saveexec_b64 s[56:57], vcc
    ds_write_b64 v246, v[244:245] offset:0
    s_mov_b64 exec, s[56:57]
    v_mul_f32 v220, v220, v241
    v_mul_f32 v221, v221, v241
    v_mul_f32 v222, v222, v241
    v_mul_f32 v223, v223, v241
    v_cvt_pk_bf16_f32 v244, v220, v221
    v_cvt_pk_bf16_f32 v245, v222, v223
    v_cmp_eq_u32 vcc, 0, v3
    s_and_saveexec_b64 s[56:57], vcc
    ds_write_b64 v246, v[244:245] offset:4096
    s_mov_b64 exec, s[56:57]
    v_mul_f32 v228, v228, v242
    v_mul_f32 v229, v229, v242
    v_mul_f32 v230, v230, v242
    v_mul_f32 v231, v231, v242
    v_cvt_pk_bf16_f32 v244, v228, v229
    v_cvt_pk_bf16_f32 v245, v230, v231
    v_cmp_eq_u32 vcc, 0, v3
    s_and_saveexec_b64 s[56:57], vcc
    ds_write_b64 v246, v[244:245] offset:8192
    s_mov_b64 exec, s[56:57]
    v_mul_f32 v236, v236, v243
    v_mul_f32 v237, v237, v243
    v_mul_f32 v238, v238, v243
    v_mul_f32 v239, v239, v243
    v_cvt_pk_bf16_f32 v244, v236, v237
    v_cvt_pk_bf16_f32 v245, v238, v239
    v_cmp_eq_u32 vcc, 0, v3
    s_and_saveexec_b64 s[56:57], vcc
    ds_write_b64 v246, v[244:245] offset:12288
    s_mov_b64 exec, s[56:57]
    s_waitcnt vmcnt(24)
    v_cvt_pk_bf16_f32 v200, v168, v169
    v_cvt_pk_bf16_f32 v201, v170, v171
    v_cvt_pk_bf16_f32 v202, v172, v173
    v_cvt_pk_bf16_f32 v203, v174, v175
    v_cvt_pk_bf16_f32 v204, v176, v177
    v_cvt_pk_bf16_f32 v205, v178, v179
    v_cvt_pk_bf16_f32 v206, v180, v181
    v_cvt_pk_bf16_f32 v207, v182, v183
    v_cndmask_b32 v184, 0, v184, s[72:73]
    v_cndmask_b32 v185, 0, v185, s[72:73]
    v_cndmask_b32 v186, 0, v186, s[74:75]
    v_cndmask_b32 v187, 0, v187, s[74:75]
    v_cndmask_b32 v188, 0, v188, s[72:73]
    v_cndmask_b32 v189, 0, v189, s[72:73]
    v_cndmask_b32 v190, 0, v190, s[74:75]
    v_cndmask_b32 v191, 0, v191, s[74:75]
    v_cndmask_b32 v192, 0, v192, s[72:73]
    v_cndmask_b32 v193, 0, v193, s[72:73]
    v_cndmask_b32 v194, 0, v194, s[74:75]
    v_cndmask_b32 v195, 0, v195, s[74:75]
    v_cndmask_b32 v196, 0, v196, s[72:73]
    v_cndmask_b32 v197, 0, v197, s[72:73]
    v_cndmask_b32 v198, 0, v198, s[74:75]
    v_cndmask_b32 v199, 0, v199, s[74:75]
    v_mov_b32 v208, 0
    v_mov_b32 v209, 0
    v_mov_b32 v210, 0
    v_mov_b32 v211, 0
    v_mov_b32 v212, 0
    v_mov_b32 v213, 0
    v_mov_b32 v214, 0
    v_mov_b32 v215, 0
    v_mov_b32 v216, 0
    v_mov_b32 v217, 0
    v_mov_b32 v218, 0
    v_mov_b32 v219, 0
    v_mov_b32 v220, 0
    v_mov_b32 v221, 0
    v_mov_b32 v222, 0
    v_mov_b32 v223, 0
    v_mov_b32 v224, 0
    v_mov_b32 v225, 0
    v_mov_b32 v226, 0
    v_mov_b32 v227, 0
    v_mov_b32 v228, 0
    v_mov_b32 v229, 0
    v_mov_b32 v230, 0
    v_mov_b32 v231, 0
    v_mov_b32 v232, 0
    v_mov_b32 v233, 0
    v_mov_b32 v234, 0
    v_mov_b32 v235, 0
    v_mov_b32 v236, 0
    v_mov_b32 v237, 0
    v_mov_b32 v238, 0
    v_mov_b32 v239, 0
    s_nop 1
    v_mfma_f32_16x16x32_bf16 v[208:211], v[200:203], v[184:187], v[208:211]
    v_mfma_f32_16x16x32_bf16 v[212:215], v[204:207], v[184:187], v[212:215]
    v_mfma_f32_16x16x32_bf16 v[216:219], v[200:203], v[188:191], v[216:219]
    v_mfma_f32_16x16x32_bf16 v[220:223], v[204:207], v[188:191], v[220:223]
    v_mfma_f32_16x16x32_bf16 v[224:227], v[200:203], v[192:195], v[224:227]
    v_mfma_f32_16x16x32_bf16 v[228:231], v[204:207], v[192:195], v[228:231]
    v_mfma_f32_16x16x32_bf16 v[232:235], v[200:203], v[196:199], v[232:235]
    v_mfma_f32_16x16x32_bf16 v[236:239], v[204:207], v[196:199], v[236:239]
    s_nop 7
    s_nop 1
    s_nop 3
    v_lshlrev_b32 v6, 2, v2
    v_add_u32 v6, 64, v6
    ds_bpermute_b32 v240, v6, v212
    ds_bpermute_b32 v241, v6, v220
    ds_bpermute_b32 v242, v6, v228
    ds_bpermute_b32 v243, v6, v236
    s_waitcnt lgkmcnt(0)
    v_add_f32 v240, 897988541, v240
    v_rcp_f32 v240, v240
    v_add_f32 v241, 897988541, v241
    v_rcp_f32 v241, v241
    v_add_f32 v242, 897988541, v242
    v_rcp_f32 v242, v242
    v_add_f32 v243, 897988541, v243
    v_rcp_f32 v243, v243
    s_nop 0
    s_mul_i32 s59, s26, 160
    s_add_u32 s59, s59, 80
    v_lshlrev_b32 v7, 2, v3
    v_add_u32 v7, s59, v7
    v_lshrrev_b32 v8, 7, v7
    v_lshlrev_b32 v8, 14, v8
    v_and_b32 v9, 127, v7
    v_lshrrev_b32 v9, 3, v9
    v_and_b32 v7, 7, v7
    v_lshlrev_b32 v7, 1, v7
    v_add_u32 v8, v8, v7
    v_xor_b32 v246, v9, v2
    v_lshlrev_b32 v246, 4, v246
    v_lshlrev_b32 v247, 8, v2
    v_add3_u32 v246, v246, v247, v8
    v_mul_f32 v208, v208, v240
    v_mul_f32 v209, v209, v240
    v_mul_f32 v210, v210, v240
    v_mul_f32 v211, v211, v240
    v_cvt_pk_bf16_f32 v244, v208, v209
    v_cvt_pk_bf16_f32 v245, v210, v211
    ds_write_b64 v246, v[244:245] offset:0
    v_mul_f32 v216, v216, v241
    v_mul_f32 v217, v217, v241
    v_mul_f32 v218, v218, v241
    v_mul_f32 v219, v219, v241
    v_cvt_pk_bf16_f32 v244, v216, v217
    v_cvt_pk_bf16_f32 v245, v218, v219
    ds_write_b64 v246, v[244:245] offset:4096
    v_mul_f32 v224, v224, v242
    v_mul_f32 v225, v225, v242
    v_mul_f32 v226, v226, v242
    v_mul_f32 v227, v227, v242
    v_cvt_pk_bf16_f32 v244, v224, v225
    v_cvt_pk_bf16_f32 v245, v226, v227
    ds_write_b64 v246, v[244:245] offset:8192
    v_mul_f32 v232, v232, v243
    v_mul_f32 v233, v233, v243
    v_mul_f32 v234, v234, v243
    v_mul_f32 v235, v235, v243
    v_cvt_pk_bf16_f32 v244, v232, v233
    v_cvt_pk_bf16_f32 v245, v234, v235
    ds_write_b64 v246, v[244:245] offset:12288
    v_lshlrev_b32 v7, 2, v3
    v_add_u32 v7, s59, v7
    v_add_u32 v7, 16, v7
    v_lshrrev_b32 v8, 7, v7
    v_lshlrev_b32 v8, 14, v8
    v_and_b32 v9, 127, v7
    v_lshrrev_b32 v9, 3, v9
    v_and_b32 v7, 7, v7
    v_lshlrev_b32 v7, 1, v7
    v_add_u32 v8, v8, v7
    v_xor_b32 v246, v9, v2
    v_lshlrev_b32 v246, 4, v246
    v_lshlrev_b32 v247, 8, v2
    v_add3_u32 v246, v246, v247, v8
    v_mul_f32 v212, v212, v240
    v_mul_f32 v213, v213, v240
    v_mul_f32 v214, v214, v240
    v_mul_f32 v215, v215, v240
    v_cvt_pk_bf16_f32 v244, v212, v213
    v_cvt_pk_bf16_f32 v245, v214, v215
    v_cmp_eq_u32 vcc, 0, v3
    s_and_saveexec_b64 s[56:57], vcc
    ds_write_b64 v246, v[244:245] offset:0
    s_mov_b64 exec, s[56:57]
    v_mul_f32 v220, v220, v241
    v_mul_f32 v221, v221, v241
    v_mul_f32 v222, v222, v241
    v_mul_f32 v223, v223, v241
    v_cvt_pk_bf16_f32 v244, v220, v221
    v_cvt_pk_bf16_f32 v245, v222, v223
    v_cmp_eq_u32 vcc, 0, v3
    s_and_saveexec_b64 s[56:57], vcc
    ds_write_b64 v246, v[244:245] offset:4096
    s_mov_b64 exec, s[56:57]
    v_mul_f32 v228, v228, v242
    v_mul_f32 v229, v229, v242
    v_mul_f32 v230, v230, v242
    v_mul_f32 v231, v231, v242
    v_cvt_pk_bf16_f32 v244, v228, v229
    v_cvt_pk_bf16_f32 v245, v230, v231
    v_cmp_eq_u32 vcc, 0, v3
    s_and_saveexec_b64 s[56:57], vcc
    ds_write_b64 v246, v[244:245] offset:8192
    s_mov_b64 exec, s[56:57]
    v_mul_f32 v236, v236, v243
    v_mul_f32 v237, v237, v243
    v_mul_f32 v238, v238, v243
    v_mul_f32 v239, v239, v243
    v_cvt_pk_bf16_f32 v244, v236, v237
    v_cvt_pk_bf16_f32 v245, v238, v239
    v_cmp_eq_u32 vcc, 0, v3
    s_and_saveexec_b64 s[56:57], vcc
    ds_write_b64 v246, v[244:245] offset:12288
    s_mov_b64 exec, s[56:57]
    s_waitcnt vmcnt(16)
    v_cvt_pk_bf16_f32 v200, v40, v41
    v_cvt_pk_bf16_f32 v201, v42, v43
    v_cvt_pk_bf16_f32 v202, v44, v45
    v_cvt_pk_bf16_f32 v203, v46, v47
    v_cvt_pk_bf16_f32 v204, v48, v49
    v_cvt_pk_bf16_f32 v205, v50, v51
    v_cvt_pk_bf16_f32 v206, v52, v53
    v_cvt_pk_bf16_f32 v207, v54, v55
    v_cndmask_b32 v56, 0, v56, s[72:73]
    v_cndmask_b32 v57, 0, v57, s[72:73]
    v_cndmask_b32 v58, 0, v58, s[74:75]
    v_cndmask_b32 v59, 0, v59, s[74:75]
    v_cndmask_b32 v60, 0, v60, s[72:73]
    v_cndmask_b32 v61, 0, v61, s[72:73]
    v_cndmask_b32 v62, 0, v62, s[74:75]
    v_cndmask_b32 v63, 0, v63, s[74:75]
    v_cndmask_b32 v64, 0, v64, s[72:73]
    v_cndmask_b32 v65, 0, v65, s[72:73]
    v_cndmask_b32 v66, 0, v66, s[74:75]
    v_cndmask_b32 v67, 0, v67, s[74:75]
    v_cndmask_b32 v68, 0, v68, s[72:73]
    v_cndmask_b32 v69, 0, v69, s[72:73]
    v_cndmask_b32 v70, 0, v70, s[74:75]
    v_cndmask_b32 v71, 0, v71, s[74:75]
    v_mov_b32 v208, 0
    v_mov_b32 v209, 0
    v_mov_b32 v210, 0
    v_mov_b32 v211, 0
    v_mov_b32 v212, 0
    v_mov_b32 v213, 0
    v_mov_b32 v214, 0
    v_mov_b32 v215, 0
    v_mov_b32 v216, 0
    v_mov_b32 v217, 0
    v_mov_b32 v218, 0
    v_mov_b32 v219, 0
    v_mov_b32 v220, 0
    v_mov_b32 v221, 0
    v_mov_b32 v222, 0
    v_mov_b32 v223, 0
    v_mov_b32 v224, 0
    v_mov_b32 v225, 0
    v_mov_b32 v226, 0
    v_mov_b32 v227, 0
    v_mov_b32 v228, 0
    v_mov_b32 v229, 0
    v_mov_b32 v230, 0
    v_mov_b32 v231, 0
    v_mov_b32 v232, 0
    v_mov_b32 v233, 0
    v_mov_b32 v234, 0
    v_mov_b32 v235, 0
    v_mov_b32 v236, 0
    v_mov_b32 v237, 0
    v_mov_b32 v238, 0
    v_mov_b32 v239, 0
    s_nop 1
    v_mfma_f32_16x16x32_bf16 v[208:211], v[200:203], v[56:59], v[208:211]
    v_mfma_f32_16x16x32_bf16 v[212:215], v[204:207], v[56:59], v[212:215]
    v_mfma_f32_16x16x32_bf16 v[216:219], v[200:203], v[60:63], v[216:219]
    v_mfma_f32_16x16x32_bf16 v[220:223], v[204:207], v[60:63], v[220:223]
    v_mfma_f32_16x16x32_bf16 v[224:227], v[200:203], v[64:67], v[224:227]
    v_mfma_f32_16x16x32_bf16 v[228:231], v[204:207], v[64:67], v[228:231]
    v_mfma_f32_16x16x32_bf16 v[232:235], v[200:203], v[68:71], v[232:235]
    v_mfma_f32_16x16x32_bf16 v[236:239], v[204:207], v[68:71], v[236:239]
    s_nop 7
    s_nop 1
    s_nop 3
    v_lshlrev_b32 v6, 2, v2
    v_add_u32 v6, 64, v6
    ds_bpermute_b32 v240, v6, v212
    ds_bpermute_b32 v241, v6, v220
    ds_bpermute_b32 v242, v6, v228
    ds_bpermute_b32 v243, v6, v236
    s_waitcnt lgkmcnt(0)
    v_add_f32 v240, 897988541, v240
    v_rcp_f32 v240, v240
    v_add_f32 v241, 897988541, v241
    v_rcp_f32 v241, v241
    v_add_f32 v242, 897988541, v242
    v_rcp_f32 v242, v242
    v_add_f32 v243, 897988541, v243
    v_rcp_f32 v243, v243
    s_nop 0
    s_mul_i32 s59, s26, 160
    s_add_u32 s59, s59, 100
    v_lshlrev_b32 v7, 2, v3
    v_add_u32 v7, s59, v7
    v_lshrrev_b32 v8, 7, v7
    v_lshlrev_b32 v8, 14, v8
    v_and_b32 v9, 127, v7
    v_lshrrev_b32 v9, 3, v9
    v_and_b32 v7, 7, v7
    v_lshlrev_b32 v7, 1, v7
    v_add_u32 v8, v8, v7
    v_xor_b32 v246, v9, v2
    v_lshlrev_b32 v246, 4, v246
    v_lshlrev_b32 v247, 8, v2
    v_add3_u32 v246, v246, v247, v8
    v_mul_f32 v208, v208, v240
    v_mul_f32 v209, v209, v240
    v_mul_f32 v210, v210, v240
    v_mul_f32 v211, v211, v240
    v_cvt_pk_bf16_f32 v244, v208, v209
    v_cvt_pk_bf16_f32 v245, v210, v211
    ds_write_b64 v246, v[244:245] offset:0
    v_mul_f32 v216, v216, v241
    v_mul_f32 v217, v217, v241
    v_mul_f32 v218, v218, v241
    v_mul_f32 v219, v219, v241
    v_cvt_pk_bf16_f32 v244, v216, v217
    v_cvt_pk_bf16_f32 v245, v218, v219
    ds_write_b64 v246, v[244:245] offset:4096
    v_mul_f32 v224, v224, v242
    v_mul_f32 v225, v225, v242
    v_mul_f32 v226, v226, v242
    v_mul_f32 v227, v227, v242
    v_cvt_pk_bf16_f32 v244, v224, v225
    v_cvt_pk_bf16_f32 v245, v226, v227
    ds_write_b64 v246, v[244:245] offset:8192
    v_mul_f32 v232, v232, v243
    v_mul_f32 v233, v233, v243
    v_mul_f32 v234, v234, v243
    v_mul_f32 v235, v235, v243
    v_cvt_pk_bf16_f32 v244, v232, v233
    v_cvt_pk_bf16_f32 v245, v234, v235
    ds_write_b64 v246, v[244:245] offset:12288
    v_lshlrev_b32 v7, 2, v3
    v_add_u32 v7, s59, v7
    v_add_u32 v7, 16, v7
    v_lshrrev_b32 v8, 7, v7
    v_lshlrev_b32 v8, 14, v8
    v_and_b32 v9, 127, v7
    v_lshrrev_b32 v9, 3, v9
    v_and_b32 v7, 7, v7
    v_lshlrev_b32 v7, 1, v7
    v_add_u32 v8, v8, v7
    v_xor_b32 v246, v9, v2
    v_lshlrev_b32 v246, 4, v246
    v_lshlrev_b32 v247, 8, v2
    v_add3_u32 v246, v246, v247, v8
    v_mul_f32 v212, v212, v240
    v_mul_f32 v213, v213, v240
    v_mul_f32 v214, v214, v240
    v_mul_f32 v215, v215, v240
    v_cvt_pk_bf16_f32 v244, v212, v213
    v_cvt_pk_bf16_f32 v245, v214, v215
    v_cmp_eq_u32 vcc, 0, v3
    s_and_saveexec_b64 s[56:57], vcc
    ds_write_b64 v246, v[244:245] offset:0
    s_mov_b64 exec, s[56:57]
    v_mul_f32 v220, v220, v241
    v_mul_f32 v221, v221, v241
    v_mul_f32 v222, v222, v241
    v_mul_f32 v223, v223, v241
    v_cvt_pk_bf16_f32 v244, v220, v221
    v_cvt_pk_bf16_f32 v245, v222, v223
    v_cmp_eq_u32 vcc, 0, v3
    s_and_saveexec_b64 s[56:57], vcc
    ds_write_b64 v246, v[244:245] offset:4096
    s_mov_b64 exec, s[56:57]
    v_mul_f32 v228, v228, v242
    v_mul_f32 v229, v229, v242
    v_mul_f32 v230, v230, v242
    v_mul_f32 v231, v231, v242
    v_cvt_pk_bf16_f32 v244, v228, v229
    v_cvt_pk_bf16_f32 v245, v230, v231
    v_cmp_eq_u32 vcc, 0, v3
    s_and_saveexec_b64 s[56:57], vcc
    ds_write_b64 v246, v[244:245] offset:8192
    s_mov_b64 exec, s[56:57]
    v_mul_f32 v236, v236, v243
    v_mul_f32 v237, v237, v243
    v_mul_f32 v238, v238, v243
    v_mul_f32 v239, v239, v243
    v_cvt_pk_bf16_f32 v244, v236, v237
    v_cvt_pk_bf16_f32 v245, v238, v239
    v_cmp_eq_u32 vcc, 0, v3
    s_and_saveexec_b64 s[56:57], vcc
    ds_write_b64 v246, v[244:245] offset:12288
    s_mov_b64 exec, s[56:57]
    s_waitcnt vmcnt(8)
    v_cvt_pk_bf16_f32 v200, v72, v73
    v_cvt_pk_bf16_f32 v201, v74, v75
    v_cvt_pk_bf16_f32 v202, v76, v77
    v_cvt_pk_bf16_f32 v203, v78, v79
    v_cvt_pk_bf16_f32 v204, v80, v81
    v_cvt_pk_bf16_f32 v205, v82, v83
    v_cvt_pk_bf16_f32 v206, v84, v85
    v_cvt_pk_bf16_f32 v207, v86, v87
    v_cndmask_b32 v88, 0, v88, s[72:73]
    v_cndmask_b32 v89, 0, v89, s[72:73]
    v_cndmask_b32 v90, 0, v90, s[74:75]
    v_cndmask_b32 v91, 0, v91, s[74:75]
    v_cndmask_b32 v92, 0, v92, s[72:73]
    v_cndmask_b32 v93, 0, v93, s[72:73]
    v_cndmask_b32 v94, 0, v94, s[74:75]
    v_cndmask_b32 v95, 0, v95, s[74:75]
    v_cndmask_b32 v96, 0, v96, s[72:73]
    v_cndmask_b32 v97, 0, v97, s[72:73]
    v_cndmask_b32 v98, 0, v98, s[74:75]
    v_cndmask_b32 v99, 0, v99, s[74:75]
    v_cndmask_b32 v100, 0, v100, s[72:73]
    v_cndmask_b32 v101, 0, v101, s[72:73]
    v_cndmask_b32 v102, 0, v102, s[74:75]
    v_cndmask_b32 v103, 0, v103, s[74:75]
    v_mov_b32 v208, 0
    v_mov_b32 v209, 0
    v_mov_b32 v210, 0
    v_mov_b32 v211, 0
    v_mov_b32 v212, 0
    v_mov_b32 v213, 0
    v_mov_b32 v214, 0
    v_mov_b32 v215, 0
    v_mov_b32 v216, 0
    v_mov_b32 v217, 0
    v_mov_b32 v218, 0
    v_mov_b32 v219, 0
    v_mov_b32 v220, 0
    v_mov_b32 v221, 0
    v_mov_b32 v222, 0
    v_mov_b32 v223, 0
    v_mov_b32 v224, 0
    v_mov_b32 v225, 0
    v_mov_b32 v226, 0
    v_mov_b32 v227, 0
    v_mov_b32 v228, 0
    v_mov_b32 v229, 0
    v_mov_b32 v230, 0
    v_mov_b32 v231, 0
    v_mov_b32 v232, 0
    v_mov_b32 v233, 0
    v_mov_b32 v234, 0
    v_mov_b32 v235, 0
    v_mov_b32 v236, 0
    v_mov_b32 v237, 0
    v_mov_b32 v238, 0
    v_mov_b32 v239, 0
    s_nop 1
    v_mfma_f32_16x16x32_bf16 v[208:211], v[200:203], v[88:91], v[208:211]
    v_mfma_f32_16x16x32_bf16 v[212:215], v[204:207], v[88:91], v[212:215]
    v_mfma_f32_16x16x32_bf16 v[216:219], v[200:203], v[92:95], v[216:219]
    v_mfma_f32_16x16x32_bf16 v[220:223], v[204:207], v[92:95], v[220:223]
    v_mfma_f32_16x16x32_bf16 v[224:227], v[200:203], v[96:99], v[224:227]
    v_mfma_f32_16x16x32_bf16 v[228:231], v[204:207], v[96:99], v[228:231]
    v_mfma_f32_16x16x32_bf16 v[232:235], v[200:203], v[100:103], v[232:235]
    v_mfma_f32_16x16x32_bf16 v[236:239], v[204:207], v[100:103], v[236:239]
    s_nop 7
    s_nop 1
    s_nop 3
    v_lshlrev_b32 v6, 2, v2
    v_add_u32 v6, 64, v6
    ds_bpermute_b32 v240, v6, v212
    ds_bpermute_b32 v241, v6, v220
    ds_bpermute_b32 v242, v6, v228
    ds_bpermute_b32 v243, v6, v236
    s_waitcnt lgkmcnt(0)
    v_add_f32 v240, 897988541, v240
    v_rcp_f32 v240, v240
    v_add_f32 v241, 897988541, v241
    v_rcp_f32 v241, v241
    v_add_f32 v242, 897988541, v242
    v_rcp_f32 v242, v242
    v_add_f32 v243, 897988541, v243
    v_rcp_f32 v243, v243
    s_nop 0
    s_mul_i32 s59, s26, 160
    s_add_u32 s59, s59, 120
    v_lshlrev_b32 v7, 2, v3
    v_add_u32 v7, s59, v7
    v_lshrrev_b32 v8, 7, v7
    v_lshlrev_b32 v8, 14, v8
    v_and_b32 v9, 127, v7
    v_lshrrev_b32 v9, 3, v9
    v_and_b32 v7, 7, v7
    v_lshlrev_b32 v7, 1, v7
    v_add_u32 v8, v8, v7
    v_xor_b32 v246, v9, v2
    v_lshlrev_b32 v246, 4, v246
    v_lshlrev_b32 v247, 8, v2
    v_add3_u32 v246, v246, v247, v8
    v_mul_f32 v208, v208, v240
    v_mul_f32 v209, v209, v240
    v_mul_f32 v210, v210, v240
    v_mul_f32 v211, v211, v240
    v_cvt_pk_bf16_f32 v244, v208, v209
    v_cvt_pk_bf16_f32 v245, v210, v211
    ds_write_b64 v246, v[244:245] offset:0
    v_mul_f32 v216, v216, v241
    v_mul_f32 v217, v217, v241
    v_mul_f32 v218, v218, v241
    v_mul_f32 v219, v219, v241
    v_cvt_pk_bf16_f32 v244, v216, v217
    v_cvt_pk_bf16_f32 v245, v218, v219
    ds_write_b64 v246, v[244:245] offset:4096
    v_mul_f32 v224, v224, v242
    v_mul_f32 v225, v225, v242
    v_mul_f32 v226, v226, v242
    v_mul_f32 v227, v227, v242
    v_cvt_pk_bf16_f32 v244, v224, v225
    v_cvt_pk_bf16_f32 v245, v226, v227
    ds_write_b64 v246, v[244:245] offset:8192
    v_mul_f32 v232, v232, v243
    v_mul_f32 v233, v233, v243
    v_mul_f32 v234, v234, v243
    v_mul_f32 v235, v235, v243
    v_cvt_pk_bf16_f32 v244, v232, v233
    v_cvt_pk_bf16_f32 v245, v234, v235
    ds_write_b64 v246, v[244:245] offset:12288
    v_lshlrev_b32 v7, 2, v3
    v_add_u32 v7, s59, v7
    v_add_u32 v7, 16, v7
    v_lshrrev_b32 v8, 7, v7
    v_lshlrev_b32 v8, 14, v8
    v_and_b32 v9, 127, v7
    v_lshrrev_b32 v9, 3, v9
    v_and_b32 v7, 7, v7
    v_lshlrev_b32 v7, 1, v7
    v_add_u32 v8, v8, v7
    v_xor_b32 v246, v9, v2
    v_lshlrev_b32 v246, 4, v246
    v_lshlrev_b32 v247, 8, v2
    v_add3_u32 v246, v246, v247, v8
    v_mul_f32 v212, v212, v240
    v_mul_f32 v213, v213, v240
    v_mul_f32 v214, v214, v240
    v_mul_f32 v215, v215, v240
    v_cvt_pk_bf16_f32 v244, v212, v213
    v_cvt_pk_bf16_f32 v245, v214, v215
    v_cmp_eq_u32 vcc, 0, v3
    s_and_saveexec_b64 s[56:57], vcc
    ds_write_b64 v246, v[244:245] offset:0
    s_mov_b64 exec, s[56:57]
    v_mul_f32 v220, v220, v241
    v_mul_f32 v221, v221, v241
    v_mul_f32 v222, v222, v241
    v_mul_f32 v223, v223, v241
    v_cvt_pk_bf16_f32 v244, v220, v221
    v_cvt_pk_bf16_f32 v245, v222, v223
    v_cmp_eq_u32 vcc, 0, v3
    s_and_saveexec_b64 s[56:57], vcc
    ds_write_b64 v246, v[244:245] offset:4096
    s_mov_b64 exec, s[56:57]
    v_mul_f32 v228, v228, v242
    v_mul_f32 v229, v229, v242
    v_mul_f32 v230, v230, v242
    v_mul_f32 v231, v231, v242
    v_cvt_pk_bf16_f32 v244, v228, v229
    v_cvt_pk_bf16_f32 v245, v230, v231
    v_cmp_eq_u32 vcc, 0, v3
    s_and_saveexec_b64 s[56:57], vcc
    ds_write_b64 v246, v[244:245] offset:8192
    s_mov_b64 exec, s[56:57]
    v_mul_f32 v236, v236, v243
    v_mul_f32 v237, v237, v243
    v_mul_f32 v238, v238, v243
    v_mul_f32 v239, v239, v243
    v_cvt_pk_bf16_f32 v244, v236, v237
    v_cvt_pk_bf16_f32 v245, v238, v239
    v_cmp_eq_u32 vcc, 0, v3
    s_and_saveexec_b64 s[56:57], vcc
    ds_write_b64 v246, v[244:245] offset:12288
    s_mov_b64 exec, s[56:57]
    s_waitcnt vmcnt(0)
    v_cvt_pk_bf16_f32 v200, v104, v105
    v_cvt_pk_bf16_f32 v201, v106, v107
    v_cvt_pk_bf16_f32 v202, v108, v109
    v_cvt_pk_bf16_f32 v203, v110, v111
    v_cvt_pk_bf16_f32 v204, v112, v113
    v_cvt_pk_bf16_f32 v205, v114, v115
    v_cvt_pk_bf16_f32 v206, v116, v117
    v_cvt_pk_bf16_f32 v207, v118, v119
    v_cndmask_b32 v120, 0, v120, s[72:73]
    v_cndmask_b32 v121, 0, v121, s[72:73]
    v_cndmask_b32 v122, 0, v122, s[74:75]
    v_cndmask_b32 v123, 0, v123, s[74:75]
    v_cndmask_b32 v124, 0, v124, s[72:73]
    v_cndmask_b32 v125, 0, v125, s[72:73]
    v_cndmask_b32 v126, 0, v126, s[74:75]
    v_cndmask_b32 v127, 0, v127, s[74:75]
    v_cndmask_b32 v128, 0, v128, s[72:73]
    v_cndmask_b32 v129, 0, v129, s[72:73]
    v_cndmask_b32 v130, 0, v130, s[74:75]
    v_cndmask_b32 v131, 0, v131, s[74:75]
    v_cndmask_b32 v132, 0, v132, s[72:73]
    v_cndmask_b32 v133, 0, v133, s[72:73]
    v_cndmask_b32 v134, 0, v134, s[74:75]
    v_cndmask_b32 v135, 0, v135, s[74:75]
    v_mov_b32 v208, 0
    v_mov_b32 v209, 0
    v_mov_b32 v210, 0
    v_mov_b32 v211, 0
    v_mov_b32 v212, 0
    v_mov_b32 v213, 0
    v_mov_b32 v214, 0
    v_mov_b32 v215, 0
    v_mov_b32 v216, 0
    v_mov_b32 v217, 0
    v_mov_b32 v218, 0
    v_mov_b32 v219, 0
    v_mov_b32 v220, 0
    v_mov_b32 v221, 0
    v_mov_b32 v222, 0
    v_mov_b32 v223, 0
    v_mov_b32 v224, 0
    v_mov_b32 v225, 0
    v_mov_b32 v226, 0
    v_mov_b32 v227, 0
    v_mov_b32 v228, 0
    v_mov_b32 v229, 0
    v_mov_b32 v230, 0
    v_mov_b32 v231, 0
    v_mov_b32 v232, 0
    v_mov_b32 v233, 0
    v_mov_b32 v234, 0
    v_mov_b32 v235, 0
    v_mov_b32 v236, 0
    v_mov_b32 v237, 0
    v_mov_b32 v238, 0
    v_mov_b32 v239, 0
    s_nop 1
    v_mfma_f32_16x16x32_bf16 v[208:211], v[200:203], v[120:123], v[208:211]
    v_mfma_f32_16x16x32_bf16 v[212:215], v[204:207], v[120:123], v[212:215]
    v_mfma_f32_16x16x32_bf16 v[216:219], v[200:203], v[124:127], v[216:219]
    v_mfma_f32_16x16x32_bf16 v[220:223], v[204:207], v[124:127], v[220:223]
    v_mfma_f32_16x16x32_bf16 v[224:227], v[200:203], v[128:131], v[224:227]
    v_mfma_f32_16x16x32_bf16 v[228:231], v[204:207], v[128:131], v[228:231]
    v_mfma_f32_16x16x32_bf16 v[232:235], v[200:203], v[132:135], v[232:235]
    v_mfma_f32_16x16x32_bf16 v[236:239], v[204:207], v[132:135], v[236:239]
    s_nop 7
    s_nop 1
    s_nop 3
    v_lshlrev_b32 v6, 2, v2
    v_add_u32 v6, 64, v6
    ds_bpermute_b32 v240, v6, v212
    ds_bpermute_b32 v241, v6, v220
    ds_bpermute_b32 v242, v6, v228
    ds_bpermute_b32 v243, v6, v236
    s_waitcnt lgkmcnt(0)
    v_add_f32 v240, 897988541, v240
    v_rcp_f32 v240, v240
    v_add_f32 v241, 897988541, v241
    v_rcp_f32 v241, v241
    v_add_f32 v242, 897988541, v242
    v_rcp_f32 v242, v242
    v_add_f32 v243, 897988541, v243
    v_rcp_f32 v243, v243
    s_nop 0
    s_mul_i32 s59, s26, 160
    s_add_u32 s59, s59, 140
    v_lshlrev_b32 v7, 2, v3
    v_add_u32 v7, s59, v7
    v_lshrrev_b32 v8, 7, v7
    v_lshlrev_b32 v8, 14, v8
    v_and_b32 v9, 127, v7
    v_lshrrev_b32 v9, 3, v9
    v_and_b32 v7, 7, v7
    v_lshlrev_b32 v7, 1, v7
    v_add_u32 v8, v8, v7
    v_xor_b32 v246, v9, v2
    v_lshlrev_b32 v246, 4, v246
    v_lshlrev_b32 v247, 8, v2
    v_add3_u32 v246, v246, v247, v8
    v_mul_f32 v208, v208, v240
    v_mul_f32 v209, v209, v240
    v_mul_f32 v210, v210, v240
    v_mul_f32 v211, v211, v240
    v_cvt_pk_bf16_f32 v244, v208, v209
    v_cvt_pk_bf16_f32 v245, v210, v211
    ds_write_b64 v246, v[244:245] offset:0
    v_mul_f32 v216, v216, v241
    v_mul_f32 v217, v217, v241
    v_mul_f32 v218, v218, v241
    v_mul_f32 v219, v219, v241
    v_cvt_pk_bf16_f32 v244, v216, v217
    v_cvt_pk_bf16_f32 v245, v218, v219
    ds_write_b64 v246, v[244:245] offset:4096
    v_mul_f32 v224, v224, v242
    v_mul_f32 v225, v225, v242
    v_mul_f32 v226, v226, v242
    v_mul_f32 v227, v227, v242
    v_cvt_pk_bf16_f32 v244, v224, v225
    v_cvt_pk_bf16_f32 v245, v226, v227
    ds_write_b64 v246, v[244:245] offset:8192
    v_mul_f32 v232, v232, v243
    v_mul_f32 v233, v233, v243
    v_mul_f32 v234, v234, v243
    v_mul_f32 v235, v235, v243
    v_cvt_pk_bf16_f32 v244, v232, v233
    v_cvt_pk_bf16_f32 v245, v234, v235
    ds_write_b64 v246, v[244:245] offset:12288
    v_lshlrev_b32 v7, 2, v3
    v_add_u32 v7, s59, v7
    v_add_u32 v7, 16, v7
    v_lshrrev_b32 v8, 7, v7
    v_lshlrev_b32 v8, 14, v8
    v_and_b32 v9, 127, v7
    v_lshrrev_b32 v9, 3, v9
    v_and_b32 v7, 7, v7
    v_lshlrev_b32 v7, 1, v7
    v_add_u32 v8, v8, v7
    v_xor_b32 v246, v9, v2
    v_lshlrev_b32 v246, 4, v246
    v_lshlrev_b32 v247, 8, v2
    v_add3_u32 v246, v246, v247, v8
    v_mul_f32 v212, v212, v240
    v_mul_f32 v213, v213, v240
    v_mul_f32 v214, v214, v240
    v_mul_f32 v215, v215, v240
    v_cvt_pk_bf16_f32 v244, v212, v213
    v_cvt_pk_bf16_f32 v245, v214, v215
    v_cmp_eq_u32 vcc, 0, v3
    s_and_saveexec_b64 s[56:57], vcc
    ds_write_b64 v246, v[244:245] offset:0
    s_mov_b64 exec, s[56:57]
    v_mul_f32 v220, v220, v241
    v_mul_f32 v221, v221, v241
    v_mul_f32 v222, v222, v241
    v_mul_f32 v223, v223, v241
    v_cvt_pk_bf16_f32 v244, v220, v221
    v_cvt_pk_bf16_f32 v245, v222, v223
    v_cmp_eq_u32 vcc, 0, v3
    s_and_saveexec_b64 s[56:57], vcc
    ds_write_b64 v246, v[244:245] offset:4096
    s_mov_b64 exec, s[56:57]
    v_mul_f32 v228, v228, v242
    v_mul_f32 v229, v229, v242
    v_mul_f32 v230, v230, v242
    v_mul_f32 v231, v231, v242
    v_cvt_pk_bf16_f32 v244, v228, v229
    v_cvt_pk_bf16_f32 v245, v230, v231
    v_cmp_eq_u32 vcc, 0, v3
    s_and_saveexec_b64 s[56:57], vcc
    ds_write_b64 v246, v[244:245] offset:8192
    s_mov_b64 exec, s[56:57]
    v_mul_f32 v236, v236, v243
    v_mul_f32 v237, v237, v243
    v_mul_f32 v238, v238, v243
    v_mul_f32 v239, v239, v243
    v_cvt_pk_bf16_f32 v244, v236, v237
    v_cvt_pk_bf16_f32 v245, v238, v239
    v_cmp_eq_u32 vcc, 0, v3
    s_and_saveexec_b64 s[56:57], vcc
    ds_write_b64 v246, v[244:245] offset:12288
    s_mov_b64 exec, s[56:57]
    s_waitcnt lgkmcnt(0)
    buffer_load_dwordx2 v[220:221], v30, s[36:39], 0 offen offset:0
    buffer_load_dwordx2 v[222:223], v30, s[36:39], 0 offen offset:32
    buffer_load_dwordx2 v[224:225], v30, s[36:39], 0 offen offset:64
    buffer_load_dwordx2 v[226:227], v30, s[36:39], 0 offen offset:96
    buffer_load_dwordx2 v[228:229], v30, s[36:39], 0 offen offset:128
    v_mov_b32 v100, 0
    v_mov_b32 v101, 0
    v_mov_b32 v102, 0
    v_mov_b32 v103, 0
    v_mov_b32 v104, 0
    v_mov_b32 v105, 0
    v_mov_b32 v106, 0
    v_mov_b32 v107, 0
    v_mov_b32 v108, 0
    v_mov_b32 v109, 0
    v_mov_b32 v110, 0
    v_mov_b32 v111, 0
    v_mov_b32 v112, 0
    v_mov_b32 v113, 0
    v_mov_b32 v114, 0
    v_mov_b32 v115, 0
    v_mov_b32 v116, 0
    v_mov_b32 v117, 0
    v_mov_b32 v118, 0
    v_mov_b32 v119, 0
    s_add_u32 m0, s63, 81920
    s_nop 0
    buffer_load_dwordx4 v14, s[32:35], s61 offen lds
    s_add_u32 m0, s63, 82944
    s_nop 0
    buffer_load_dwordx4 v15, s[32:35], s61 offen lds
    s_add_u32 m0, s63, 83968
    s_nop 0
    buffer_load_dwordx4 v16, s[32:35], s61 offen lds
    s_add_u32 m0, s63, 84992
    s_nop 0
    buffer_load_dwordx4 v17, s[32:35], s61 offen lds
    s_add_u32 m0, s63, 86016
    s_nop 0
    buffer_load_dwordx4 v18, s[32:35], s61 offen lds
    s_add_u32 s61, s61, 163840
    s_add_u32 m0, s63, 102400
    s_nop 0
    buffer_load_dwordx4 v14, s[32:35], s61 offen lds
    s_add_u32 m0, s63, 103424
    s_nop 0
    buffer_load_dwordx4 v15, s[32:35], s61 offen lds
    s_add_u32 m0, s63, 104448
    s_nop 0
    buffer_load_dwordx4 v16, s[32:35], s61 offen lds
    s_add_u32 m0, s63, 105472
    s_nop 0
    buffer_load_dwordx4 v17, s[32:35], s61 offen lds
    s_add_u32 m0, s63, 106496
    s_nop 0
    buffer_load_dwordx4 v18, s[32:35], s61 offen lds
    s_add_u32 s61, s61, 163840
    s_waitcnt vmcnt(5)
    s_barrier
    ds_read_b128 v[40:43], v20 offset:0
    ds_read_b64_tr_b16 v[44:45], v24 offset:0
    ds_read_b64_tr_b16 v[46:47], v24 offset:1280
    ds_read_b64_tr_b16 v[48:49], v24 offset:32
    ds_read_b64_tr_b16 v[50:51], v24 offset:1312
    ds_read_b64_tr_b16 v[52:53], v24 offset:64
    ds_read_b64_tr_b16 v[54:55], v24 offset:1344
    ds_read_b64_tr_b16 v[56:57], v24 offset:96
    ds_read_b64_tr_b16 v[58:59], v24 offset:1376
    ds_read_b64_tr_b16 v[60:61], v24 offset:128
    ds_read_b64_tr_b16 v[62:63], v24 offset:1408
    s_waitcnt lgkmcnt(0)
    v_mfma_f32_16x16x32_bf16 v[100:103], v[44:47], v[40:43], v[100:103]
    ds_read_b128 v[64:67], v21 offset:0
    ds_read_b64_tr_b16 v[68:69], v24 offset:5120
    ds_read_b64_tr_b16 v[70:71], v24 offset:6400
    v_mfma_f32_16x16x32_bf16 v[104:107], v[48:51], v[40:43], v[104:107]
    ds_read_b64_tr_b16 v[72:73], v24 offset:5152
    ds_read_b64_tr_b16 v[74:75], v24 offset:6432
    ds_read_b64_tr_b16 v[76:77], v24 offset:5184
    s_add_u32 m0, s63, 122880
    s_nop 0
    buffer_load_dwordx4 v14, s[32:35], s61 offen lds
    v_mfma_f32_16x16x32_bf16 v[108:111], v[52:55], v[40:43], v[108:111]
    ds_read_b64_tr_b16 v[78:79], v24 offset:6464
    ds_read_b64_tr_b16 v[80:81], v24 offset:5216
    ds_read_b64_tr_b16 v[82:83], v24 offset:6496
    v_mfma_f32_16x16x32_bf16 v[112:115], v[56:59], v[40:43], v[112:115]
    ds_read_b64_tr_b16 v[84:85], v24 offset:5248
    ds_read_b64_tr_b16 v[86:87], v24 offset:6528
    s_add_u32 m0, s63, 123904
    s_nop 0
    buffer_load_dwordx4 v15, s[32:35], s61 offen lds
    v_mfma_f32_16x16x32_bf16 v[116:119], v[60:63], v[40:43], v[116:119]
    s_waitcnt lgkmcnt(0)
    v_mfma_f32_16x16x32_bf16 v[100:103], v[68:71], v[64:67], v[100:103]
    ds_read_b128 v[40:43], v22 offset:0
    ds_read_b64_tr_b16 v[44:45], v24 offset:10240
    ds_read_b64_tr_b16 v[46:47], v24 offset:11520
    v_mfma_f32_16x16x32_bf16 v[104:107], v[72:75], v[64:67], v[104:107]
    ds_read_b64_tr_b16 v[48:49], v24 offset:10272
    ds_read_b64_tr_b16 v[50:51], v24 offset:11552
    ds_read_b64_tr_b16 v[52:53], v24 offset:10304
    s_add_u32 m0, s63, 124928
    s_nop 0
    buffer_load_dwordx4 v16, s[32:35], s61 offen lds
    v_mfma_f32_16x16x32_bf16 v[108:111], v[76:79], v[64:67], v[108:111]
    ds_read_b64_tr_b16 v[54:55], v24 offset:11584
    ds_read_b64_tr_b16 v[56:57], v24 offset:10336
    ds_read_b64_tr_b16 v[58:59], v24 offset:11616
    v_mfma_f32_16x16x32_bf16 v[112:115], v[80:83], v[64:67], v[112:115]
    ds_read_b64_tr_b16 v[60:61], v24 offset:10368
    ds_read_b64_tr_b16 v[62:63], v24 offset:11648
    v_mfma_f32_16x16x32_bf16 v[116:119], v[84:87], v[64:67], v[116:119]
    s_waitcnt lgkmcnt(0)
    v_mfma_f32_16x16x32_bf16 v[100:103], v[44:47], v[40:43], v[100:103]
    ds_read_b128 v[64:67], v23 offset:0
    ds_read_b64_tr_b16 v[68:69], v24 offset:15360
    ds_read_b64_tr_b16 v[70:71], v24 offset:16640
    v_mfma_f32_16x16x32_bf16 v[104:107], v[48:51], v[40:43], v[104:107]
    ds_read_b64_tr_b16 v[72:73], v24 offset:15392
    ds_read_b64_tr_b16 v[74:75], v24 offset:16672
    ds_read_b64_tr_b16 v[76:77], v24 offset:15424
    s_add_u32 m0, s63, 125952
    s_nop 0
    buffer_load_dwordx4 v17, s[32:35], s61 offen lds
    v_mfma_f32_16x16x32_bf16 v[108:111], v[52:55], v[40:43], v[108:111]
    ds_read_b64_tr_b16 v[78:79], v24 offset:16704
    ds_read_b64_tr_b16 v[80:81], v24 offset:15456
    ds_read_b64_tr_b16 v[82:83], v24 offset:16736
    v_mfma_f32_16x16x32_bf16 v[112:115], v[56:59], v[40:43], v[112:115]
    ds_read_b64_tr_b16 v[84:85], v24 offset:15488
    ds_read_b64_tr_b16 v[86:87], v24 offset:16768
    v_mfma_f32_16x16x32_bf16 v[116:119], v[60:63], v[40:43], v[116:119]
    s_waitcnt lgkmcnt(0)
    s_add_u32 m0, s63, 126976
    s_nop 0
    buffer_load_dwordx4 v18, s[32:35], s61 offen lds
    s_add_u32 s61, s61, 163840
    s_waitcnt vmcnt(5)
    s_barrier
    v_mfma_f32_16x16x32_bf16 v[100:103], v[68:71], v[64:67], v[100:103]
    ds_read_b128 v[40:43], v20 offset:16384
    ds_read_b64_tr_b16 v[44:45], v24 offset:20480
    ds_read_b64_tr_b16 v[46:47], v24 offset:21760
    v_mfma_f32_16x16x32_bf16 v[104:107], v[72:75], v[64:67], v[104:107]
    ds_read_b64_tr_b16 v[48:49], v24 offset:20512
    ds_read_b64_tr_b16 v[50:51], v24 offset:21792
    ds_read_b64_tr_b16 v[52:53], v24 offset:20544
    s_add_u32 m0, s63, 81920
    s_nop 0
    buffer_load_dwordx4 v14, s[32:35], s61 offen lds
    s_add_u32 m0, s63, 82944
    s_nop 0
    buffer_load_dwordx4 v15, s[32:35], s61 offen lds
    v_mfma_f32_16x16x32_bf16 v[108:111], v[76:79], v[64:67], v[108:111]
    ds_read_b64_tr_b16 v[54:55], v24 offset:21824
    ds_read_b64_tr_b16 v[56:57], v24 offset:20576
    ds_read_b64_tr_b16 v[58:59], v24 offset:21856
    s_add_u32 m0, s63, 83968
    s_nop 0
    buffer_load_dwordx4 v16, s[32:35], s61 offen lds
    v_mfma_f32_16x16x32_bf16 v[112:115], v[80:83], v[64:67], v[112:115]
    ds_read_b64_tr_b16 v[60:61], v24 offset:20608
    ds_read_b64_tr_b16 v[62:63], v24 offset:21888
    s_add_u32 m0, s63, 84992
    s_nop 0
    buffer_load_dwordx4 v17, s[32:35], s61 offen lds
    v_mfma_f32_16x16x32_bf16 v[116:119], v[84:87], v[64:67], v[116:119]
    s_add_u32 m0, s63, 86016
    s_nop 0
    buffer_load_dwordx4 v18, s[32:35], s61 offen lds
    s_add_u32 s61, s61, 163840
    s_waitcnt lgkmcnt(0)
    v_mfma_f32_16x16x32_bf16 v[100:103], v[44:47], v[40:43], v[100:103]
    ds_read_b128 v[64:67], v21 offset:16384
    ds_read_b64_tr_b16 v[68:69], v24 offset:25600
    ds_read_b64_tr_b16 v[70:71], v24 offset:26880
    v_mfma_f32_16x16x32_bf16 v[104:107], v[48:51], v[40:43], v[104:107]
    ds_read_b64_tr_b16 v[72:73], v24 offset:25632
    ds_read_b64_tr_b16 v[74:75], v24 offset:26912
    ds_read_b64_tr_b16 v[76:77], v24 offset:25664
    v_mfma_f32_16x16x32_bf16 v[108:111], v[52:55], v[40:43], v[108:111]
    ds_read_b64_tr_b16 v[78:79], v24 offset:26944
    ds_read_b64_tr_b16 v[80:81], v24 offset:25696
    ds_read_b64_tr_b16 v[82:83], v24 offset:26976
    v_mfma_f32_16x16x32_bf16 v[112:115], v[56:59], v[40:43], v[112:115]
    ds_read_b64_tr_b16 v[84:85], v24 offset:25728
    ds_read_b64_tr_b16 v[86:87], v24 offset:27008
    v_mfma_f32_16x16x32_bf16 v[116:119], v[60:63], v[40:43], v[116:119]
    s_waitcnt lgkmcnt(0)
    v_mfma_f32_16x16x32_bf16 v[100:103], v[68:71], v[64:67], v[100:103]
    ds_read_b128 v[40:43], v22 offset:16384
    ds_read_b64_tr_b16 v[44:45], v24 offset:30720
    ds_read_b64_tr_b16 v[46:47], v24 offset:32000
    v_mfma_f32_16x16x32_bf16 v[104:107], v[72:75], v[64:67], v[104:107]
    ds_read_b64_tr_b16 v[48:49], v24 offset:30752
    ds_read_b64_tr_b16 v[50:51], v24 offset:32032
    ds_read_b64_tr_b16 v[52:53], v24 offset:30784
    v_mfma_f32_16x16x32_bf16 v[108:111], v[76:79], v[64:67], v[108:111]
    ds_read_b64_tr_b16 v[54:55], v24 offset:32064
    ds_read_b64_tr_b16 v[56:57], v24 offset:30816
    ds_read_b64_tr_b16 v[58:59], v24 offset:32096
    v_mfma_f32_16x16x32_bf16 v[112:115], v[80:83], v[64:67], v[112:115]
    ds_read_b64_tr_b16 v[60:61], v24 offset:30848
    ds_read_b64_tr_b16 v[62:63], v24 offset:32128
    v_mfma_f32_16x16x32_bf16 v[116:119], v[84:87], v[64:67], v[116:119]
    s_waitcnt lgkmcnt(0)
    v_mfma_f32_16x16x32_bf16 v[100:103], v[44:47], v[40:43], v[100:103]
    ds_read_b128 v[64:67], v23 offset:16384
    ds_read_b64_tr_b16 v[68:69], v24 offset:35840
    ds_read_b64_tr_b16 v[70:71], v24 offset:37120
    v_mfma_f32_16x16x32_bf16 v[104:107], v[48:51], v[40:43], v[104:107]
    ds_read_b64_tr_b16 v[72:73], v24 offset:35872
    ds_read_b64_tr_b16 v[74:75], v24 offset:37152
    ds_read_b64_tr_b16 v[76:77], v24 offset:35904
    v_mfma_f32_16x16x32_bf16 v[108:111], v[52:55], v[40:43], v[108:111]
    ds_read_b64_tr_b16 v[78:79], v24 offset:37184
    ds_read_b64_tr_b16 v[80:81], v24 offset:35936
    ds_read_b64_tr_b16 v[82:83], v24 offset:37216
    v_mfma_f32_16x16x32_bf16 v[112:115], v[56:59], v[40:43], v[112:115]
    ds_read_b64_tr_b16 v[84:85], v24 offset:35968
    ds_read_b64_tr_b16 v[86:87], v24 offset:37248
    v_mfma_f32_16x16x32_bf16 v[116:119], v[60:63], v[40:43], v[116:119]
    s_waitcnt lgkmcnt(0)
    s_waitcnt vmcnt(5)
    s_barrier
    v_mfma_f32_16x16x32_bf16 v[100:103], v[68:71], v[64:67], v[100:103]
    ds_read_b128 v[40:43], v20 offset:32768
    ds_read_b64_tr_b16 v[44:45], v24 offset:40960
    ds_read_b64_tr_b16 v[46:47], v24 offset:42240
    v_mfma_f32_16x16x32_bf16 v[104:107], v[72:75], v[64:67], v[104:107]
    ds_read_b64_tr_b16 v[48:49], v24 offset:40992
    ds_read_b64_tr_b16 v[50:51], v24 offset:42272
    ds_read_b64_tr_b16 v[52:53], v24 offset:41024
    s_add_u32 m0, s63, 102400
    s_nop 0
    buffer_load_dwordx4 v14, s[32:35], s61 offen lds
    s_add_u32 m0, s63, 103424
    s_nop 0
    buffer_load_dwordx4 v15, s[32:35], s61 offen lds
    v_mfma_f32_16x16x32_bf16 v[108:111], v[76:79], v[64:67], v[108:111]
    ds_read_b64_tr_b16 v[54:55], v24 offset:42304
    ds_read_b64_tr_b16 v[56:57], v24 offset:41056
    ds_read_b64_tr_b16 v[58:59], v24 offset:42336
    s_add_u32 m0, s63, 104448
    s_nop 0
    buffer_load_dwordx4 v16, s[32:35], s61 offen lds
    v_mfma_f32_16x16x32_bf16 v[112:115], v[80:83], v[64:67], v[112:115]
    ds_read_b64_tr_b16 v[60:61], v24 offset:41088
    ds_read_b64_tr_b16 v[62:63], v24 offset:42368
    s_add_u32 m0, s63, 105472
    s_nop 0
    buffer_load_dwordx4 v17, s[32:35], s61 offen lds
    v_mfma_f32_16x16x32_bf16 v[116:119], v[84:87], v[64:67], v[116:119]
    s_add_u32 m0, s63, 106496
    s_nop 0
    buffer_load_dwordx4 v18, s[32:35], s61 offen lds
    s_add_u32 s61, s61, 163840
    s_waitcnt lgkmcnt(0)
    v_mfma_f32_16x16x32_bf16 v[100:103], v[44:47], v[40:43], v[100:103]
    ds_read_b128 v[64:67], v21 offset:32768
    ds_read_b64_tr_b16 v[68:69], v24 offset:46080
    ds_read_b64_tr_b16 v[70:71], v24 offset:47360
    v_mfma_f32_16x16x32_bf16 v[104:107], v[48:51], v[40:43], v[104:107]
    ds_read_b64_tr_b16 v[72:73], v24 offset:46112
    ds_read_b64_tr_b16 v[74:75], v24 offset:47392
    ds_read_b64_tr_b16 v[76:77], v24 offset:46144
    v_mfma_f32_16x16x32_bf16 v[108:111], v[52:55], v[40:43], v[108:111]
    ds_read_b64_tr_b16 v[78:79], v24 offset:47424
    ds_read_b64_tr_b16 v[80:81], v24 offset:46176
    ds_read_b64_tr_b16 v[82:83], v24 offset:47456
    v_mfma_f32_16x16x32_bf16 v[112:115], v[56:59], v[40:43], v[112:115]
    ds_read_b64_tr_b16 v[84:85], v24 offset:46208
    ds_read_b64_tr_b16 v[86:87], v24 offset:47488
    v_mfma_f32_16x16x32_bf16 v[116:119], v[60:63], v[40:43], v[116:119]
    s_waitcnt lgkmcnt(0)
    v_mfma_f32_16x16x32_bf16 v[100:103], v[68:71], v[64:67], v[100:103]
    ds_read_b128 v[40:43], v22 offset:32768
    ds_read_b64_tr_b16 v[44:45], v24 offset:51200
    ds_read_b64_tr_b16 v[46:47], v24 offset:52480
    v_mfma_f32_16x16x32_bf16 v[104:107], v[72:75], v[64:67], v[104:107]
    ds_read_b64_tr_b16 v[48:49], v24 offset:51232
    ds_read_b64_tr_b16 v[50:51], v24 offset:52512
    ds_read_b64_tr_b16 v[52:53], v24 offset:51264
    v_mfma_f32_16x16x32_bf16 v[108:111], v[76:79], v[64:67], v[108:111]
    ds_read_b64_tr_b16 v[54:55], v24 offset:52544
    ds_read_b64_tr_b16 v[56:57], v24 offset:51296
    ds_read_b64_tr_b16 v[58:59], v24 offset:52576
    v_mfma_f32_16x16x32_bf16 v[112:115], v[80:83], v[64:67], v[112:115]
    ds_read_b64_tr_b16 v[60:61], v24 offset:51328
    ds_read_b64_tr_b16 v[62:63], v24 offset:52608
    v_mfma_f32_16x16x32_bf16 v[116:119], v[84:87], v[64:67], v[116:119]
    s_waitcnt lgkmcnt(0)
    v_mfma_f32_16x16x32_bf16 v[100:103], v[44:47], v[40:43], v[100:103]
    ds_read_b128 v[64:67], v23 offset:32768
    ds_read_b64_tr_b16 v[68:69], v24 offset:56320
    ds_read_b64_tr_b16 v[70:71], v24 offset:57600
    v_mfma_f32_16x16x32_bf16 v[104:107], v[48:51], v[40:43], v[104:107]
    ds_read_b64_tr_b16 v[72:73], v24 offset:56352
    ds_read_b64_tr_b16 v[74:75], v24 offset:57632
    ds_read_b64_tr_b16 v[76:77], v24 offset:56384
    v_mfma_f32_16x16x32_bf16 v[108:111], v[52:55], v[40:43], v[108:111]
    ds_read_b64_tr_b16 v[78:79], v24 offset:57664
    ds_read_b64_tr_b16 v[80:81], v24 offset:56416
    ds_read_b64_tr_b16 v[82:83], v24 offset:57696
    v_mfma_f32_16x16x32_bf16 v[112:115], v[56:59], v[40:43], v[112:115]
    ds_read_b64_tr_b16 v[84:85], v24 offset:56448
    ds_read_b64_tr_b16 v[86:87], v24 offset:57728
    v_mfma_f32_16x16x32_bf16 v[116:119], v[60:63], v[40:43], v[116:119]
    s_waitcnt lgkmcnt(0)
    s_waitcnt vmcnt(5)
    s_barrier
    v_mfma_f32_16x16x32_bf16 v[100:103], v[68:71], v[64:67], v[100:103]
    ds_read_b128 v[40:43], v20 offset:49152
    ds_read_b64_tr_b16 v[44:45], v24 offset:0
    ds_read_b64_tr_b16 v[46:47], v24 offset:1280
    v_mfma_f32_16x16x32_bf16 v[104:107], v[72:75], v[64:67], v[104:107]
    ds_read_b64_tr_b16 v[48:49], v24 offset:32
    ds_read_b64_tr_b16 v[50:51], v24 offset:1312
    ds_read_b64_tr_b16 v[52:53], v24 offset:64
    v_mfma_f32_16x16x32_bf16 v[108:111], v[76:79], v[64:67], v[108:111]
    ds_read_b64_tr_b16 v[54:55], v24 offset:1344
    ds_read_b64_tr_b16 v[56:57], v24 offset:96
    ds_read_b64_tr_b16 v[58:59], v24 offset:1376
    v_mfma_f32_16x16x32_bf16 v[112:115], v[80:83], v[64:67], v[112:115]
    ds_read_b64_tr_b16 v[60:61], v24 offset:128
    ds_read_b64_tr_b16 v[62:63], v24 offset:1408
    v_mfma_f32_16x16x32_bf16 v[116:119], v[84:87], v[64:67], v[116:119]
    s_waitcnt lgkmcnt(0)
    v_mfma_f32_16x16x32_bf16 v[100:103], v[44:47], v[40:43], v[100:103]
    ds_read_b128 v[64:67], v21 offset:49152
    ds_read_b64_tr_b16 v[68:69], v24 offset:5120
    ds_read_b64_tr_b16 v[70:71], v24 offset:6400
    v_mfma_f32_16x16x32_bf16 v[104:107], v[48:51], v[40:43], v[104:107]
    ds_read_b64_tr_b16 v[72:73], v24 offset:5152
    ds_read_b64_tr_b16 v[74:75], v24 offset:6432
    ds_read_b64_tr_b16 v[76:77], v24 offset:5184
    v_mfma_f32_16x16x32_bf16 v[108:111], v[52:55], v[40:43], v[108:111]
    ds_read_b64_tr_b16 v[78:79], v24 offset:6464
    ds_read_b64_tr_b16 v[80:81], v24 offset:5216
    ds_read_b64_tr_b16 v[82:83], v24 offset:6496
    v_mfma_f32_16x16x32_bf16 v[112:115], v[56:59], v[40:43], v[112:115]
    ds_read_b64_tr_b16 v[84:85], v24 offset:5248
    ds_read_b64_tr_b16 v[86:87], v24 offset:6528
    v_mfma_f32_16x16x32_bf16 v[116:119], v[60:63], v[40:43], v[116:119]
    s_waitcnt lgkmcnt(0)
    v_mfma_f32_16x16x32_bf16 v[100:103], v[68:71], v[64:67], v[100:103]
    ds_read_b128 v[40:43], v22 offset:49152
    ds_read_b64_tr_b16 v[44:45], v24 offset:10240
    ds_read_b64_tr_b16 v[46:47], v24 offset:11520
    v_mfma_f32_16x16x32_bf16 v[104:107], v[72:75], v[64:67], v[104:107]
    ds_read_b64_tr_b16 v[48:49], v24 offset:10272
    ds_read_b64_tr_b16 v[50:51], v24 offset:11552
    ds_read_b64_tr_b16 v[52:53], v24 offset:10304
    v_mfma_f32_16x16x32_bf16 v[108:111], v[76:79], v[64:67], v[108:111]
    ds_read_b64_tr_b16 v[54:55], v24 offset:11584
    ds_read_b64_tr_b16 v[56:57], v24 offset:10336
    ds_read_b64_tr_b16 v[58:59], v24 offset:11616
    v_mfma_f32_16x16x32_bf16 v[112:115], v[80:83], v[64:67], v[112:115]
    ds_read_b64_tr_b16 v[60:61], v24 offset:10368
    ds_read_b64_tr_b16 v[62:63], v24 offset:11648
    v_mfma_f32_16x16x32_bf16 v[116:119], v[84:87], v[64:67], v[116:119]
    s_waitcnt lgkmcnt(0)
    v_mfma_f32_16x16x32_bf16 v[100:103], v[44:47], v[40:43], v[100:103]
    ds_read_b128 v[64:67], v23 offset:49152
    ds_read_b64_tr_b16 v[68:69], v24 offset:15360
    ds_read_b64_tr_b16 v[70:71], v24 offset:16640
    v_mfma_f32_16x16x32_bf16 v[104:107], v[48:51], v[40:43], v[104:107]
    ds_read_b64_tr_b16 v[72:73], v24 offset:15392
    ds_read_b64_tr_b16 v[74:75], v24 offset:16672
    ds_read_b64_tr_b16 v[76:77], v24 offset:15424
    v_mfma_f32_16x16x32_bf16 v[108:111], v[52:55], v[40:43], v[108:111]
    ds_read_b64_tr_b16 v[78:79], v24 offset:16704
    ds_read_b64_tr_b16 v[80:81], v24 offset:15456
    ds_read_b64_tr_b16 v[82:83], v24 offset:16736
    v_mfma_f32_16x16x32_bf16 v[112:115], v[56:59], v[40:43], v[112:115]
    ds_read_b64_tr_b16 v[84:85], v24 offset:15488
    ds_read_b64_tr_b16 v[86:87], v24 offset:16768
    v_mfma_f32_16x16x32_bf16 v[116:119], v[60:63], v[40:43], v[116:119]
    s_waitcnt lgkmcnt(0)
    s_waitcnt vmcnt(0)
    s_barrier
    v_mfma_f32_16x16x32_bf16 v[100:103], v[68:71], v[64:67], v[100:103]
    ds_read_b128 v[40:43], v32 offset:32768
    ds_read_b64_tr_b16 v[44:45], v24 offset:20480
    ds_read_b64_tr_b16 v[46:47], v24 offset:21760
    v_mfma_f32_16x16x32_bf16 v[104:107], v[72:75], v[64:67], v[104:107]
    ds_read_b64_tr_b16 v[48:49], v24 offset:20512
    ds_read_b64_tr_b16 v[50:51], v24 offset:21792
    ds_read_b64_tr_b16 v[52:53], v24 offset:20544
    v_mfma_f32_16x16x32_bf16 v[108:111], v[76:79], v[64:67], v[108:111]
    ds_read_b64_tr_b16 v[54:55], v24 offset:21824
    ds_read_b64_tr_b16 v[56:57], v24 offset:20576
    ds_read_b64_tr_b16 v[58:59], v24 offset:21856
    v_mfma_f32_16x16x32_bf16 v[112:115], v[80:83], v[64:67], v[112:115]
    ds_read_b64_tr_b16 v[60:61], v24 offset:20608
    ds_read_b64_tr_b16 v[62:63], v24 offset:21888
    v_mfma_f32_16x16x32_bf16 v[116:119], v[84:87], v[64:67], v[116:119]
    s_waitcnt lgkmcnt(0)
    v_mfma_f32_16x16x32_bf16 v[100:103], v[44:47], v[40:43], v[100:103]
    ds_read_b128 v[64:67], v33 offset:32768
    ds_read_b64_tr_b16 v[68:69], v24 offset:25600
    ds_read_b64_tr_b16 v[70:71], v24 offset:26880
    v_mfma_f32_16x16x32_bf16 v[104:107], v[48:51], v[40:43], v[104:107]
    ds_read_b64_tr_b16 v[72:73], v24 offset:25632
    ds_read_b64_tr_b16 v[74:75], v24 offset:26912
    ds_read_b64_tr_b16 v[76:77], v24 offset:25664
    v_mfma_f32_16x16x32_bf16 v[108:111], v[52:55], v[40:43], v[108:111]
    ds_read_b64_tr_b16 v[78:79], v24 offset:26944
    ds_read_b64_tr_b16 v[80:81], v24 offset:25696
    ds_read_b64_tr_b16 v[82:83], v24 offset:26976
    v_mfma_f32_16x16x32_bf16 v[112:115], v[56:59], v[40:43], v[112:115]
    ds_read_b64_tr_b16 v[84:85], v24 offset:25728
    ds_read_b64_tr_b16 v[86:87], v24 offset:27008
    v_mfma_f32_16x16x32_bf16 v[116:119], v[60:63], v[40:43], v[116:119]
    s_waitcnt lgkmcnt(0)
    v_mfma_f32_16x16x32_bf16 v[100:103], v[68:71], v[64:67], v[100:103]
    ds_read_b128 v[40:43], v34 offset:32768
    ds_read_b64_tr_b16 v[44:45], v24 offset:30720
    ds_read_b64_tr_b16 v[46:47], v24 offset:32000
    v_mfma_f32_16x16x32_bf16 v[104:107], v[72:75], v[64:67], v[104:107]
    ds_read_b64_tr_b16 v[48:49], v24 offset:30752
    ds_read_b64_tr_b16 v[50:51], v24 offset:32032
    ds_read_b64_tr_b16 v[52:53], v24 offset:30784
    v_mfma_f32_16x16x32_bf16 v[108:111], v[76:79], v[64:67], v[108:111]
    ds_read_b64_tr_b16 v[54:55], v24 offset:32064
    ds_read_b64_tr_b16 v[56:57], v24 offset:30816
    ds_read_b64_tr_b16 v[58:59], v24 offset:32096
    v_mfma_f32_16x16x32_bf16 v[112:115], v[80:83], v[64:67], v[112:115]
    ds_read_b64_tr_b16 v[60:61], v24 offset:30848
    ds_read_b64_tr_b16 v[62:63], v24 offset:32128
    v_mfma_f32_16x16x32_bf16 v[116:119], v[84:87], v[64:67], v[116:119]
    s_waitcnt lgkmcnt(0)
    v_mfma_f32_16x16x32_bf16 v[100:103], v[44:47], v[40:43], v[100:103]
    ds_read_b128 v[64:67], v35 offset:32768
    ds_read_b64_tr_b16 v[68:69], v24 offset:35840
    ds_read_b64_tr_b16 v[70:71], v24 offset:37120
    v_mfma_f32_16x16x32_bf16 v[104:107], v[48:51], v[40:43], v[104:107]
    ds_read_b64_tr_b16 v[72:73], v24 offset:35872
    ds_read_b64_tr_b16 v[74:75], v24 offset:37152
    ds_read_b64_tr_b16 v[76:77], v24 offset:35904
    v_mfma_f32_16x16x32_bf16 v[108:111], v[52:55], v[40:43], v[108:111]
    ds_read_b64_tr_b16 v[78:79], v24 offset:37184
    ds_read_b64_tr_b16 v[80:81], v24 offset:35936
    ds_read_b64_tr_b16 v[82:83], v24 offset:37216
    v_mfma_f32_16x16x32_bf16 v[112:115], v[56:59], v[40:43], v[112:115]
    ds_read_b64_tr_b16 v[84:85], v24 offset:35968
    ds_read_b64_tr_b16 v[86:87], v24 offset:37248
    v_mfma_f32_16x16x32_bf16 v[116:119], v[60:63], v[40:43], v[116:119]
    s_waitcnt lgkmcnt(0)
    v_mfma_f32_16x16x32_bf16 v[100:103], v[68:71], v[64:67], v[100:103]
    v_mfma_f32_16x16x32_bf16 v[104:107], v[72:75], v[64:67], v[104:107]
    v_mfma_f32_16x16x32_bf16 v[108:111], v[76:79], v[64:67], v[108:111]
    v_mfma_f32_16x16x32_bf16 v[112:115], v[80:83], v[64:67], v[112:115]
    v_mfma_f32_16x16x32_bf16 v[116:119], v[84:87], v[64:67], v[116:119]
    s_nop 7
    s_nop 7
    s_waitcnt vmcnt(0) lgkmcnt(0)
    v_lshlrev_b32 v40, 16, v220
    v_and_b32 v41, 0xffff0000, v220
    v_lshlrev_b32 v42, 16, v221
    v_and_b32 v43, 0xffff0000, v221
    v_lshlrev_b32 v44, 16, v222
    v_and_b32 v45, 0xffff0000, v222
    v_lshlrev_b32 v46, 16, v223
    v_and_b32 v47, 0xffff0000, v223
    v_lshlrev_b32 v48, 16, v224
    v_and_b32 v49, 0xffff0000, v224
    v_lshlrev_b32 v50, 16, v225
    v_and_b32 v51, 0xffff0000, v225
    v_lshlrev_b32 v52, 16, v226
    v_and_b32 v53, 0xffff0000, v226
    v_lshlrev_b32 v54, 16, v227
    v_and_b32 v55, 0xffff0000, v227
    v_lshlrev_b32 v56, 16, v228
    v_and_b32 v57, 0xffff0000, v228
    v_lshlrev_b32 v58, 16, v229
    v_and_b32 v59, 0xffff0000, v229
    v_add_f32 v100, v100, v40
    v_add_f32 v101, v101, v41
    v_add_f32 v102, v102, v42
    v_add_f32 v103, v103, v43
    v_add_f32 v104, v104, v44
    v_add_f32 v105, v105, v45
    v_add_f32 v106, v106, v46
    v_add_f32 v107, v107, v47
    v_add_f32 v108, v108, v48
    v_add_f32 v109, v109, v49
    v_add_f32 v110, v110, v50
    v_add_f32 v111, v111, v51
    v_add_f32 v112, v112, v52
    v_add_f32 v113, v113, v53
    v_add_f32 v114, v114, v54
    v_add_f32 v115, v115, v55
    v_add_f32 v116, v116, v56
    v_add_f32 v117, v117, v57
    v_add_f32 v118, v118, v58
    v_add_f32 v119, v119, v59
    v_cvt_pk_bf16_f32 v80, v100, v101
    v_cvt_pk_bf16_f32 v81, v102, v103
    v_cvt_pk_bf16_f32 v82, v104, v105
    v_cvt_pk_bf16_f32 v83, v106, v107
    v_cvt_pk_bf16_f32 v84, v108, v109
    v_cvt_pk_bf16_f32 v85, v110, v111
    v_cvt_pk_bf16_f32 v86, v112, v113
    v_cvt_pk_bf16_f32 v87, v114, v115
    v_cvt_pk_bf16_f32 v88, v116, v117
    v_cvt_pk_bf16_f32 v89, v118, v119
    buffer_store_dwordx2 v[80:81], v30, s[44:47], 0 offen offset:0
    buffer_store_dwordx2 v[82:83], v30, s[44:47], 0 offen offset:32
    buffer_store_dwordx2 v[84:85], v30, s[44:47], 0 offen offset:64
    buffer_store_dwordx2 v[86:87], v30, s[44:47], 0 offen offset:96
    buffer_store_dwordx2 v[88:89], v30, s[44:47], 0 offen offset:128
    v_lshlrev_b32 v100, 16, v80
    v_and_b32 v101, 0xffff0000, v80
    v_lshlrev_b32 v102, 16, v81
    v_and_b32 v103, 0xffff0000, v81
    v_lshlrev_b32 v104, 16, v82
    v_and_b32 v105, 0xffff0000, v82
    v_lshlrev_b32 v106, 16, v83
    v_and_b32 v107, 0xffff0000, v83
    v_lshlrev_b32 v108, 16, v84
    v_and_b32 v109, 0xffff0000, v84
    v_lshlrev_b32 v110, 16, v85
    v_and_b32 v111, 0xffff0000, v85
    v_lshlrev_b32 v112, 16, v86
    v_and_b32 v113, 0xffff0000, v86
    v_lshlrev_b32 v114, 16, v87
    v_and_b32 v115, 0xffff0000, v87
    v_lshlrev_b32 v116, 16, v88
    v_and_b32 v117, 0xffff0000, v88
    v_lshlrev_b32 v118, 16, v89
    v_and_b32 v119, 0xffff0000, v89
    v_add_f32 v4, v100, v101
    v_add_f32 v4, v4, v102
    v_add_f32 v4, v4, v103
    v_add_f32 v4, v4, v104
    v_add_f32 v4, v4, v105
    v_add_f32 v4, v4, v106
    v_add_f32 v4, v4, v107
    v_add_f32 v4, v4, v108
    v_add_f32 v4, v4, v109
    v_add_f32 v4, v4, v110
    v_add_f32 v4, v4, v111
    v_add_f32 v4, v4, v112
    v_add_f32 v4, v4, v113
    v_add_f32 v4, v4, v114
    v_add_f32 v4, v4, v115
    v_add_f32 v4, v4, v116
    v_add_f32 v4, v4, v117
    v_add_f32 v4, v4, v118
    v_add_f32 v4, v4, v119
    ds_swizzle_b32 v5, v4 offset:0x401F
    s_waitcnt lgkmcnt(0)
    v_add_f32 v4, v4, v5
    v_mov_b32 v5, v4
    s_nop 1
    v_xor_b32 v6, 32, v1
    v_lshlrev_b32 v6, 2, v6
    ds_bpermute_b32 v5, v6, v4
    s_waitcnt lgkmcnt(0)
    v_add_f32 v4, v4, v5
    v_mul_f32 v7, 1011666125, v4
    v_mov_b32 v8, 0
    v_sub_f32 v9, v100, v7
    v_fma_f32 v8, v9, v9, v8
    v_sub_f32 v9, v101, v7
    v_fma_f32 v8, v9, v9, v8
    v_sub_f32 v9, v102, v7
    v_fma_f32 v8, v9, v9, v8
    v_sub_f32 v9, v103, v7
    v_fma_f32 v8, v9, v9, v8
    v_sub_f32 v9, v104, v7
    v_fma_f32 v8, v9, v9, v8
    v_sub_f32 v9, v105, v7
    v_fma_f32 v8, v9, v9, v8
    v_sub_f32 v9, v106, v7
    v_fma_f32 v8, v9, v9, v8
    v_sub_f32 v9, v107, v7
    v_fma_f32 v8, v9, v9, v8
    v_sub_f32 v9, v108, v7
    v_fma_f32 v8, v9, v9, v8
    v_sub_f32 v9, v109, v7
    v_fma_f32 v8, v9, v9, v8
    v_sub_f32 v9, v110, v7
    v_fma_f32 v8, v9, v9, v8
    v_sub_f32 v9, v111, v7
    v_fma_f32 v8, v9, v9, v8
    v_sub_f32 v9, v112, v7
    v_fma_f32 v8, v9, v9, v8
    v_sub_f32 v9, v113, v7
    v_fma_f32 v8, v9, v9, v8
    v_sub_f32 v9, v114, v7
    v_fma_f32 v8, v9, v9, v8
    v_sub_f32 v9, v115, v7
    v_fma_f32 v8, v9, v9, v8
    v_sub_f32 v9, v116, v7
    v_fma_f32 v8, v9, v9, v8
    v_sub_f32 v9, v117, v7
    v_fma_f32 v8, v9, v9, v8
    v_sub_f32 v9, v118, v7
    v_fma_f32 v8, v9, v9, v8
    v_sub_f32 v9, v119, v7
    v_fma_f32 v8, v9, v9, v8
    ds_swizzle_b32 v5, v8 offset:0x401F
    s_waitcnt lgkmcnt(0)
    v_add_f32 v8, v8, v5
    ds_bpermute_b32 v5, v6, v8
    s_waitcnt lgkmcnt(0)
    v_add_f32 v5, v8, v5
    s_lshl_b32 s54, s52, 6
    s_lshl_b32 s58, s26, 4
    s_add_u32 s54, s54, s58
    v_add_u32 v10, s54, v2
    v_lshlrev_b32 v10, 6, v10
    s_lshl_b32 s55, s53, 3
    v_cmp_eq_u32 vcc, 0, v3
    s_and_saveexec_b64 s[56:57], vcc
    buffer_store_dwordx2 v[4:5], v10, s[48:51], s55 offen
    s_mov_b64 exec, s[56:57]
    s_waitcnt vmcnt(0)
K2_end:
    s_endpgm
.globl k4_l0_kernel
.p2align 8
.type k4_l0_kernel,@function
k4_l0_kernel:
    s_mov_b32 s101, 0
    s_branch K4_body
.globl k4_l1_kernel
.p2align 8
.type k4_l1_kernel,@function
k4_l1_kernel:
    s_mov_b32 s101, 1
    s_branch K4_body
.p2align 8
K4_body:
    s_load_dwordx16 s[4:19], s[0:1], 0
    s_load_dwordx4 s[20:23], s[0:1], 64
    s_load_dwordx2 s[24:25], s[0:1], 80
    s_cmp_ge_u32 s2, 256
    s_cbranch_scc1 K4_end
    v_lshrrev_b32 v1, 6, v0
    s_nop 0
    v_readfirstlane_b32 s26, v1
    s_waitcnt lgkmcnt(0)
    s_and_b32 s52, s2, 31
    s_lshr_b32 s53, s2, 5
    s_mul_i32 s42, s101, 6291456
    s_add_u32 s40, s24, s42
    s_addc_u32 s41, s25, 0
    s_mov_b32 s36, s40
    s_mov_b32 s37, s41
    s_mov_b32 s38, 2621440
    s_mov_b32 s39, 0x00020000
    s_add_u32 s40, s24, 3145728
    s_addc_u32 s41, s25, 0
    s_cmp_eq_u32 s101, 0
    s_cselect_b32 s40, s40, s20
    s_cselect_b32 s41, s41, s21
    s_mov_b32 s44, s40
    s_mov_b32 s45, s41
    s_mov_b32 s46, 2621440
    s_mov_b32 s47, 0x00020000
    s_mov_b32 s42, 21757952
    s_mov_b32 s32, s16
    s_mov_b32 s33, s17
    s_mov_b32 s34, 2211840
    s_mov_b32 s35, 0x00020000
    s_add_u32 s28, s24, 12582912
    s_addc_u32 s29, s25, 0
    s_mov_b32 s30, 7077888
    s_mov_b32 s31, 0x00020000
    s_mov_b32 s68, s18
    s_mov_b32 s69, s19
    s_mov_b32 s70, 1280
    s_mov_b32 s71, 0x00020000
    s_add_u32 s48, s24, s42
    s_addc_u32 s49, s25, 0
    s_mov_b32 s50, 131072
    s_mov_b32 s51, 0x00020000
    v_and_b32 v1, 63, v0
    v_and_b32 v2, 15, v1
    v_lshrrev_b32 v3, 4, v1
    s_lshl_b32 s54, s52, 6
    s_lshl_b32 s58, s26, 4
    s_add_u32 s54, s54, s58
    v_add_u32 v4, s54, v2
    v_mul_u32_u24 v5, 1280, v4
    s_mul_i32 s55, s53, 160
    v_lshlrev_b32 v6, 3, v3
    v_add_u32 v5, v5, v6
    v_add_u32 v30, s55, v5
    v_lshrrev_b32 v4, 4, v1
    v_and_b32 v5, 15, v1
    s_lshl_b32 s58, s26, 4
    v_add_u32 v6, s58, v4
    v_add_u32 v6, 0, v6
    v_and_b32 v7, 15, v6
    v_xor_b32 v7, v7, v5
    v_lshlrev_b32 v7, 4, v7
    v_mul_u32_u24 v6, 3456, v6
    v_add_u32 v10, v6, v7
    v_add_u32 v6, s58, v4
    v_add_u32 v6, 4, v6
    v_and_b32 v7, 15, v6
    v_xor_b32 v7, v7, v5
    v_lshlrev_b32 v7, 4, v7
    v_mul_u32_u24 v6, 3456, v6
    v_add_u32 v11, v6, v7
    v_add_u32 v6, s58, v4
    v_add_u32 v6, 8, v6
    v_and_b32 v7, 15, v6
    v_xor_b32 v7, v7, v5
    v_lshlrev_b32 v7, 4, v7
    v_mul_u32_u24 v6, 3456, v6
    v_add_u32 v12, v6, v7
    v_add_u32 v6, s58, v4
    v_add_u32 v6, 12, v6
    v_and_b32 v7, 15, v6
    v_xor_b32 v7, v7, v5
    v_lshlrev_b32 v7, 4, v7
    v_mul_u32_u24 v6, 3456, v6
    v_add_u32 v13, v6, v7
    s_mul_i32 s58, s26, 320
    v_add_u32 v4, s58, v1
    v_add_u32 v4, 0, v4
    v_mov_b32 v7, 1639
    v_mul_u32_u24 v5, v7, v4
    v_lshrrev_b32 v5, 14, v5
    v_mul_u32_u24 v7, 10, v5
    v_sub_u32 v6, v4, v7
    v_and_b32 v7, 0x73, v5
    v_and_b32 v8, 4, v5
    v_lshlrev_b32 v8, 1, v8
    v_or_b32 v7, v7, v8
    v_and_b32 v8, 8, v5
    v_lshrrev_b32 v8, 1, v8
    v_or_b32 v7, v7, v8
    v_mul_u32_u24 v7, 1280, v7
    v_lshlrev_b32 v6, 4, v6
    v_add_u32 v14, v7, v6
    v_add_u32 v4, s58, v1
    v_add_u32 v4, 64, v4
    v_mov_b32 v7, 1639
    v_mul_u32_u24 v5, v7, v4
    v_lshrrev_b32 v5, 14, v5
    v_mul_u32_u24 v7, 10, v5
    v_sub_u32 v6, v4, v7
    v_and_b32 v7, 0x73, v5
    v_and_b32 v8, 4, v5
    v_lshlrev_b32 v8, 1, v8
    v_or_b32 v7, v7, v8
    v_and_b32 v8, 8, v5
    v_lshrrev_b32 v8, 1, v8
    v_or_b32 v7, v7, v8
    v_mul_u32_u24 v7, 1280, v7
    v_lshlrev_b32 v6, 4, v6
    v_add_u32 v15, v7, v6
    v_add_u32 v4, s58, v1
    v_add_u32 v4, 128, v4
    v_mov_b32 v7, 1639
    v_mul_u32_u24 v5, v7, v4
    v_lshrrev_b32 v5, 14, v5
    v_mul_u32_u24 v7, 10, v5
    v_sub_u32 v6, v4, v7
    v_and_b32 v7, 0x73, v5
    v_and_b32 v8, 4, v5
    v_lshlrev_b32 v8, 1, v8
    v_or_b32 v7, v7, v8
    v_and_b32 v8, 8, v5
    v_lshrrev_b32 v8, 1, v8
    v_or_b32 v7, v7, v8
    v_mul_u32_u24 v7, 1280, v7
    v_lshlrev_b32 v6, 4, v6
    v_add_u32 v16, v7, v6
    v_add_u32 v4, s58, v1
    v_add_u32 v4, 192, v4
    v_mov_b32 v7, 1639
    v_mul_u32_u24 v5, v7, v4
    v_lshrrev_b32 v5, 14, v5
    v_mul_u32_u24 v7, 10, v5
    v_sub_u32 v6, v4, v7
    v_and_b32 v7, 0x73, v5
    v_and_b32 v8, 4, v5
    v_lshlrev_b32 v8, 1, v8
    v_or_b32 v7, v7, v8
    v_and_b32 v8, 8, v5
    v_lshrrev_b32 v8, 1, v8
    v_or_b32 v7, v7, v8
    v_mul_u32_u24 v7, 1280, v7
    v_lshlrev_b32 v6, 4, v6
    v_add_u32 v17, v7, v6
    v_add_u32 v4, s58, v1
    v_add_u32 v4, 256, v4
    v_mov_b32 v7, 1639
    v_mul_u32_u24 v5, v7, v4
    v_lshrrev_b32 v5, 14, v5
    v_mul_u32_u24 v7, 10, v5
    v_sub_u32 v6, v4, v7
    v_and_b32 v7, 0x73, v5
    v_and_b32 v8, 4, v5
    v_lshlrev_b32 v8, 1, v8
    v_or_b32 v7, v7, v8
    v_and_b32 v8, 8, v5
    v_lshrrev_b32 v8, 1, v8
    v_or_b32 v7, v7, v8
    v_mul_u32_u24 v7, 1280, v7
    v_lshlrev_b32 v6, 4, v6
    v_add_u32 v18, v7, v6
    s_mul_i32 s60, s52, 221184
    s_mul_i32 s61, s53, 160
    s_lshl_b32 s62, s26, 12
    s_mul_i32 s63, s26, 5120
    s_lshl_b32 s58, s26, 4
    v_add_u32 v4, s58, v2
    v_and_b32 v5, 15, v4
    v_add_u32 v6, 0, v3
    v_xor_b32 v6, v6, v5
    v_lshlrev_b32 v6, 4, v6
    v_lshlrev_b32 v7, 8, v4
    v_add_u32 v20, v6, v7
    v_add_u32 v32, 0x8000, v20
    v_add_u32 v6, 4, v3
    v_xor_b32 v6, v6, v5
    v_lshlrev_b32 v6, 4, v6
    v_lshlrev_b32 v7, 8, v4
    v_add_u32 v21, v6, v7
    v_add_u32 v33, 0x8000, v21
    v_add_u32 v6, 8, v3
    v_xor_b32 v6, v6, v5
    v_lshlrev_b32 v6, 4, v6
    v_lshlrev_b32 v7, 8, v4
    v_add_u32 v22, v6, v7
    v_add_u32 v34, 0x8000, v22
    v_add_u32 v6, 12, v3
    v_xor_b32 v6, v6, v5
    v_lshlrev_b32 v6, 4, v6
    v_lshlrev_b32 v7, 8, v4
    v_add_u32 v23, v6, v7
    v_add_u32 v35, 0x8000, v23
    v_lshrrev_b32 v4, 2, v2
    v_and_b32 v5, 3, v2
    v_lshrrev_b32 v6, 1, v3
    v_lshlrev_b32 v6, 4, v6
    v_and_b32 v7, 1, v3
    v_lshlrev_b32 v7, 2, v7
    v_add_u32 v4, v4, v6
    v_add_u32 v4, v4, v7
    v_mul_u32_u24 v4, 160, v4
    v_lshlrev_b32 v5, 3, v5
    v_add_u32 v4, v4, v5
    v_add_u32 v24, 65536, v4
    v_add_u32 v25, 106496, v4
    buffer_load_dwordx2 v[220:221], v30, s[36:39], 0 offen offset:0
    buffer_load_dwordx2 v[222:223], v30, s[36:39], 0 offen offset:32
    buffer_load_dwordx2 v[224:225], v30, s[36:39], 0 offen offset:64
    buffer_load_dwordx2 v[226:227], v30, s[36:39], 0 offen offset:96
    buffer_load_dwordx2 v[228:229], v30, s[36:39], 0 offen offset:128
    s_mul_i32 s55, s53, 160
    v_lshlrev_b32 v6, 3, v3
    v_add_u32 v6, s55, v6
    buffer_load_dwordx2 v[230:231], v6, s[68:71], 0 offen offset:0
    buffer_load_dwordx2 v[232:233], v6, s[68:71], 0 offen offset:32
    buffer_load_dwordx2 v[234:235], v6, s[68:71], 0 offen offset:64
    buffer_load_dwordx2 v[236:237], v6, s[68:71], 0 offen offset:96
    buffer_load_dwordx2 v[238:239], v6, s[68:71], 0 offen offset:128
    v_mov_b32 v100, 0
    v_mov_b32 v101, 0
    v_mov_b32 v102, 0
    v_mov_b32 v103, 0
    v_mov_b32 v104, 0
    v_mov_b32 v105, 0
    v_mov_b32 v106, 0
    v_mov_b32 v107, 0
    v_mov_b32 v108, 0
    v_mov_b32 v109, 0
    v_mov_b32 v110, 0
    v_mov_b32 v111, 0
    v_mov_b32 v112, 0
    v_mov_b32 v113, 0
    v_mov_b32 v114, 0
    v_mov_b32 v115, 0
    v_mov_b32 v116, 0
    v_mov_b32 v117, 0
    v_mov_b32 v118, 0
    v_mov_b32 v119, 0
    s_add_u32 m0, s62, 0
    s_nop 0
    buffer_load_dwordx4 v10, s[28:31], s60 offen lds
    s_add_u32 m0, s62, 1024
    s_nop 0
    buffer_load_dwordx4 v11, s[28:31], s60 offen lds
    s_add_u32 m0, s62, 2048
    s_nop 0
    buffer_load_dwordx4 v12, s[28:31], s60 offen lds
    s_add_u32 m0, s62, 3072
    s_nop 0
    buffer_load_dwordx4 v13, s[28:31], s60 offen lds
    s_add_u32 s60, s60, 256
    s_add_u32 m0, s63, 65536
    s_nop 0
    buffer_load_dwordx4 v14, s[32:35], s61 offen lds
    s_add_u32 m0, s63, 66560
    s_nop 0
    buffer_load_dwordx4 v15, s[32:35], s61 offen lds
    s_add_u32 m0, s63, 67584
    s_nop 0
    buffer_load_dwordx4 v16, s[32:35], s61 offen lds
    s_add_u32 m0, s63, 68608
    s_nop 0
    buffer_load_dwordx4 v17, s[32:35], s61 offen lds
    s_add_u32 m0, s63, 69632
    s_nop 0
    buffer_load_dwordx4 v18, s[32:35], s61 offen lds
    s_add_u32 s61, s61, 163840
    s_add_u32 m0, s62, 16384
    s_nop 0
    buffer_load_dwordx4 v10, s[28:31], s60 offen lds
    s_add_u32 m0, s62, 17408
    s_nop 0
    buffer_load_dwordx4 v11, s[28:31], s60 offen lds
    s_add_u32 m0, s62, 18432
    s_nop 0
    buffer_load_dwordx4 v12, s[28:31], s60 offen lds
    s_add_u32 m0, s62, 19456
    s_nop 0
    buffer_load_dwordx4 v13, s[28:31], s60 offen lds
    s_add_u32 s60, s60, 256
    s_add_u32 m0, s63, 86016
    s_nop 0
    buffer_load_dwordx4 v14, s[32:35], s61 offen lds
    s_add_u32 m0, s63, 87040
    s_nop 0
    buffer_load_dwordx4 v15, s[32:35], s61 offen lds
    s_add_u32 m0, s63, 88064
    s_nop 0
    buffer_load_dwordx4 v16, s[32:35], s61 offen lds
    s_add_u32 m0, s63, 89088
    s_nop 0
    buffer_load_dwordx4 v17, s[32:35], s61 offen lds
    s_add_u32 m0, s63, 90112
    s_nop 0
    buffer_load_dwordx4 v18, s[32:35], s61 offen lds
    s_add_u32 s61, s61, 163840
    s_add_u32 m0, s62, 32768
    s_nop 0
    buffer_load_dwordx4 v10, s[28:31], s60 offen lds
    s_add_u32 m0, s62, 33792
    s_nop 0
    buffer_load_dwordx4 v11, s[28:31], s60 offen lds
    s_add_u32 m0, s62, 34816
    s_nop 0
    buffer_load_dwordx4 v12, s[28:31], s60 offen lds
    s_add_u32 m0, s62, 35840
    s_nop 0
    buffer_load_dwordx4 v13, s[28:31], s60 offen lds
    s_add_u32 s60, s60, 256
    s_add_u32 m0, s63, 106496
    s_nop 0
    buffer_load_dwordx4 v14, s[32:35], s61 offen lds
    s_add_u32 m0, s63, 107520
    s_nop 0
    buffer_load_dwordx4 v15, s[32:35], s61 offen lds
    s_add_u32 m0, s63, 108544
    s_nop 0
    buffer_load_dwordx4 v16, s[32:35], s61 offen lds
    s_add_u32 m0, s63, 109568
    s_nop 0
    buffer_load_dwordx4 v17, s[32:35], s61 offen lds
    s_add_u32 m0, s63, 110592
    s_nop 0
    buffer_load_dwordx4 v18, s[32:35], s61 offen lds
    s_add_u32 s61, s61, 163840
    s_waitcnt vmcnt(18)
    s_barrier
    ds_read_b128 v[40:43], v20 offset:0
    ds_read_b64_tr_b16 v[44:45], v24 offset:0
    ds_read_b64_tr_b16 v[46:47], v24 offset:1280
    ds_read_b64_tr_b16 v[48:49], v24 offset:32
    ds_read_b64_tr_b16 v[50:51], v24 offset:1312
    ds_read_b64_tr_b16 v[52:53], v24 offset:64
    ds_read_b64_tr_b16 v[54:55], v24 offset:1344
    ds_read_b64_tr_b16 v[56:57], v24 offset:96
    ds_read_b64_tr_b16 v[58:59], v24 offset:1376
    ds_read_b64_tr_b16 v[60:61], v24 offset:128
    ds_read_b64_tr_b16 v[62:63], v24 offset:1408
    s_waitcnt lgkmcnt(0)
    v_mfma_f32_16x16x32_bf16 v[100:103], v[44:47], v[40:43], v[100:103]
    ds_read_b128 v[64:67], v21 offset:0
    ds_read_b64_tr_b16 v[68:69], v24 offset:5120
    ds_read_b64_tr_b16 v[70:71], v24 offset:6400
    v_mfma_f32_16x16x32_bf16 v[104:107], v[48:51], v[40:43], v[104:107]
    ds_read_b64_tr_b16 v[72:73], v24 offset:5152
    ds_read_b64_tr_b16 v[74:75], v24 offset:6432
    ds_read_b64_tr_b16 v[76:77], v24 offset:5184
    s_add_u32 m0, s62, 49152
    s_nop 0
    buffer_load_dwordx4 v10, s[28:31], s60 offen lds
    v_mfma_f32_16x16x32_bf16 v[108:111], v[52:55], v[40:43], v[108:111]
    ds_read_b64_tr_b16 v[78:79], v24 offset:6464
    ds_read_b64_tr_b16 v[80:81], v24 offset:5216
    ds_read_b64_tr_b16 v[82:83], v24 offset:6496
    s_add_u32 m0, s62, 50176
    s_nop 0
    buffer_load_dwordx4 v11, s[28:31], s60 offen lds
    v_mfma_f32_16x16x32_bf16 v[112:115], v[56:59], v[40:43], v[112:115]
    ds_read_b64_tr_b16 v[84:85], v24 offset:5248
    ds_read_b64_tr_b16 v[86:87], v24 offset:6528
    s_add_u32 m0, s62, 51200
    s_nop 0
    buffer_load_dwordx4 v12, s[28:31], s60 offen lds
    v_mfma_f32_16x16x32_bf16 v[116:119], v[60:63], v[40:43], v[116:119]
    s_waitcnt lgkmcnt(0)
    v_mfma_f32_16x16x32_bf16 v[100:103], v[68:71], v[64:67], v[100:103]
    ds_read_b128 v[40:43], v22 offset:0
    ds_read_b64_tr_b16 v[44:45], v24 offset:10240
    ds_read_b64_tr_b16 v[46:47], v24 offset:11520
    v_mfma_f32_16x16x32_bf16 v[104:107], v[72:75], v[64:67], v[104:107]
    ds_read_b64_tr_b16 v[48:49], v24 offset:10272
    ds_read_b64_tr_b16 v[50:51], v24 offset:11552
    ds_read_b64_tr_b16 v[52:53], v24 offset:10304
    s_add_u32 m0, s62, 52224
    s_nop 0
    buffer_load_dwordx4 v13, s[28:31], s60 offen lds
    s_add_u32 s60, s60, 256
    v_mfma_f32_16x16x32_bf16 v[108:111], v[76:79], v[64:67], v[108:111]
    ds_read_b64_tr_b16 v[54:55], v24 offset:11584
    ds_read_b64_tr_b16 v[56:57], v24 offset:10336
    ds_read_b64_tr_b16 v[58:59], v24 offset:11616
    v_mfma_f32_16x16x32_bf16 v[112:115], v[80:83], v[64:67], v[112:115]
    ds_read_b64_tr_b16 v[60:61], v24 offset:10368
    ds_read_b64_tr_b16 v[62:63], v24 offset:11648
    s_add_u32 m0, s63, 126976
    s_nop 0
    buffer_load_dwordx4 v14, s[32:35], s61 offen lds
    v_mfma_f32_16x16x32_bf16 v[116:119], v[84:87], v[64:67], v[116:119]
    s_waitcnt lgkmcnt(0)
    v_mfma_f32_16x16x32_bf16 v[100:103], v[44:47], v[40:43], v[100:103]
    ds_read_b128 v[64:67], v23 offset:0
    ds_read_b64_tr_b16 v[68:69], v24 offset:15360
    ds_read_b64_tr_b16 v[70:71], v24 offset:16640
    v_mfma_f32_16x16x32_bf16 v[104:107], v[48:51], v[40:43], v[104:107]
    ds_read_b64_tr_b16 v[72:73], v24 offset:15392
    ds_read_b64_tr_b16 v[74:75], v24 offset:16672
    ds_read_b64_tr_b16 v[76:77], v24 offset:15424
    s_add_u32 m0, s63, 128000
    s_nop 0
    buffer_load_dwordx4 v15, s[32:35], s61 offen lds
    v_mfma_f32_16x16x32_bf16 v[108:111], v[52:55], v[40:43], v[108:111]
    ds_read_b64_tr_b16 v[78:79], v24 offset:16704
    ds_read_b64_tr_b16 v[80:81], v24 offset:15456
    ds_read_b64_tr_b16 v[82:83], v24 offset:16736
    v_mfma_f32_16x16x32_bf16 v[112:115], v[56:59], v[40:43], v[112:115]
    ds_read_b64_tr_b16 v[84:85], v24 offset:15488
    ds_read_b64_tr_b16 v[86:87], v24 offset:16768
    s_add_u32 m0, s63, 129024
    s_nop 0
    buffer_load_dwordx4 v16, s[32:35], s61 offen lds
    v_mfma_f32_16x16x32_bf16 v[116:119], v[60:63], v[40:43], v[116:119]
    s_waitcnt lgkmcnt(0)
    s_add_u32 m0, s63, 130048
    s_nop 0
    buffer_load_dwordx4 v17, s[32:35], s61 offen lds
    s_add_u32 m0, s63, 131072
    s_nop 0
    buffer_load_dwordx4 v18, s[32:35], s61 offen lds
    s_add_u32 s61, s61, 163840
    s_waitcnt vmcnt(18)
    s_barrier
    v_mfma_f32_16x16x32_bf16 v[100:103], v[68:71], v[64:67], v[100:103]
    ds_read_b128 v[40:43], v20 offset:16384
    ds_read_b64_tr_b16 v[44:45], v24 offset:20480
    ds_read_b64_tr_b16 v[46:47], v24 offset:21760
    v_mfma_f32_16x16x32_bf16 v[104:107], v[72:75], v[64:67], v[104:107]
    ds_read_b64_tr_b16 v[48:49], v24 offset:20512
    ds_read_b64_tr_b16 v[50:51], v24 offset:21792
    ds_read_b64_tr_b16 v[52:53], v24 offset:20544
    s_add_u32 m0, s62, 0
    s_nop 0
    buffer_load_dwordx4 v10, s[28:31], s60 offen lds
    s_add_u32 m0, s62, 1024
    s_nop 0
    buffer_load_dwordx4 v11, s[28:31], s60 offen lds
    s_add_u32 m0, s62, 2048
    s_nop 0
    buffer_load_dwordx4 v12, s[28:31], s60 offen lds
    v_mfma_f32_16x16x32_bf16 v[108:111], v[76:79], v[64:67], v[108:111]
    ds_read_b64_tr_b16 v[54:55], v24 offset:21824
    ds_read_b64_tr_b16 v[56:57], v24 offset:20576
    ds_read_b64_tr_b16 v[58:59], v24 offset:21856
    s_add_u32 m0, s62, 3072
    s_nop 0
    buffer_load_dwordx4 v13, s[28:31], s60 offen lds
    s_add_u32 s60, s60, 256
    s_add_u32 m0, s63, 65536
    s_nop 0
    buffer_load_dwordx4 v14, s[32:35], s61 offen lds
    v_mfma_f32_16x16x32_bf16 v[112:115], v[80:83], v[64:67], v[112:115]
    ds_read_b64_tr_b16 v[60:61], v24 offset:20608
    ds_read_b64_tr_b16 v[62:63], v24 offset:21888
    s_add_u32 m0, s63, 66560
    s_nop 0
    buffer_load_dwordx4 v15, s[32:35], s61 offen lds
    s_add_u32 m0, s63, 67584
    s_nop 0
    buffer_load_dwordx4 v16, s[32:35], s61 offen lds
    v_mfma_f32_16x16x32_bf16 v[116:119], v[84:87], v[64:67], v[116:119]
    s_add_u32 m0, s63, 68608
    s_nop 0
    buffer_load_dwordx4 v17, s[32:35], s61 offen lds
    s_add_u32 m0, s63, 69632
    s_nop 0
    buffer_load_dwordx4 v18, s[32:35], s61 offen lds
    s_add_u32 s61, s61, 163840
    s_waitcnt lgkmcnt(0)
    v_mfma_f32_16x16x32_bf16 v[100:103], v[44:47], v[40:43], v[100:103]
    ds_read_b128 v[64:67], v21 offset:16384
    ds_read_b64_tr_b16 v[68:69], v24 offset:25600
    ds_read_b64_tr_b16 v[70:71], v24 offset:26880
    v_mfma_f32_16x16x32_bf16 v[104:107], v[48:51], v[40:43], v[104:107]
    ds_read_b64_tr_b16 v[72:73], v24 offset:25632
    ds_read_b64_tr_b16 v[74:75], v24 offset:26912
    ds_read_b64_tr_b16 v[76:77], v24 offset:25664
    v_mfma_f32_16x16x32_bf16 v[108:111], v[52:55], v[40:43], v[108:111]
    ds_read_b64_tr_b16 v[78:79], v24 offset:26944
    ds_read_b64_tr_b16 v[80:81], v24 offset:25696
    ds_read_b64_tr_b16 v[82:83], v24 offset:26976
    v_mfma_f32_16x16x32_bf16 v[112:115], v[56:59], v[40:43], v[112:115]
    ds_read_b64_tr_b16 v[84:85], v24 offset:25728
    ds_read_b64_tr_b16 v[86:87], v24 offset:27008
    v_mfma_f32_16x16x32_bf16 v[116:119], v[60:63], v[40:43], v[116:119]
    s_waitcnt lgkmcnt(0)
    v_mfma_f32_16x16x32_bf16 v[100:103], v[68:71], v[64:67], v[100:103]
    ds_read_b128 v[40:43], v22 offset:16384
    ds_read_b64_tr_b16 v[44:45], v24 offset:30720
    ds_read_b64_tr_b16 v[46:47], v24 offset:32000
    v_mfma_f32_16x16x32_bf16 v[104:107], v[72:75], v[64:67], v[104:107]
    ds_read_b64_tr_b16 v[48:49], v24 offset:30752
    ds_read_b64_tr_b16 v[50:51], v24 offset:32032
    ds_read_b64_tr_b16 v[52:53], v24 offset:30784
    v_mfma_f32_16x16x32_bf16 v[108:111], v[76:79], v[64:67], v[108:111]
    ds_read_b64_tr_b16 v[54:55], v24 offset:32064
    ds_read_b64_tr_b16 v[56:57], v24 offset:30816
    ds_read_b64_tr_b16 v[58:59], v24 offset:32096
    v_mfma_f32_16x16x32_bf16 v[112:115], v[80:83], v[64:67], v[112:115]
    ds_read_b64_tr_b16 v[60:61], v24 offset:30848
    ds_read_b64_tr_b16 v[62:63], v24 offset:32128
    v_mfma_f32_16x16x32_bf16 v[116:119], v[84:87], v[64:67], v[116:119]
    s_waitcnt lgkmcnt(0)
    v_mfma_f32_16x16x32_bf16 v[100:103], v[44:47], v[40:43], v[100:103]
    ds_read_b128 v[64:67], v23 offset:16384
    ds_read_b64_tr_b16 v[68:69], v24 offset:35840
    ds_read_b64_tr_b16 v[70:71], v24 offset:37120
    v_mfma_f32_16x16x32_bf16 v[104:107], v[48:51], v[40:43], v[104:107]
    ds_read_b64_tr_b16 v[72:73], v24 offset:35872
    ds_read_b64_tr_b16 v[74:75], v24 offset:37152
    ds_read_b64_tr_b16 v[76:77], v24 offset:35904
    v_mfma_f32_16x16x32_bf16 v[108:111], v[52:55], v[40:43], v[108:111]
    ds_read_b64_tr_b16 v[78:79], v24 offset:37184
    ds_read_b64_tr_b16 v[80:81], v24 offset:35936
    ds_read_b64_tr_b16 v[82:83], v24 offset:37216
    v_mfma_f32_16x16x32_bf16 v[112:115], v[56:59], v[40:43], v[112:115]
    ds_read_b64_tr_b16 v[84:85], v24 offset:35968
    ds_read_b64_tr_b16 v[86:87], v24 offset:37248
    v_mfma_f32_16x16x32_bf16 v[116:119], v[60:63], v[40:43], v[116:119]
    s_waitcnt lgkmcnt(0)
    s_waitcnt vmcnt(18)
    s_barrier
    v_mfma_f32_16x16x32_bf16 v[100:103], v[68:71], v[64:67], v[100:103]
    ds_read_b128 v[40:43], v20 offset:32768
    ds_read_b64_tr_b16 v[44:45], v24 offset:40960
    ds_read_b64_tr_b16 v[46:47], v24 offset:42240
    v_mfma_f32_16x16x32_bf16 v[104:107], v[72:75], v[64:67], v[104:107]
    ds_read_b64_tr_b16 v[48:49], v24 offset:40992
    ds_read_b64_tr_b16 v[50:51], v24 offset:42272
    ds_read_b64_tr_b16 v[52:53], v24 offset:41024
    s_add_u32 m0, s62, 16384
    s_nop 0
    buffer_load_dwordx4 v10, s[28:31], s60 offen lds
    s_add_u32 m0, s62, 17408
    s_nop 0
    buffer_load_dwordx4 v11, s[28:31], s60 offen lds
    s_add_u32 m0, s62, 18432
    s_nop 0
    buffer_load_dwordx4 v12, s[28:31], s60 offen lds
    v_mfma_f32_16x16x32_bf16 v[108:111], v[76:79], v[64:67], v[108:111]
    ds_read_b64_tr_b16 v[54:55], v24 offset:42304
    ds_read_b64_tr_b16 v[56:57], v24 offset:41056
    ds_read_b64_tr_b16 v[58:59], v24 offset:42336
    s_add_u32 m0, s62, 19456
    s_nop 0
    buffer_load_dwordx4 v13, s[28:31], s60 offen lds
    s_add_u32 s60, s60, 256
    s_add_u32 m0, s63, 86016
    s_nop 0
    buffer_load_dwordx4 v14, s[32:35], s61 offen lds
    v_mfma_f32_16x16x32_bf16 v[112:115], v[80:83], v[64:67], v[112:115]
    ds_read_b64_tr_b16 v[60:61], v24 offset:41088
    ds_read_b64_tr_b16 v[62:63], v24 offset:42368
    s_add_u32 m0, s63, 87040
    s_nop 0
    buffer_load_dwordx4 v15, s[32:35], s61 offen lds
    s_add_u32 m0, s63, 88064
    s_nop 0
    buffer_load_dwordx4 v16, s[32:35], s61 offen lds
    v_mfma_f32_16x16x32_bf16 v[116:119], v[84:87], v[64:67], v[116:119]
    s_add_u32 m0, s63, 89088
    s_nop 0
    buffer_load_dwordx4 v17, s[32:35], s61 offen lds
    s_add_u32 m0, s63, 90112
    s_nop 0
    buffer_load_dwordx4 v18, s[32:35], s61 offen lds
    s_add_u32 s61, s61, 163840
    s_waitcnt lgkmcnt(0)
    v_mfma_f32_16x16x32_bf16 v[100:103], v[44:47], v[40:43], v[100:103]
    ds_read_b128 v[64:67], v21 offset:32768
    ds_read_b64_tr_b16 v[68:69], v24 offset:46080
    ds_read_b64_tr_b16 v[70:71], v24 offset:47360
    v_mfma_f32_16x16x32_bf16 v[104:107], v[48:51], v[40:43], v[104:107]
    ds_read_b64_tr_b16 v[72:73], v24 offset:46112
    ds_read_b64_tr_b16 v[74:75], v24 offset:47392
    ds_read_b64_tr_b16 v[76:77], v24 offset:46144
    v_mfma_f32_16x16x32_bf16 v[108:111], v[52:55], v[40:43], v[108:111]
    ds_read_b64_tr_b16 v[78:79], v24 offset:47424
    ds_read_b64_tr_b16 v[80:81], v24 offset:46176
    ds_read_b64_tr_b16 v[82:83], v24 offset:47456
    v_mfma_f32_16x16x32_bf16 v[112:115], v[56:59], v[40:43], v[112:115]
    ds_read_b64_tr_b16 v[84:85], v24 offset:46208
    ds_read_b64_tr_b16 v[86:87], v24 offset:47488
    v_mfma_f32_16x16x32_bf16 v[116:119], v[60:63], v[40:43], v[116:119]
    s_waitcnt lgkmcnt(0)
    v_mfma_f32_16x16x32_bf16 v[100:103], v[68:71], v[64:67], v[100:103]
    ds_read_b128 v[40:43], v22 offset:32768
    ds_read_b64_tr_b16 v[44:45], v24 offset:51200
    ds_read_b64_tr_b16 v[46:47], v24 offset:52480
    v_mfma_f32_16x16x32_bf16 v[104:107], v[72:75], v[64:67], v[104:107]
    ds_read_b64_tr_b16 v[48:49], v24 offset:51232
    ds_read_b64_tr_b16 v[50:51], v24 offset:52512
    ds_read_b64_tr_b16 v[52:53], v24 offset:51264
    v_mfma_f32_16x16x32_bf16 v[108:111], v[76:79], v[64:67], v[108:111]
    ds_read_b64_tr_b16 v[54:55], v24 offset:52544
    ds_read_b64_tr_b16 v[56:57], v24 offset:51296
    ds_read_b64_tr_b16 v[58:59], v24 offset:52576
    v_mfma_f32_16x16x32_bf16 v[112:115], v[80:83], v[64:67], v[112:115]
    ds_read_b64_tr_b16 v[60:61], v24 offset:51328
    ds_read_b64_tr_b16 v[62:63], v24 offset:52608
    v_mfma_f32_16x16x32_bf16 v[116:119], v[84:87], v[64:67], v[116:119]
    s_waitcnt lgkmcnt(0)
    v_mfma_f32_16x16x32_bf16 v[100:103], v[44:47], v[40:43], v[100:103]
    ds_read_b128 v[64:67], v23 offset:32768
    ds_read_b64_tr_b16 v[68:69], v24 offset:56320
    ds_read_b64_tr_b16 v[70:71], v24 offset:57600
    v_mfma_f32_16x16x32_bf16 v[104:107], v[48:51], v[40:43], v[104:107]
    ds_read_b64_tr_b16 v[72:73], v24 offset:56352
    ds_read_b64_tr_b16 v[74:75], v24 offset:57632
    ds_read_b64_tr_b16 v[76:77], v24 offset:56384
    v_mfma_f32_16x16x32_bf16 v[108:111], v[52:55], v[40:43], v[108:111]
    ds_read_b64_tr_b16 v[78:79], v24 offset:57664
    ds_read_b64_tr_b16 v[80:81], v24 offset:56416
    ds_read_b64_tr_b16 v[82:83], v24 offset:57696
    v_mfma_f32_16x16x32_bf16 v[112:115], v[56:59], v[40:43], v[112:115]
    ds_read_b64_tr_b16 v[84:85], v24 offset:56448
    ds_read_b64_tr_b16 v[86:87], v24 offset:57728
    v_mfma_f32_16x16x32_bf16 v[116:119], v[60:63], v[40:43], v[116:119]
    s_waitcnt lgkmcnt(0)
    s_waitcnt vmcnt(18)
    s_barrier
    v_mfma_f32_16x16x32_bf16 v[100:103], v[68:71], v[64:67], v[100:103]
    ds_read_b128 v[40:43], v20 offset:49152
    ds_read_b64_tr_b16 v[44:45], v24 offset:61440
    ds_read_b64_tr_b16 v[46:47], v24 offset:62720
    v_mfma_f32_16x16x32_bf16 v[104:107], v[72:75], v[64:67], v[104:107]
    ds_read_b64_tr_b16 v[48:49], v24 offset:61472
    ds_read_b64_tr_b16 v[50:51], v24 offset:62752
    ds_read_b64_tr_b16 v[52:53], v24 offset:61504
    s_add_u32 m0, s62, 32768
    s_nop 0
    buffer_load_dwordx4 v10, s[28:31], s60 offen lds
    s_add_u32 m0, s62, 33792
    s_nop 0
    buffer_load_dwordx4 v11, s[28:31], s60 offen lds
    s_add_u32 m0, s62, 34816
    s_nop 0
    buffer_load_dwordx4 v12, s[28:31], s60 offen lds
    v_mfma_f32_16x16x32_bf16 v[108:111], v[76:79], v[64:67], v[108:111]
    ds_read_b64_tr_b16 v[54:55], v24 offset:62784
    ds_read_b64_tr_b16 v[56:57], v24 offset:61536
    ds_read_b64_tr_b16 v[58:59], v24 offset:62816
    s_add_u32 m0, s62, 35840
    s_nop 0
    buffer_load_dwordx4 v13, s[28:31], s60 offen lds
    s_add_u32 s60, s60, 256
    s_add_u32 m0, s63, 106496
    s_nop 0
    buffer_load_dwordx4 v14, s[32:35], s61 offen lds
    v_mfma_f32_16x16x32_bf16 v[112:115], v[80:83], v[64:67], v[112:115]
    ds_read_b64_tr_b16 v[60:61], v24 offset:61568
    ds_read_b64_tr_b16 v[62:63], v24 offset:62848
    s_add_u32 m0, s63, 107520
    s_nop 0
    buffer_load_dwordx4 v15, s[32:35], s61 offen lds
    s_add_u32 m0, s63, 108544
    s_nop 0
    buffer_load_dwordx4 v16, s[32:35], s61 offen lds
    v_mfma_f32_16x16x32_bf16 v[116:119], v[84:87], v[64:67], v[116:119]
    s_add_u32 m0, s63, 109568
    s_nop 0
    buffer_load_dwordx4 v17, s[32:35], s61 offen lds
    s_add_u32 m0, s63, 110592
    s_nop 0
    buffer_load_dwordx4 v18, s[32:35], s61 offen lds
    s_add_u32 s61, s61, 163840
    s_waitcnt lgkmcnt(0)
    v_mfma_f32_16x16x32_bf16 v[100:103], v[44:47], v[40:43], v[100:103]
    ds_read_b128 v[64:67], v21 offset:49152
    ds_read_b64_tr_b16 v[68:69], v25 offset:25600
    ds_read_b64_tr_b16 v[70:71], v25 offset:26880
    v_mfma_f32_16x16x32_bf16 v[104:107], v[48:51], v[40:43], v[104:107]
    ds_read_b64_tr_b16 v[72:73], v25 offset:25632
    ds_read_b64_tr_b16 v[74:75], v25 offset:26912
    ds_read_b64_tr_b16 v[76:77], v25 offset:25664
    v_mfma_f32_16x16x32_bf16 v[108:111], v[52:55], v[40:43], v[108:111]
    ds_read_b64_tr_b16 v[78:79], v25 offset:26944
    ds_read_b64_tr_b16 v[80:81], v25 offset:25696
    ds_read_b64_tr_b16 v[82:83], v25 offset:26976
    v_mfma_f32_16x16x32_bf16 v[112:115], v[56:59], v[40:43], v[112:115]
    ds_read_b64_tr_b16 v[84:85], v25 offset:25728
    ds_read_b64_tr_b16 v[86:87], v25 offset:27008
    v_mfma_f32_16x16x32_bf16 v[116:119], v[60:63], v[40:43], v[116:119]
    s_waitcnt lgkmcnt(0)
    v_mfma_f32_16x16x32_bf16 v[100:103], v[68:71], v[64:67], v[100:103]
    ds_read_b128 v[40:43], v22 offset:49152
    ds_read_b64_tr_b16 v[44:45], v25 offset:30720
    ds_read_b64_tr_b16 v[46:47], v25 offset:32000
    v_mfma_f32_16x16x32_bf16 v[104:107], v[72:75], v[64:67], v[104:107]
    ds_read_b64_tr_b16 v[48:49], v25 offset:30752
    ds_read_b64_tr_b16 v[50:51], v25 offset:32032
    ds_read_b64_tr_b16 v[52:53], v25 offset:30784
    v_mfma_f32_16x16x32_bf16 v[108:111], v[76:79], v[64:67], v[108:111]
    ds_read_b64_tr_b16 v[54:55], v25 offset:32064
    ds_read_b64_tr_b16 v[56:57], v25 offset:30816
    ds_read_b64_tr_b16 v[58:59], v25 offset:32096
    v_mfma_f32_16x16x32_bf16 v[112:115], v[80:83], v[64:67], v[112:115]
    ds_read_b64_tr_b16 v[60:61], v25 offset:30848
    ds_read_b64_tr_b16 v[62:63], v25 offset:32128
    v_mfma_f32_16x16x32_bf16 v[116:119], v[84:87], v[64:67], v[116:119]
    s_waitcnt lgkmcnt(0)
    v_mfma_f32_16x16x32_bf16 v[100:103], v[44:47], v[40:43], v[100:103]
    ds_read_b128 v[64:67], v23 offset:49152
    ds_read_b64_tr_b16 v[68:69], v25 offset:35840
    ds_read_b64_tr_b16 v[70:71], v25 offset:37120
    v_mfma_f32_16x16x32_bf16 v[104:107], v[48:51], v[40:43], v[104:107]
    ds_read_b64_tr_b16 v[72:73], v25 offset:35872
    ds_read_b64_tr_b16 v[74:75], v25 offset:37152
    ds_read_b64_tr_b16 v[76:77], v25 offset:35904
    v_mfma_f32_16x16x32_bf16 v[108:111], v[52:55], v[40:43], v[108:111]
    ds_read_b64_tr_b16 v[78:79], v25 offset:37184
    ds_read_b64_tr_b16 v[80:81], v25 offset:35936
    ds_read_b64_tr_b16 v[82:83], v25 offset:37216
    v_mfma_f32_16x16x32_bf16 v[112:115], v[56:59], v[40:43], v[112:115]
    ds_read_b64_tr_b16 v[84:85], v25 offset:35968
    ds_read_b64_tr_b16 v[86:87], v25 offset:37248
    v_mfma_f32_16x16x32_bf16 v[116:119], v[60:63], v[40:43], v[116:119]
    s_waitcnt lgkmcnt(0)
    s_waitcnt vmcnt(18)
    s_barrier
    v_mfma_f32_16x16x32_bf16 v[100:103], v[68:71], v[64:67], v[100:103]
    ds_read_b128 v[40:43], v20 offset:0
    ds_read_b64_tr_b16 v[44:45], v24 offset:0
    ds_read_b64_tr_b16 v[46:47], v24 offset:1280
    v_mfma_f32_16x16x32_bf16 v[104:107], v[72:75], v[64:67], v[104:107]
    ds_read_b64_tr_b16 v[48:49], v24 offset:32
    ds_read_b64_tr_b16 v[50:51], v24 offset:1312
    ds_read_b64_tr_b16 v[52:53], v24 offset:64
    s_add_u32 m0, s62, 49152
    s_nop 0
    buffer_load_dwordx4 v10, s[28:31], s60 offen lds
    s_add_u32 m0, s62, 50176
    s_nop 0
    buffer_load_dwordx4 v11, s[28:31], s60 offen lds
    s_add_u32 m0, s62, 51200
    s_nop 0
    buffer_load_dwordx4 v12, s[28:31], s60 offen lds
    v_mfma_f32_16x16x32_bf16 v[108:111], v[76:79], v[64:67], v[108:111]
    ds_read_b64_tr_b16 v[54:55], v24 offset:1344
    ds_read_b64_tr_b16 v[56:57], v24 offset:96
    ds_read_b64_tr_b16 v[58:59], v24 offset:1376
    s_add_u32 m0, s62, 52224
    s_nop 0
    buffer_load_dwordx4 v13, s[28:31], s60 offen lds
    s_add_u32 s60, s60, 256
    s_add_u32 m0, s63, 126976
    s_nop 0
    buffer_load_dwordx4 v14, s[32:35], s61 offen lds
    v_mfma_f32_16x16x32_bf16 v[112:115], v[80:83], v[64:67], v[112:115]
    ds_read_b64_tr_b16 v[60:61], v24 offset:128
    ds_read_b64_tr_b16 v[62:63], v24 offset:1408
    s_add_u32 m0, s63, 128000
    s_nop 0
    buffer_load_dwordx4 v15, s[32:35], s61 offen lds
    s_add_u32 m0, s63, 129024
    s_nop 0
    buffer_load_dwordx4 v16, s[32:35], s61 offen lds
    v_mfma_f32_16x16x32_bf16 v[116:119], v[84:87], v[64:67], v[116:119]
    s_add_u32 m0, s63, 130048
    s_nop 0
    buffer_load_dwordx4 v17, s[32:35], s61 offen lds
    s_add_u32 m0, s63, 131072
    s_nop 0
    buffer_load_dwordx4 v18, s[32:35], s61 offen lds
    s_add_u32 s61, s61, 163840
    s_waitcnt lgkmcnt(0)
    v_mfma_f32_16x16x32_bf16 v[100:103], v[44:47], v[40:43], v[100:103]
    ds_read_b128 v[64:67], v21 offset:0
    ds_read_b64_tr_b16 v[68:69], v24 offset:5120
    ds_read_b64_tr_b16 v[70:71], v24 offset:6400
    v_mfma_f32_16x16x32_bf16 v[104:107], v[48:51], v[40:43], v[104:107]
    ds_read_b64_tr_b16 v[72:73], v24 offset:5152
    ds_read_b64_tr_b16 v[74:75], v24 offset:6432
    ds_read_b64_tr_b16 v[76:77], v24 offset:5184
    v_mfma_f32_16x16x32_bf16 v[108:111], v[52:55], v[40:43], v[108:111]
    ds_read_b64_tr_b16 v[78:79], v24 offset:6464
    ds_read_b64_tr_b16 v[80:81], v24 offset:5216
    ds_read_b64_tr_b16 v[82:83], v24 offset:6496
    v_mfma_f32_16x16x32_bf16 v[112:115], v[56:59], v[40:43], v[112:115]
    ds_read_b64_tr_b16 v[84:85], v24 offset:5248
    ds_read_b64_tr_b16 v[86:87], v24 offset:6528
    v_mfma_f32_16x16x32_bf16 v[116:119], v[60:63], v[40:43], v[116:119]
    s_waitcnt lgkmcnt(0)
    v_mfma_f32_16x16x32_bf16 v[100:103], v[68:71], v[64:67], v[100:103]
    ds_read_b128 v[40:43], v22 offset:0
    ds_read_b64_tr_b16 v[44:45], v24 offset:10240
    ds_read_b64_tr_b16 v[46:47], v24 offset:11520
    v_mfma_f32_16x16x32_bf16 v[104:107], v[72:75], v[64:67], v[104:107]
    ds_read_b64_tr_b16 v[48:49], v24 offset:10272
    ds_read_b64_tr_b16 v[50:51], v24 offset:11552
    ds_read_b64_tr_b16 v[52:53], v24 offset:10304
    v_mfma_f32_16x16x32_bf16 v[108:111], v[76:79], v[64:67], v[108:111]
    ds_read_b64_tr_b16 v[54:55], v24 offset:11584
    ds_read_b64_tr_b16 v[56:57], v24 offset:10336
    ds_read_b64_tr_b16 v[58:59], v24 offset:11616
    v_mfma_f32_16x16x32_bf16 v[112:115], v[80:83], v[64:67], v[112:115]
    ds_read_b64_tr_b16 v[60:61], v24 offset:10368
    ds_read_b64_tr_b16 v[62:63], v24 offset:11648
    v_mfma_f32_16x16x32_bf16 v[116:119], v[84:87], v[64:67], v[116:119]
    s_waitcnt lgkmcnt(0)
    v_mfma_f32_16x16x32_bf16 v[100:103], v[44:47], v[40:43], v[100:103]
    ds_read_b128 v[64:67], v23 offset:0
    ds_read_b64_tr_b16 v[68:69], v24 offset:15360
    ds_read_b64_tr_b16 v[70:71], v24 offset:16640
    v_mfma_f32_16x16x32_bf16 v[104:107], v[48:51], v[40:43], v[104:107]
    ds_read_b64_tr_b16 v[72:73], v24 offset:15392
    ds_read_b64_tr_b16 v[74:75], v24 offset:16672
    ds_read_b64_tr_b16 v[76:77], v24 offset:15424
    v_mfma_f32_16x16x32_bf16 v[108:111], v[52:55], v[40:43], v[108:111]
    ds_read_b64_tr_b16 v[78:79], v24 offset:16704
    ds_read_b64_tr_b16 v[80:81], v24 offset:15456
    ds_read_b64_tr_b16 v[82:83], v24 offset:16736
    v_mfma_f32_16x16x32_bf16 v[112:115], v[56:59], v[40:43], v[112:115]
    ds_read_b64_tr_b16 v[84:85], v24 offset:15488
    ds_read_b64_tr_b16 v[86:87], v24 offset:16768
    v_mfma_f32_16x16x32_bf16 v[116:119], v[60:63], v[40:43], v[116:119]
    s_waitcnt lgkmcnt(0)
    s_waitcnt vmcnt(18)
    s_barrier
    v_mfma_f32_16x16x32_bf16 v[100:103], v[68:71], v[64:67], v[100:103]
    ds_read_b128 v[40:43], v20 offset:16384
    ds_read_b64_tr_b16 v[44:45], v24 offset:20480
    ds_read_b64_tr_b16 v[46:47], v24 offset:21760
    v_mfma_f32_16x16x32_bf16 v[104:107], v[72:75], v[64:67], v[104:107]
    ds_read_b64_tr_b16 v[48:49], v24 offset:20512
    ds_read_b64_tr_b16 v[50:51], v24 offset:21792
    ds_read_b64_tr_b16 v[52:53], v24 offset:20544
    s_add_u32 m0, s62, 0
    s_nop 0
    buffer_load_dwordx4 v10, s[28:31], s60 offen lds
    s_add_u32 m0, s62, 1024
    s_nop 0
    buffer_load_dwordx4 v11, s[28:31], s60 offen lds
    s_add_u32 m0, s62, 2048
    s_nop 0
    buffer_load_dwordx4 v12, s[28:31], s60 offen lds
    v_mfma_f32_16x16x32_bf16 v[108:111], v[76:79], v[64:67], v[108:111]
    ds_read_b64_tr_b16 v[54:55], v24 offset:21824
    ds_read_b64_tr_b16 v[56:57], v24 offset:20576
    ds_read_b64_tr_b16 v[58:59], v24 offset:21856
    s_add_u32 m0, s62, 3072
    s_nop 0
    buffer_load_dwordx4 v13, s[28:31], s60 offen lds
    s_add_u32 s60, s60, 256
    s_add_u32 m0, s63, 65536
    s_nop 0
    buffer_load_dwordx4 v14, s[32:35], s61 offen lds
    v_mfma_f32_16x16x32_bf16 v[112:115], v[80:83], v[64:67], v[112:115]
    ds_read_b64_tr_b16 v[60:61], v24 offset:20608
    ds_read_b64_tr_b16 v[62:63], v24 offset:21888
    s_add_u32 m0, s63, 66560
    s_nop 0
    buffer_load_dwordx4 v15, s[32:35], s61 offen lds
    s_add_u32 m0, s63, 67584
    s_nop 0
    buffer_load_dwordx4 v16, s[32:35], s61 offen lds
    v_mfma_f32_16x16x32_bf16 v[116:119], v[84:87], v[64:67], v[116:119]
    s_add_u32 m0, s63, 68608
    s_nop 0
    buffer_load_dwordx4 v17, s[32:35], s61 offen lds
    s_add_u32 m0, s63, 69632
    s_nop 0
    buffer_load_dwordx4 v18, s[32:35], s61 offen lds
    s_add_u32 s61, s61, 163840
    s_waitcnt lgkmcnt(0)
    v_mfma_f32_16x16x32_bf16 v[100:103], v[44:47], v[40:43], v[100:103]
    ds_read_b128 v[64:67], v21 offset:16384
    ds_read_b64_tr_b16 v[68:69], v24 offset:25600
    ds_read_b64_tr_b16 v[70:71], v24 offset:26880
    v_mfma_f32_16x16x32_bf16 v[104:107], v[48:51], v[40:43], v[104:107]
    ds_read_b64_tr_b16 v[72:73], v24 offset:25632
    ds_read_b64_tr_b16 v[74:75], v24 offset:26912
    ds_read_b64_tr_b16 v[76:77], v24 offset:25664
    v_mfma_f32_16x16x32_bf16 v[108:111], v[52:55], v[40:43], v[108:111]
    ds_read_b64_tr_b16 v[78:79], v24 offset:26944
    ds_read_b64_tr_b16 v[80:81], v24 offset:25696
    ds_read_b64_tr_b16 v[82:83], v24 offset:26976
    v_mfma_f32_16x16x32_bf16 v[112:115], v[56:59], v[40:43], v[112:115]
    ds_read_b64_tr_b16 v[84:85], v24 offset:25728
    ds_read_b64_tr_b16 v[86:87], v24 offset:27008
    v_mfma_f32_16x16x32_bf16 v[116:119], v[60:63], v[40:43], v[116:119]
    s_waitcnt lgkmcnt(0)
    v_mfma_f32_16x16x32_bf16 v[100:103], v[68:71], v[64:67], v[100:103]
    ds_read_b128 v[40:43], v22 offset:16384
    ds_read_b64_tr_b16 v[44:45], v24 offset:30720
    ds_read_b64_tr_b16 v[46:47], v24 offset:32000
    v_mfma_f32_16x16x32_bf16 v[104:107], v[72:75], v[64:67], v[104:107]
    ds_read_b64_tr_b16 v[48:49], v24 offset:30752
    ds_read_b64_tr_b16 v[50:51], v24 offset:32032
    ds_read_b64_tr_b16 v[52:53], v24 offset:30784
    v_mfma_f32_16x16x32_bf16 v[108:111], v[76:79], v[64:67], v[108:111]
    ds_read_b64_tr_b16 v[54:55], v24 offset:32064
    ds_read_b64_tr_b16 v[56:57], v24 offset:30816
    ds_read_b64_tr_b16 v[58:59], v24 offset:32096
    v_mfma_f32_16x16x32_bf16 v[112:115], v[80:83], v[64:67], v[112:115]
    ds_read_b64_tr_b16 v[60:61], v24 offset:30848
    ds_read_b64_tr_b16 v[62:63], v24 offset:32128
    v_mfma_f32_16x16x32_bf16 v[116:119], v[84:87], v[64:67], v[116:119]
    s_waitcnt lgkmcnt(0)
    v_mfma_f32_16x16x32_bf16 v[100:103], v[44:47], v[40:43], v[100:103]
    ds_read_b128 v[64:67], v23 offset:16384
    ds_read_b64_tr_b16 v[68:69], v24 offset:35840
    ds_read_b64_tr_b16 v[70:71], v24 offset:37120
    v_mfma_f32_16x16x32_bf16 v[104:107], v[48:51], v[40:43], v[104:107]
    ds_read_b64_tr_b16 v[72:73], v24 offset:35872
    ds_read_b64_tr_b16 v[74:75], v24 offset:37152
    ds_read_b64_tr_b16 v[76:77], v24 offset:35904
    v_mfma_f32_16x16x32_bf16 v[108:111], v[52:55], v[40:43], v[108:111]
    ds_read_b64_tr_b16 v[78:79], v24 offset:37184
    ds_read_b64_tr_b16 v[80:81], v24 offset:35936
    ds_read_b64_tr_b16 v[82:83], v24 offset:37216
    v_mfma_f32_16x16x32_bf16 v[112:115], v[56:59], v[40:43], v[112:115]
    ds_read_b64_tr_b16 v[84:85], v24 offset:35968
    ds_read_b64_tr_b16 v[86:87], v24 offset:37248
    v_mfma_f32_16x16x32_bf16 v[116:119], v[60:63], v[40:43], v[116:119]
    s_waitcnt lgkmcnt(0)
    s_waitcnt vmcnt(18)
    s_barrier
    v_mfma_f32_16x16x32_bf16 v[100:103], v[68:71], v[64:67], v[100:103]
    ds_read_b128 v[40:43], v20 offset:32768
    ds_read_b64_tr_b16 v[44:45], v24 offset:40960
    ds_read_b64_tr_b16 v[46:47], v24 offset:42240
    v_mfma_f32_16x16x32_bf16 v[104:107], v[72:75], v[64:67], v[104:107]
    ds_read_b64_tr_b16 v[48:49], v24 offset:40992
    ds_read_b64_tr_b16 v[50:51], v24 offset:42272
    ds_read_b64_tr_b16 v[52:53], v24 offset:41024
    s_add_u32 m0, s62, 16384
    s_nop 0
    buffer_load_dwordx4 v10, s[28:31], s60 offen lds
    s_add_u32 m0, s62, 17408
    s_nop 0
    buffer_load_dwordx4 v11, s[28:31], s60 offen lds
    s_add_u32 m0, s62, 18432
    s_nop 0
    buffer_load_dwordx4 v12, s[28:31], s60 offen lds
    v_mfma_f32_16x16x32_bf16 v[108:111], v[76:79], v[64:67], v[108:111]
    ds_read_b64_tr_b16 v[54:55], v24 offset:42304
    ds_read_b64_tr_b16 v[56:57], v24 offset:41056
    ds_read_b64_tr_b16 v[58:59], v24 offset:42336
    s_add_u32 m0, s62, 19456
    s_nop 0
    buffer_load_dwordx4 v13, s[28:31], s60 offen lds
    s_add_u32 s60, s60, 256
    s_add_u32 m0, s63, 86016
    s_nop 0
    buffer_load_dwordx4 v14, s[32:35], s61 offen lds
    v_mfma_f32_16x16x32_bf16 v[112:115], v[80:83], v[64:67], v[112:115]
    ds_read_b64_tr_b16 v[60:61], v24 offset:41088
    ds_read_b64_tr_b16 v[62:63], v24 offset:42368
    s_add_u32 m0, s63, 87040
    s_nop 0
    buffer_load_dwordx4 v15, s[32:35], s61 offen lds
    s_add_u32 m0, s63, 88064
    s_nop 0
    buffer_load_dwordx4 v16, s[32:35], s61 offen lds
    v_mfma_f32_16x16x32_bf16 v[116:119], v[84:87], v[64:67], v[116:119]
    s_add_u32 m0, s63, 89088
    s_nop 0
    buffer_load_dwordx4 v17, s[32:35], s61 offen lds
    s_add_u32 m0, s63, 90112
    s_nop 0
    buffer_load_dwordx4 v18, s[32:35], s61 offen lds
    s_add_u32 s61, s61, 163840
    s_waitcnt lgkmcnt(0)
    v_mfma_f32_16x16x32_bf16 v[100:103], v[44:47], v[40:43], v[100:103]
    ds_read_b128 v[64:67], v21 offset:32768
    ds_read_b64_tr_b16 v[68:69], v24 offset:46080
    ds_read_b64_tr_b16 v[70:71], v24 offset:47360
    v_mfma_f32_16x16x32_bf16 v[104:107], v[48:51], v[40:43], v[104:107]
    ds_read_b64_tr_b16 v[72:73], v24 offset:46112
    ds_read_b64_tr_b16 v[74:75], v24 offset:47392
    ds_read_b64_tr_b16 v[76:77], v24 offset:46144
    v_mfma_f32_16x16x32_bf16 v[108:111], v[52:55], v[40:43], v[108:111]
    ds_read_b64_tr_b16 v[78:79], v24 offset:47424
    ds_read_b64_tr_b16 v[80:81], v24 offset:46176
    ds_read_b64_tr_b16 v[82:83], v24 offset:47456
    v_mfma_f32_16x16x32_bf16 v[112:115], v[56:59], v[40:43], v[112:115]
    ds_read_b64_tr_b16 v[84:85], v24 offset:46208
    ds_read_b64_tr_b16 v[86:87], v24 offset:47488
    v_mfma_f32_16x16x32_bf16 v[116:119], v[60:63], v[40:43], v[116:119]
    s_waitcnt lgkmcnt(0)
    v_mfma_f32_16x16x32_bf16 v[100:103], v[68:71], v[64:67], v[100:103]
    ds_read_b128 v[40:43], v22 offset:32768
    ds_read_b64_tr_b16 v[44:45], v24 offset:51200
    ds_read_b64_tr_b16 v[46:47], v24 offset:52480
    v_mfma_f32_16x16x32_bf16 v[104:107], v[72:75], v[64:67], v[104:107]
    ds_read_b64_tr_b16 v[48:49], v24 offset:51232
    ds_read_b64_tr_b16 v[50:51], v24 offset:52512
    ds_read_b64_tr_b16 v[52:53], v24 offset:51264
    v_mfma_f32_16x16x32_bf16 v[108:111], v[76:79], v[64:67], v[108:111]
    ds_read_b64_tr_b16 v[54:55], v24 offset:52544
    ds_read_b64_tr_b16 v[56:57], v24 offset:51296
    ds_read_b64_tr_b16 v[58:59], v24 offset:52576
    v_mfma_f32_16x16x32_bf16 v[112:115], v[80:83], v[64:67], v[112:115]
    ds_read_b64_tr_b16 v[60:61], v24 offset:51328
    ds_read_b64_tr_b16 v[62:63], v24 offset:52608
    v_mfma_f32_16x16x32_bf16 v[116:119], v[84:87], v[64:67], v[116:119]
    s_waitcnt lgkmcnt(0)
    v_mfma_f32_16x16x32_bf16 v[100:103], v[44:47], v[40:43], v[100:103]
    ds_read_b128 v[64:67], v23 offset:32768
    ds_read_b64_tr_b16 v[68:69], v24 offset:56320
    ds_read_b64_tr_b16 v[70:71], v24 offset:57600
    v_mfma_f32_16x16x32_bf16 v[104:107], v[48:51], v[40:43], v[104:107]
    ds_read_b64_tr_b16 v[72:73], v24 offset:56352
    ds_read_b64_tr_b16 v[74:75], v24 offset:57632
    ds_read_b64_tr_b16 v[76:77], v24 offset:56384
    v_mfma_f32_16x16x32_bf16 v[108:111], v[52:55], v[40:43], v[108:111]
    ds_read_b64_tr_b16 v[78:79], v24 offset:57664
    ds_read_b64_tr_b16 v[80:81], v24 offset:56416
    ds_read_b64_tr_b16 v[82:83], v24 offset:57696
    v_mfma_f32_16x16x32_bf16 v[112:115], v[56:59], v[40:43], v[112:115]
    ds_read_b64_tr_b16 v[84:85], v24 offset:56448
    ds_read_b64_tr_b16 v[86:87], v24 offset:57728
    v_mfma_f32_16x16x32_bf16 v[116:119], v[60:63], v[40:43], v[116:119]
    s_waitcnt lgkmcnt(0)
    s_waitcnt vmcnt(18)
    s_barrier
    v_mfma_f32_16x16x32_bf16 v[100:103], v[68:71], v[64:67], v[100:103]
    ds_read_b128 v[40:43], v20 offset:49152
    ds_read_b64_tr_b16 v[44:45], v24 offset:61440
    ds_read_b64_tr_b16 v[46:47], v24 offset:62720
    v_mfma_f32_16x16x32_bf16 v[104:107], v[72:75], v[64:67], v[104:107]
    ds_read_b64_tr_b16 v[48:49], v24 offset:61472
    ds_read_b64_tr_b16 v[50:51], v24 offset:62752
    ds_read_b64_tr_b16 v[52:53], v24 offset:61504
    s_add_u32 m0, s62, 32768
    s_nop 0
    buffer_load_dwordx4 v10, s[28:31], s60 offen lds
    s_add_u32 m0, s62, 33792
    s_nop 0
    buffer_load_dwordx4 v11, s[28:31], s60 offen lds
    s_add_u32 m0, s62, 34816
    s_nop 0
    buffer_load_dwordx4 v12, s[28:31], s60 offen lds
    v_mfma_f32_16x16x32_bf16 v[108:111], v[76:79], v[64:67], v[108:111]
    ds_read_b64_tr_b16 v[54:55], v24 offset:62784
    ds_read_b64_tr_b16 v[56:57], v24 offset:61536
    ds_read_b64_tr_b16 v[58:59], v24 offset:62816
    s_add_u32 m0, s62, 35840
    s_nop 0
    buffer_load_dwordx4 v13, s[28:31], s60 offen lds
    s_add_u32 s60, s60, 256
    s_add_u32 m0, s63, 106496
    s_nop 0
    buffer_load_dwordx4 v14, s[32:35], s61 offen lds
    v_mfma_f32_16x16x32_bf16 v[112:115], v[80:83], v[64:67], v[112:115]
    ds_read_b64_tr_b16 v[60:61], v24 offset:61568
    ds_read_b64_tr_b16 v[62:63], v24 offset:62848
    s_add_u32 m0, s63, 107520
    s_nop 0
    buffer_load_dwordx4 v15, s[32:35], s61 offen lds
    s_add_u32 m0, s63, 108544
    s_nop 0
    buffer_load_dwordx4 v16, s[32:35], s61 offen lds
    v_mfma_f32_16x16x32_bf16 v[116:119], v[84:87], v[64:67], v[116:119]
    s_add_u32 m0, s63, 109568
    s_nop 0
    buffer_load_dwordx4 v17, s[32:35], s61 offen lds
    s_add_u32 m0, s63, 110592
    s_nop 0
    buffer_load_dwordx4 v18, s[32:35], s61 offen lds
    s_add_u32 s61, s61, 163840
    s_waitcnt lgkmcnt(0)
    v_mfma_f32_16x16x32_bf16 v[100:103], v[44:47], v[40:43], v[100:103]
    ds_read_b128 v[64:67], v21 offset:49152
    ds_read_b64_tr_b16 v[68:69], v25 offset:25600
    ds_read_b64_tr_b16 v[70:71], v25 offset:26880
    v_mfma_f32_16x16x32_bf16 v[104:107], v[48:51], v[40:43], v[104:107]
    ds_read_b64_tr_b16 v[72:73], v25 offset:25632
    ds_read_b64_tr_b16 v[74:75], v25 offset:26912
    ds_read_b64_tr_b16 v[76:77], v25 offset:25664
    v_mfma_f32_16x16x32_bf16 v[108:111], v[52:55], v[40:43], v[108:111]
    ds_read_b64_tr_b16 v[78:79], v25 offset:26944
    ds_read_b64_tr_b16 v[80:81], v25 offset:25696
    ds_read_b64_tr_b16 v[82:83], v25 offset:26976
    v_mfma_f32_16x16x32_bf16 v[112:115], v[56:59], v[40:43], v[112:115]
    ds_read_b64_tr_b16 v[84:85], v25 offset:25728
    ds_read_b64_tr_b16 v[86:87], v25 offset:27008
    v_mfma_f32_16x16x32_bf16 v[116:119], v[60:63], v[40:43], v[116:119]
    s_waitcnt lgkmcnt(0)
    v_mfma_f32_16x16x32_bf16 v[100:103], v[68:71], v[64:67], v[100:103]
    ds_read_b128 v[40:43], v22 offset:49152
    ds_read_b64_tr_b16 v[44:45], v25 offset:30720
    ds_read_b64_tr_b16 v[46:47], v25 offset:32000
    v_mfma_f32_16x16x32_bf16 v[104:107], v[72:75], v[64:67], v[104:107]
    ds_read_b64_tr_b16 v[48:49], v25 offset:30752
    ds_read_b64_tr_b16 v[50:51], v25 offset:32032
    ds_read_b64_tr_b16 v[52:53], v25 offset:30784
    v_mfma_f32_16x16x32_bf16 v[108:111], v[76:79], v[64:67], v[108:111]
    ds_read_b64_tr_b16 v[54:55], v25 offset:32064
    ds_read_b64_tr_b16 v[56:57], v25 offset:30816
    ds_read_b64_tr_b16 v[58:59], v25 offset:32096
    v_mfma_f32_16x16x32_bf16 v[112:115], v[80:83], v[64:67], v[112:115]
    ds_read_b64_tr_b16 v[60:61], v25 offset:30848
    ds_read_b64_tr_b16 v[62:63], v25 offset:32128
    v_mfma_f32_16x16x32_bf16 v[116:119], v[84:87], v[64:67], v[116:119]
    s_waitcnt lgkmcnt(0)
    v_mfma_f32_16x16x32_bf16 v[100:103], v[44:47], v[40:43], v[100:103]
    ds_read_b128 v[64:67], v23 offset:49152
    ds_read_b64_tr_b16 v[68:69], v25 offset:35840
    ds_read_b64_tr_b16 v[70:71], v25 offset:37120
    v_mfma_f32_16x16x32_bf16 v[104:107], v[48:51], v[40:43], v[104:107]
    ds_read_b64_tr_b16 v[72:73], v25 offset:35872
    ds_read_b64_tr_b16 v[74:75], v25 offset:37152
    ds_read_b64_tr_b16 v[76:77], v25 offset:35904
    v_mfma_f32_16x16x32_bf16 v[108:111], v[52:55], v[40:43], v[108:111]
    ds_read_b64_tr_b16 v[78:79], v25 offset:37184
    ds_read_b64_tr_b16 v[80:81], v25 offset:35936
    ds_read_b64_tr_b16 v[82:83], v25 offset:37216
    v_mfma_f32_16x16x32_bf16 v[112:115], v[56:59], v[40:43], v[112:115]
    ds_read_b64_tr_b16 v[84:85], v25 offset:35968
    ds_read_b64_tr_b16 v[86:87], v25 offset:37248
    v_mfma_f32_16x16x32_bf16 v[116:119], v[60:63], v[40:43], v[116:119]
    s_waitcnt lgkmcnt(0)
    s_waitcnt vmcnt(18)
    s_barrier
    v_mfma_f32_16x16x32_bf16 v[100:103], v[68:71], v[64:67], v[100:103]
    ds_read_b128 v[40:43], v20 offset:0
    ds_read_b64_tr_b16 v[44:45], v24 offset:0
    ds_read_b64_tr_b16 v[46:47], v24 offset:1280
    v_mfma_f32_16x16x32_bf16 v[104:107], v[72:75], v[64:67], v[104:107]
    ds_read_b64_tr_b16 v[48:49], v24 offset:32
    ds_read_b64_tr_b16 v[50:51], v24 offset:1312
    ds_read_b64_tr_b16 v[52:53], v24 offset:64
    s_add_u32 m0, s62, 49152
    s_nop 0
    buffer_load_dwordx4 v10, s[28:31], s60 offen lds
    s_add_u32 m0, s62, 50176
    s_nop 0
    buffer_load_dwordx4 v11, s[28:31], s60 offen lds
    s_add_u32 m0, s62, 51200
    s_nop 0
    buffer_load_dwordx4 v12, s[28:31], s60 offen lds
    v_mfma_f32_16x16x32_bf16 v[108:111], v[76:79], v[64:67], v[108:111]
    ds_read_b64_tr_b16 v[54:55], v24 offset:1344
    ds_read_b64_tr_b16 v[56:57], v24 offset:96
    ds_read_b64_tr_b16 v[58:59], v24 offset:1376
    s_add_u32 m0, s62, 52224
    s_nop 0
    buffer_load_dwordx4 v13, s[28:31], s60 offen lds
    s_add_u32 s60, s60, 256
    s_add_u32 m0, s63, 126976
    s_nop 0
    buffer_load_dwordx4 v14, s[32:35], s61 offen lds
    v_mfma_f32_16x16x32_bf16 v[112:115], v[80:83], v[64:67], v[112:115]
    ds_read_b64_tr_b16 v[60:61], v24 offset:128
    ds_read_b64_tr_b16 v[62:63], v24 offset:1408
    s_add_u32 m0, s63, 128000
    s_nop 0
    buffer_load_dwordx4 v15, s[32:35], s61 offen lds
    s_add_u32 m0, s63, 129024
    s_nop 0
    buffer_load_dwordx4 v16, s[32:35], s61 offen lds
    v_mfma_f32_16x16x32_bf16 v[116:119], v[84:87], v[64:67], v[116:119]
    s_add_u32 m0, s63, 130048
    s_nop 0
    buffer_load_dwordx4 v17, s[32:35], s61 offen lds
    s_add_u32 m0, s63, 131072
    s_nop 0
    buffer_load_dwordx4 v18, s[32:35], s61 offen lds
    s_add_u32 s61, s61, 163840
    s_waitcnt lgkmcnt(0)
    v_mfma_f32_16x16x32_bf16 v[100:103], v[44:47], v[40:43], v[100:103]
    ds_read_b128 v[64:67], v21 offset:0
    ds_read_b64_tr_b16 v[68:69], v24 offset:5120
    ds_read_b64_tr_b16 v[70:71], v24 offset:6400
    v_mfma_f32_16x16x32_bf16 v[104:107], v[48:51], v[40:43], v[104:107]
    ds_read_b64_tr_b16 v[72:73], v24 offset:5152
    ds_read_b64_tr_b16 v[74:75], v24 offset:6432
    ds_read_b64_tr_b16 v[76:77], v24 offset:5184
    v_mfma_f32_16x16x32_bf16 v[108:111], v[52:55], v[40:43], v[108:111]
    ds_read_b64_tr_b16 v[78:79], v24 offset:6464
    ds_read_b64_tr_b16 v[80:81], v24 offset:5216
    ds_read_b64_tr_b16 v[82:83], v24 offset:6496
    v_mfma_f32_16x16x32_bf16 v[112:115], v[56:59], v[40:43], v[112:115]
    ds_read_b64_tr_b16 v[84:85], v24 offset:5248
    ds_read_b64_tr_b16 v[86:87], v24 offset:6528
    v_mfma_f32_16x16x32_bf16 v[116:119], v[60:63], v[40:43], v[116:119]
    s_waitcnt lgkmcnt(0)
    v_mfma_f32_16x16x32_bf16 v[100:103], v[68:71], v[64:67], v[100:103]
    ds_read_b128 v[40:43], v22 offset:0
    ds_read_b64_tr_b16 v[44:45], v24 offset:10240
    ds_read_b64_tr_b16 v[46:47], v24 offset:11520
    v_mfma_f32_16x16x32_bf16 v[104:107], v[72:75], v[64:67], v[104:107]
    ds_read_b64_tr_b16 v[48:49], v24 offset:10272
    ds_read_b64_tr_b16 v[50:51], v24 offset:11552
    ds_read_b64_tr_b16 v[52:53], v24 offset:10304
    v_mfma_f32_16x16x32_bf16 v[108:111], v[76:79], v[64:67], v[108:111]
    ds_read_b64_tr_b16 v[54:55], v24 offset:11584
    ds_read_b64_tr_b16 v[56:57], v24 offset:10336
    ds_read_b64_tr_b16 v[58:59], v24 offset:11616
    v_mfma_f32_16x16x32_bf16 v[112:115], v[80:83], v[64:67], v[112:115]
    ds_read_b64_tr_b16 v[60:61], v24 offset:10368
    ds_read_b64_tr_b16 v[62:63], v24 offset:11648
    v_mfma_f32_16x16x32_bf16 v[116:119], v[84:87], v[64:67], v[116:119]
    s_waitcnt lgkmcnt(0)
    v_mfma_f32_16x16x32_bf16 v[100:103], v[44:47], v[40:43], v[100:103]
    ds_read_b128 v[64:67], v23 offset:0
    ds_read_b64_tr_b16 v[68:69], v24 offset:15360
    ds_read_b64_tr_b16 v[70:71], v24 offset:16640
    v_mfma_f32_16x16x32_bf16 v[104:107], v[48:51], v[40:43], v[104:107]
    ds_read_b64_tr_b16 v[72:73], v24 offset:15392
    ds_read_b64_tr_b16 v[74:75], v24 offset:16672
    ds_read_b64_tr_b16 v[76:77], v24 offset:15424
    v_mfma_f32_16x16x32_bf16 v[108:111], v[52:55], v[40:43], v[108:111]
    ds_read_b64_tr_b16 v[78:79], v24 offset:16704
    ds_read_b64_tr_b16 v[80:81], v24 offset:15456
    ds_read_b64_tr_b16 v[82:83], v24 offset:16736
    v_mfma_f32_16x16x32_bf16 v[112:115], v[56:59], v[40:43], v[112:115]
    ds_read_b64_tr_b16 v[84:85], v24 offset:15488
    ds_read_b64_tr_b16 v[86:87], v24 offset:16768
    v_mfma_f32_16x16x32_bf16 v[116:119], v[60:63], v[40:43], v[116:119]
    s_waitcnt lgkmcnt(0)
    s_waitcnt vmcnt(18)
    s_barrier
    v_mfma_f32_16x16x32_bf16 v[100:103], v[68:71], v[64:67], v[100:103]
    ds_read_b128 v[40:43], v20 offset:16384
    ds_read_b64_tr_b16 v[44:45], v24 offset:20480
    ds_read_b64_tr_b16 v[46:47], v24 offset:21760
    v_mfma_f32_16x16x32_bf16 v[104:107], v[72:75], v[64:67], v[104:107]
    ds_read_b64_tr_b16 v[48:49], v24 offset:20512
    ds_read_b64_tr_b16 v[50:51], v24 offset:21792
    ds_read_b64_tr_b16 v[52:53], v24 offset:20544
    s_add_u32 m0, s62, 0
    s_nop 0
    buffer_load_dwordx4 v10, s[28:31], s60 offen lds
    s_add_u32 m0, s62, 1024
    s_nop 0
    buffer_load_dwordx4 v11, s[28:31], s60 offen lds
    s_add_u32 m0, s62, 2048
    s_nop 0
    buffer_load_dwordx4 v12, s[28:31], s60 offen lds
    v_mfma_f32_16x16x32_bf16 v[108:111], v[76:79], v[64:67], v[108:111]
    ds_read_b64_tr_b16 v[54:55], v24 offset:21824
    ds_read_b64_tr_b16 v[56:57], v24 offset:20576
    ds_read_b64_tr_b16 v[58:59], v24 offset:21856
    s_add_u32 m0, s62, 3072
    s_nop 0
    buffer_load_dwordx4 v13, s[28:31], s60 offen lds
    s_add_u32 s60, s60, 256
    s_add_u32 m0, s63, 65536
    s_nop 0
    buffer_load_dwordx4 v14, s[32:35], s61 offen lds
    v_mfma_f32_16x16x32_bf16 v[112:115], v[80:83], v[64:67], v[112:115]
    ds_read_b64_tr_b16 v[60:61], v24 offset:20608
    ds_read_b64_tr_b16 v[62:63], v24 offset:21888
    s_add_u32 m0, s63, 66560
    s_nop 0
    buffer_load_dwordx4 v15, s[32:35], s61 offen lds
    s_add_u32 m0, s63, 67584
    s_nop 0
    buffer_load_dwordx4 v16, s[32:35], s61 offen lds
    v_mfma_f32_16x16x32_bf16 v[116:119], v[84:87], v[64:67], v[116:119]
    s_add_u32 m0, s63, 68608
    s_nop 0
    buffer_load_dwordx4 v17, s[32:35], s61 offen lds
    s_add_u32 m0, s63, 69632
    s_nop 0
    buffer_load_dwordx4 v18, s[32:35], s61 offen lds
    s_add_u32 s61, s61, 163840
    s_waitcnt lgkmcnt(0)
    v_mfma_f32_16x16x32_bf16 v[100:103], v[44:47], v[40:43], v[100:103]
    ds_read_b128 v[64:67], v21 offset:16384
    ds_read_b64_tr_b16 v[68:69], v24 offset:25600
    ds_read_b64_tr_b16 v[70:71], v24 offset:26880
    v_mfma_f32_16x16x32_bf16 v[104:107], v[48:51], v[40:43], v[104:107]
    ds_read_b64_tr_b16 v[72:73], v24 offset:25632
    ds_read_b64_tr_b16 v[74:75], v24 offset:26912
    ds_read_b64_tr_b16 v[76:77], v24 offset:25664
    v_mfma_f32_16x16x32_bf16 v[108:111], v[52:55], v[40:43], v[108:111]
    ds_read_b64_tr_b16 v[78:79], v24 offset:26944
    ds_read_b64_tr_b16 v[80:81], v24 offset:25696
    ds_read_b64_tr_b16 v[82:83], v24 offset:26976
    v_mfma_f32_16x16x32_bf16 v[112:115], v[56:59], v[40:43], v[112:115]
    ds_read_b64_tr_b16 v[84:85], v24 offset:25728
    ds_read_b64_tr_b16 v[86:87], v24 offset:27008
    v_mfma_f32_16x16x32_bf16 v[116:119], v[60:63], v[40:43], v[116:119]
    s_waitcnt lgkmcnt(0)
    v_mfma_f32_16x16x32_bf16 v[100:103], v[68:71], v[64:67], v[100:103]
    ds_read_b128 v[40:43], v22 offset:16384
    ds_read_b64_tr_b16 v[44:45], v24 offset:30720
    ds_read_b64_tr_b16 v[46:47], v24 offset:32000
    v_mfma_f32_16x16x32_bf16 v[104:107], v[72:75], v[64:67], v[104:107]
    ds_read_b64_tr_b16 v[48:49], v24 offset:30752
    ds_read_b64_tr_b16 v[50:51], v24 offset:32032
    ds_read_b64_tr_b16 v[52:53], v24 offset:30784
    v_mfma_f32_16x16x32_bf16 v[108:111], v[76:79], v[64:67], v[108:111]
    ds_read_b64_tr_b16 v[54:55], v24 offset:32064
    ds_read_b64_tr_b16 v[56:57], v24 offset:30816
    ds_read_b64_tr_b16 v[58:59], v24 offset:32096
    v_mfma_f32_16x16x32_bf16 v[112:115], v[80:83], v[64:67], v[112:115]
    ds_read_b64_tr_b16 v[60:61], v24 offset:30848
    ds_read_b64_tr_b16 v[62:63], v24 offset:32128
    v_mfma_f32_16x16x32_bf16 v[116:119], v[84:87], v[64:67], v[116:119]
    s_waitcnt lgkmcnt(0)
    v_mfma_f32_16x16x32_bf16 v[100:103], v[44:47], v[40:43], v[100:103]
    ds_read_b128 v[64:67], v23 offset:16384
    ds_read_b64_tr_b16 v[68:69], v24 offset:35840
    ds_read_b64_tr_b16 v[70:71], v24 offset:37120
    v_mfma_f32_16x16x32_bf16 v[104:107], v[48:51], v[40:43], v[104:107]
    ds_read_b64_tr_b16 v[72:73], v24 offset:35872
    ds_read_b64_tr_b16 v[74:75], v24 offset:37152
    ds_read_b64_tr_b16 v[76:77], v24 offset:35904
    v_mfma_f32_16x16x32_bf16 v[108:111], v[52:55], v[40:43], v[108:111]
    ds_read_b64_tr_b16 v[78:79], v24 offset:37184
    ds_read_b64_tr_b16 v[80:81], v24 offset:35936
    ds_read_b64_tr_b16 v[82:83], v24 offset:37216
    v_mfma_f32_16x16x32_bf16 v[112:115], v[56:59], v[40:43], v[112:115]
    ds_read_b64_tr_b16 v[84:85], v24 offset:35968
    ds_read_b64_tr_b16 v[86:87], v24 offset:37248
    v_mfma_f32_16x16x32_bf16 v[116:119], v[60:63], v[40:43], v[116:119]
    s_waitcnt lgkmcnt(0)
    s_waitcnt vmcnt(18)
    s_barrier
    v_mfma_f32_16x16x32_bf16 v[100:103], v[68:71], v[64:67], v[100:103]
    ds_read_b128 v[40:43], v20 offset:32768
    ds_read_b64_tr_b16 v[44:45], v24 offset:40960
    ds_read_b64_tr_b16 v[46:47], v24 offset:42240
    v_mfma_f32_16x16x32_bf16 v[104:107], v[72:75], v[64:67], v[104:107]
    ds_read_b64_tr_b16 v[48:49], v24 offset:40992
    ds_read_b64_tr_b16 v[50:51], v24 offset:42272
    ds_read_b64_tr_b16 v[52:53], v24 offset:41024
    s_add_u32 m0, s62, 16384
    s_nop 0
    buffer_load_dwordx4 v10, s[28:31], s60 offen lds
    s_add_u32 m0, s62, 17408
    s_nop 0
    buffer_load_dwordx4 v11, s[28:31], s60 offen lds
    s_add_u32 m0, s62, 18432
    s_nop 0
    buffer_load_dwordx4 v12, s[28:31], s60 offen lds
    v_mfma_f32_16x16x32_bf16 v[108:111], v[76:79], v[64:67], v[108:111]
    ds_read_b64_tr_b16 v[54:55], v24 offset:42304
    ds_read_b64_tr_b16 v[56:57], v24 offset:41056
    ds_read_b64_tr_b16 v[58:59], v24 offset:42336
    s_add_u32 m0, s62, 19456
    s_nop 0
    buffer_load_dwordx4 v13, s[28:31], s60 offen lds
    s_add_u32 s60, s60, 256
    s_add_u32 m0, s63, 86016
    s_nop 0
    buffer_load_dwordx4 v14, s[32:35], s61 offen lds
    v_mfma_f32_16x16x32_bf16 v[112:115], v[80:83], v[64:67], v[112:115]
    ds_read_b64_tr_b16 v[60:61], v24 offset:41088
    ds_read_b64_tr_b16 v[62:63], v24 offset:42368
    s_add_u32 m0, s63, 87040
    s_nop 0
    buffer_load_dwordx4 v15, s[32:35], s61 offen lds
    s_add_u32 m0, s63, 88064
    s_nop 0
    buffer_load_dwordx4 v16, s[32:35], s61 offen lds
    v_mfma_f32_16x16x32_bf16 v[116:119], v[84:87], v[64:67], v[116:119]
    s_add_u32 m0, s63, 89088
    s_nop 0
    buffer_load_dwordx4 v17, s[32:35], s61 offen lds
    s_add_u32 m0, s63, 90112
    s_nop 0
    buffer_load_dwordx4 v18, s[32:35], s61 offen lds
    s_add_u32 s61, s61, 163840
    s_waitcnt lgkmcnt(0)
    v_mfma_f32_16x16x32_bf16 v[100:103], v[44:47], v[40:43], v[100:103]
    ds_read_b128 v[64:67], v21 offset:32768
    ds_read_b64_tr_b16 v[68:69], v24 offset:46080
    ds_read_b64_tr_b16 v[70:71], v24 offset:47360
    v_mfma_f32_16x16x32_bf16 v[104:107], v[48:51], v[40:43], v[104:107]
    ds_read_b64_tr_b16 v[72:73], v24 offset:46112
    ds_read_b64_tr_b16 v[74:75], v24 offset:47392
    ds_read_b64_tr_b16 v[76:77], v24 offset:46144
    v_mfma_f32_16x16x32_bf16 v[108:111], v[52:55], v[40:43], v[108:111]
    ds_read_b64_tr_b16 v[78:79], v24 offset:47424
    ds_read_b64_tr_b16 v[80:81], v24 offset:46176
    ds_read_b64_tr_b16 v[82:83], v24 offset:47456
    v_mfma_f32_16x16x32_bf16 v[112:115], v[56:59], v[40:43], v[112:115]
    ds_read_b64_tr_b16 v[84:85], v24 offset:46208
    ds_read_b64_tr_b16 v[86:87], v24 offset:47488
    v_mfma_f32_16x16x32_bf16 v[116:119], v[60:63], v[40:43], v[116:119]
    s_waitcnt lgkmcnt(0)
    v_mfma_f32_16x16x32_bf16 v[100:103], v[68:71], v[64:67], v[100:103]
    ds_read_b128 v[40:43], v22 offset:32768
    ds_read_b64_tr_b16 v[44:45], v24 offset:51200
    ds_read_b64_tr_b16 v[46:47], v24 offset:52480
    v_mfma_f32_16x16x32_bf16 v[104:107], v[72:75], v[64:67], v[104:107]
    ds_read_b64_tr_b16 v[48:49], v24 offset:51232
    ds_read_b64_tr_b16 v[50:51], v24 offset:52512
    ds_read_b64_tr_b16 v[52:53], v24 offset:51264
    v_mfma_f32_16x16x32_bf16 v[108:111], v[76:79], v[64:67], v[108:111]
    ds_read_b64_tr_b16 v[54:55], v24 offset:52544
    ds_read_b64_tr_b16 v[56:57], v24 offset:51296
    ds_read_b64_tr_b16 v[58:59], v24 offset:52576
    v_mfma_f32_16x16x32_bf16 v[112:115], v[80:83], v[64:67], v[112:115]
    ds_read_b64_tr_b16 v[60:61], v24 offset:51328
    ds_read_b64_tr_b16 v[62:63], v24 offset:52608
    v_mfma_f32_16x16x32_bf16 v[116:119], v[84:87], v[64:67], v[116:119]
    s_waitcnt lgkmcnt(0)
    v_mfma_f32_16x16x32_bf16 v[100:103], v[44:47], v[40:43], v[100:103]
    ds_read_b128 v[64:67], v23 offset:32768
    ds_read_b64_tr_b16 v[68:69], v24 offset:56320
    ds_read_b64_tr_b16 v[70:71], v24 offset:57600
    v_mfma_f32_16x16x32_bf16 v[104:107], v[48:51], v[40:43], v[104:107]
    ds_read_b64_tr_b16 v[72:73], v24 offset:56352
    ds_read_b64_tr_b16 v[74:75], v24 offset:57632
    ds_read_b64_tr_b16 v[76:77], v24 offset:56384
    v_mfma_f32_16x16x32_bf16 v[108:111], v[52:55], v[40:43], v[108:111]
    ds_read_b64_tr_b16 v[78:79], v24 offset:57664
    ds_read_b64_tr_b16 v[80:81], v24 offset:56416
    ds_read_b64_tr_b16 v[82:83], v24 offset:57696
    v_mfma_f32_16x16x32_bf16 v[112:115], v[56:59], v[40:43], v[112:115]
    ds_read_b64_tr_b16 v[84:85], v24 offset:56448
    ds_read_b64_tr_b16 v[86:87], v24 offset:57728
    v_mfma_f32_16x16x32_bf16 v[116:119], v[60:63], v[40:43], v[116:119]
    s_waitcnt lgkmcnt(0)
    s_waitcnt vmcnt(18)
    s_barrier
    v_mfma_f32_16x16x32_bf16 v[100:103], v[68:71], v[64:67], v[100:103]
    ds_read_b128 v[40:43], v20 offset:49152
    ds_read_b64_tr_b16 v[44:45], v24 offset:61440
    ds_read_b64_tr_b16 v[46:47], v24 offset:62720
    v_mfma_f32_16x16x32_bf16 v[104:107], v[72:75], v[64:67], v[104:107]
    ds_read_b64_tr_b16 v[48:49], v24 offset:61472
    ds_read_b64_tr_b16 v[50:51], v24 offset:62752
    ds_read_b64_tr_b16 v[52:53], v24 offset:61504
    v_mfma_f32_16x16x32_bf16 v[108:111], v[76:79], v[64:67], v[108:111]
    ds_read_b64_tr_b16 v[54:55], v24 offset:62784
    ds_read_b64_tr_b16 v[56:57], v24 offset:61536
    ds_read_b64_tr_b16 v[58:59], v24 offset:62816
    v_mfma_f32_16x16x32_bf16 v[112:115], v[80:83], v[64:67], v[112:115]
    ds_read_b64_tr_b16 v[60:61], v24 offset:61568
    ds_read_b64_tr_b16 v[62:63], v24 offset:62848
    v_mfma_f32_16x16x32_bf16 v[116:119], v[84:87], v[64:67], v[116:119]
    s_waitcnt lgkmcnt(0)
    v_mfma_f32_16x16x32_bf16 v[100:103], v[44:47], v[40:43], v[100:103]
    ds_read_b128 v[64:67], v21 offset:49152
    ds_read_b64_tr_b16 v[68:69], v25 offset:25600
    ds_read_b64_tr_b16 v[70:71], v25 offset:26880
    v_mfma_f32_16x16x32_bf16 v[104:107], v[48:51], v[40:43], v[104:107]
    ds_read_b64_tr_b16 v[72:73], v25 offset:25632
    ds_read_b64_tr_b16 v[74:75], v25 offset:26912
    ds_read_b64_tr_b16 v[76:77], v25 offset:25664
    v_mfma_f32_16x16x32_bf16 v[108:111], v[52:55], v[40:43], v[108:111]
    ds_read_b64_tr_b16 v[78:79], v25 offset:26944
    ds_read_b64_tr_b16 v[80:81], v25 offset:25696
    ds_read_b64_tr_b16 v[82:83], v25 offset:26976
    v_mfma_f32_16x16x32_bf16 v[112:115], v[56:59], v[40:43], v[112:115]
    ds_read_b64_tr_b16 v[84:85], v25 offset:25728
    ds_read_b64_tr_b16 v[86:87], v25 offset:27008
    v_mfma_f32_16x16x32_bf16 v[116:119], v[60:63], v[40:43], v[116:119]
    s_waitcnt lgkmcnt(0)
    v_mfma_f32_16x16x32_bf16 v[100:103], v[68:71], v[64:67], v[100:103]
    ds_read_b128 v[40:43], v22 offset:49152
    ds_read_b64_tr_b16 v[44:45], v25 offset:30720
    ds_read_b64_tr_b16 v[46:47], v25 offset:32000
    v_mfma_f32_16x16x32_bf16 v[104:107], v[72:75], v[64:67], v[104:107]
    ds_read_b64_tr_b16 v[48:49], v25 offset:30752
    ds_read_b64_tr_b16 v[50:51], v25 offset:32032
    ds_read_b64_tr_b16 v[52:53], v25 offset:30784
    v_mfma_f32_16x16x32_bf16 v[108:111], v[76:79], v[64:67], v[108:111]
    ds_read_b64_tr_b16 v[54:55], v25 offset:32064
    ds_read_b64_tr_b16 v[56:57], v25 offset:30816
    ds_read_b64_tr_b16 v[58:59], v25 offset:32096
    v_mfma_f32_16x16x32_bf16 v[112:115], v[80:83], v[64:67], v[112:115]
    ds_read_b64_tr_b16 v[60:61], v25 offset:30848
    ds_read_b64_tr_b16 v[62:63], v25 offset:32128
    v_mfma_f32_16x16x32_bf16 v[116:119], v[84:87], v[64:67], v[116:119]
    s_waitcnt lgkmcnt(0)
    v_mfma_f32_16x16x32_bf16 v[100:103], v[44:47], v[40:43], v[100:103]
    ds_read_b128 v[64:67], v23 offset:49152
    ds_read_b64_tr_b16 v[68:69], v25 offset:35840
    ds_read_b64_tr_b16 v[70:71], v25 offset:37120
    v_mfma_f32_16x16x32_bf16 v[104:107], v[48:51], v[40:43], v[104:107]
    ds_read_b64_tr_b16 v[72:73], v25 offset:35872
    ds_read_b64_tr_b16 v[74:75], v25 offset:37152
    ds_read_b64_tr_b16 v[76:77], v25 offset:35904
    v_mfma_f32_16x16x32_bf16 v[108:111], v[52:55], v[40:43], v[108:111]
    ds_read_b64_tr_b16 v[78:79], v25 offset:37184
    ds_read_b64_tr_b16 v[80:81], v25 offset:35936
    ds_read_b64_tr_b16 v[82:83], v25 offset:37216
    v_mfma_f32_16x16x32_bf16 v[112:115], v[56:59], v[40:43], v[112:115]
    ds_read_b64_tr_b16 v[84:85], v25 offset:35968
    ds_read_b64_tr_b16 v[86:87], v25 offset:37248
    v_mfma_f32_16x16x32_bf16 v[116:119], v[60:63], v[40:43], v[116:119]
    s_waitcnt lgkmcnt(0)
    s_waitcnt vmcnt(9)
    s_barrier
    v_mfma_f32_16x16x32_bf16 v[100:103], v[68:71], v[64:67], v[100:103]
    ds_read_b128 v[40:43], v20 offset:0
    ds_read_b64_tr_b16 v[44:45], v24 offset:0
    ds_read_b64_tr_b16 v[46:47], v24 offset:1280
    v_mfma_f32_16x16x32_bf16 v[104:107], v[72:75], v[64:67], v[104:107]
    ds_read_b64_tr_b16 v[48:49], v24 offset:32
    ds_read_b64_tr_b16 v[50:51], v24 offset:1312
    ds_read_b64_tr_b16 v[52:53], v24 offset:64
    v_mfma_f32_16x16x32_bf16 v[108:111], v[76:79], v[64:67], v[108:111]
    ds_read_b64_tr_b16 v[54:55], v24 offset:1344
    ds_read_b64_tr_b16 v[56:57], v24 offset:96
    ds_read_b64_tr_b16 v[58:59], v24 offset:1376
    v_mfma_f32_16x16x32_bf16 v[112:115], v[80:83], v[64:67], v[112:115]
    ds_read_b64_tr_b16 v[60:61], v24 offset:128
    ds_read_b64_tr_b16 v[62:63], v24 offset:1408
    v_mfma_f32_16x16x32_bf16 v[116:119], v[84:87], v[64:67], v[116:119]
    s_waitcnt lgkmcnt(0)
    v_mfma_f32_16x16x32_bf16 v[100:103], v[44:47], v[40:43], v[100:103]
    ds_read_b128 v[64:67], v21 offset:0
    ds_read_b64_tr_b16 v[68:69], v24 offset:5120
    ds_read_b64_tr_b16 v[70:71], v24 offset:6400
    v_mfma_f32_16x16x32_bf16 v[104:107], v[48:51], v[40:43], v[104:107]
    ds_read_b64_tr_b16 v[72:73], v24 offset:5152
    ds_read_b64_tr_b16 v[74:75], v24 offset:6432
    ds_read_b64_tr_b16 v[76:77], v24 offset:5184
    v_mfma_f32_16x16x32_bf16 v[108:111], v[52:55], v[40:43], v[108:111]
    ds_read_b64_tr_b16 v[78:79], v24 offset:6464
    ds_read_b64_tr_b16 v[80:81], v24 offset:5216
    ds_read_b64_tr_b16 v[82:83], v24 offset:6496
    v_mfma_f32_16x16x32_bf16 v[112:115], v[56:59], v[40:43], v[112:115]
    ds_read_b64_tr_b16 v[84:85], v24 offset:5248
    ds_read_b64_tr_b16 v[86:87], v24 offset:6528
    v_mfma_f32_16x16x32_bf16 v[116:119], v[60:63], v[40:43], v[116:119]
    s_waitcnt lgkmcnt(0)
    v_mfma_f32_16x16x32_bf16 v[100:103], v[68:71], v[64:67], v[100:103]
    ds_read_b128 v[40:43], v22 offset:0
    ds_read_b64_tr_b16 v[44:45], v24 offset:10240
    ds_read_b64_tr_b16 v[46:47], v24 offset:11520
    v_mfma_f32_16x16x32_bf16 v[104:107], v[72:75], v[64:67], v[104:107]
    ds_read_b64_tr_b16 v[48:49], v24 offset:10272
    ds_read_b64_tr_b16 v[50:51], v24 offset:11552
    ds_read_b64_tr_b16 v[52:53], v24 offset:10304
    v_mfma_f32_16x16x32_bf16 v[108:111], v[76:79], v[64:67], v[108:111]
    ds_read_b64_tr_b16 v[54:55], v24 offset:11584
    ds_read_b64_tr_b16 v[56:57], v24 offset:10336
    ds_read_b64_tr_b16 v[58:59], v24 offset:11616
    v_mfma_f32_16x16x32_bf16 v[112:115], v[80:83], v[64:67], v[112:115]
    ds_read_b64_tr_b16 v[60:61], v24 offset:10368
    ds_read_b64_tr_b16 v[62:63], v24 offset:11648
    v_mfma_f32_16x16x32_bf16 v[116:119], v[84:87], v[64:67], v[116:119]
    s_waitcnt lgkmcnt(0)
    v_mfma_f32_16x16x32_bf16 v[100:103], v[44:47], v[40:43], v[100:103]
    ds_read_b128 v[64:67], v23 offset:0
    ds_read_b64_tr_b16 v[68:69], v24 offset:15360
    ds_read_b64_tr_b16 v[70:71], v24 offset:16640
    v_mfma_f32_16x16x32_bf16 v[104:107], v[48:51], v[40:43], v[104:107]
    ds_read_b64_tr_b16 v[72:73], v24 offset:15392
    ds_read_b64_tr_b16 v[74:75], v24 offset:16672
    ds_read_b64_tr_b16 v[76:77], v24 offset:15424
    v_mfma_f32_16x16x32_bf16 v[108:111], v[52:55], v[40:43], v[108:111]
    ds_read_b64_tr_b16 v[78:79], v24 offset:16704
    ds_read_b64_tr_b16 v[80:81], v24 offset:15456
    ds_read_b64_tr_b16 v[82:83], v24 offset:16736
    v_mfma_f32_16x16x32_bf16 v[112:115], v[56:59], v[40:43], v[112:115]
    ds_read_b64_tr_b16 v[84:85], v24 offset:15488
    ds_read_b64_tr_b16 v[86:87], v24 offset:16768
    v_mfma_f32_16x16x32_bf16 v[116:119], v[60:63], v[40:43], v[116:119]
    s_waitcnt lgkmcnt(0)
    s_waitcnt vmcnt(0)
    s_barrier
    v_mfma_f32_16x16x32_bf16 v[100:103], v[68:71], v[64:67], v[100:103]
    ds_read_b128 v[40:43], v20 offset:16384
    ds_read_b64_tr_b16 v[44:45], v24 offset:20480
    ds_read_b64_tr_b16 v[46:47], v24 offset:21760
    v_mfma_f32_16x16x32_bf16 v[104:107], v[72:75], v[64:67], v[104:107]
    ds_read_b64_tr_b16 v[48:49], v24 offset:20512
    ds_read_b64_tr_b16 v[50:51], v24 offset:21792
    ds_read_b64_tr_b16 v[52:53], v24 offset:20544
    v_mfma_f32_16x16x32_bf16 v[108:111], v[76:79], v[64:67], v[108:111]
    ds_read_b64_tr_b16 v[54:55], v24 offset:21824
    ds_read_b64_tr_b16 v[56:57], v24 offset:20576
    ds_read_b64_tr_b16 v[58:59], v24 offset:21856
    v_mfma_f32_16x16x32_bf16 v[112:115], v[80:83], v[64:67], v[112:115]
    ds_read_b64_tr_b16 v[60:61], v24 offset:20608
    ds_read_b64_tr_b16 v[62:63], v24 offset:21888
    v_mfma_f32_16x16x32_bf16 v[116:119], v[84:87], v[64:67], v[116:119]
    s_waitcnt lgkmcnt(0)
    v_mfma_f32_16x16x32_bf16 v[100:103], v[44:47], v[40:43], v[100:103]
    ds_read_b128 v[64:67], v21 offset:16384
    ds_read_b64_tr_b16 v[68:69], v24 offset:25600
    ds_read_b64_tr_b16 v[70:71], v24 offset:26880
    v_mfma_f32_16x16x32_bf16 v[104:107], v[48:51], v[40:43], v[104:107]
    ds_read_b64_tr_b16 v[72:73], v24 offset:25632
    ds_read_b64_tr_b16 v[74:75], v24 offset:26912
    ds_read_b64_tr_b16 v[76:77], v24 offset:25664
    v_mfma_f32_16x16x32_bf16 v[108:111], v[52:55], v[40:43], v[108:111]
    ds_read_b64_tr_b16 v[78:79], v24 offset:26944
    ds_read_b64_tr_b16 v[80:81], v24 offset:25696
    ds_read_b64_tr_b16 v[82:83], v24 offset:26976
    v_mfma_f32_16x16x32_bf16 v[112:115], v[56:59], v[40:43], v[112:115]
    ds_read_b64_tr_b16 v[84:85], v24 offset:25728
    ds_read_b64_tr_b16 v[86:87], v24 offset:27008
    v_mfma_f32_16x16x32_bf16 v[116:119], v[60:63], v[40:43], v[116:119]
    s_waitcnt lgkmcnt(0)
    v_mfma_f32_16x16x32_bf16 v[100:103], v[68:71], v[64:67], v[100:103]
    v_mfma_f32_16x16x32_bf16 v[104:107], v[72:75], v[64:67], v[104:107]
    v_mfma_f32_16x16x32_bf16 v[108:111], v[76:79], v[64:67], v[108:111]
    v_mfma_f32_16x16x32_bf16 v[112:115], v[80:83], v[64:67], v[112:115]
    v_mfma_f32_16x16x32_bf16 v[116:119], v[84:87], v[64:67], v[116:119]
    s_nop 7
    s_nop 7
    s_waitcnt vmcnt(0) lgkmcnt(0)
    v_lshlrev_b32 v40, 16, v220
    v_and_b32 v41, 0xffff0000, v220
    v_lshlrev_b32 v60, 16, v230
    v_and_b32 v61, 0xffff0000, v230
    v_lshlrev_b32 v42, 16, v221
    v_and_b32 v43, 0xffff0000, v221
    v_lshlrev_b32 v62, 16, v231
    v_and_b32 v63, 0xffff0000, v231
    v_lshlrev_b32 v44, 16, v222
    v_and_b32 v45, 0xffff0000, v222
    v_lshlrev_b32 v64, 16, v232
    v_and_b32 v65, 0xffff0000, v232
    v_lshlrev_b32 v46, 16, v223
    v_and_b32 v47, 0xffff0000, v223
    v_lshlrev_b32 v66, 16, v233
    v_and_b32 v67, 0xffff0000, v233
    v_lshlrev_b32 v48, 16, v224
    v_and_b32 v49, 0xffff0000, v224
    v_lshlrev_b32 v68, 16, v234
    v_and_b32 v69, 0xffff0000, v234
    v_lshlrev_b32 v50, 16, v225
    v_and_b32 v51, 0xffff0000, v225
    v_lshlrev_b32 v70, 16, v235
    v_and_b32 v71, 0xffff0000, v235
    v_lshlrev_b32 v52, 16, v226
    v_and_b32 v53, 0xffff0000, v226
    v_lshlrev_b32 v72, 16, v236
    v_and_b32 v73, 0xffff0000, v236
    v_lshlrev_b32 v54, 16, v227
    v_and_b32 v55, 0xffff0000, v227
    v_lshlrev_b32 v74, 16, v237
    v_and_b32 v75, 0xffff0000, v237
    v_lshlrev_b32 v56, 16, v228
    v_and_b32 v57, 0xffff0000, v228
    v_lshlrev_b32 v76, 16, v238
    v_and_b32 v77, 0xffff0000, v238
    v_lshlrev_b32 v58, 16, v229
    v_and_b32 v59, 0xffff0000, v229
    v_lshlrev_b32 v78, 16, v239
    v_and_b32 v79, 0xffff0000, v239
    v_add_f32 v100, v100, v60
    v_add_f32 v100, v100, v40
    v_add_f32 v101, v101, v61
    v_add_f32 v101, v101, v41
    v_add_f32 v102, v102, v62
    v_add_f32 v102, v102, v42
    v_add_f32 v103, v103, v63
    v_add_f32 v103, v103, v43
    v_add_f32 v104, v104, v64
    v_add_f32 v104, v104, v44
    v_add_f32 v105, v105, v65
    v_add_f32 v105, v105, v45
    v_add_f32 v106, v106, v66
    v_add_f32 v106, v106, v46
    v_add_f32 v107, v107, v67
    v_add_f32 v107, v107, v47
    v_add_f32 v108, v108, v68
    v_add_f32 v108, v108, v48
    v_add_f32 v109, v109, v69
    v_add_f32 v109, v109, v49
    v_add_f32 v110, v110, v70
    v_add_f32 v110, v110, v50
    v_add_f32 v111, v111, v71
    v_add_f32 v111, v111, v51
    v_add_f32 v112, v112, v72
    v_add_f32 v112, v112, v52
    v_add_f32 v113, v113, v73
    v_add_f32 v113, v113, v53
    v_add_f32 v114, v114, v74
    v_add_f32 v114, v114, v54
    v_add_f32 v115, v115, v75
    v_add_f32 v115, v115, v55
    v_add_f32 v116, v116, v76
    v_add_f32 v116, v116, v56
    v_add_f32 v117, v117, v77
    v_add_f32 v117, v117, v57
    v_add_f32 v118, v118, v78
    v_add_f32 v118, v118, v58
    v_add_f32 v119, v119, v79
    v_add_f32 v119, v119, v59
    v_cvt_pk_bf16_f32 v80, v100, v101
    v_cvt_pk_bf16_f32 v81, v102, v103
    v_cvt_pk_bf16_f32 v82, v104, v105
    v_cvt_pk_bf16_f32 v83, v106, v107
    v_cvt_pk_bf16_f32 v84, v108, v109
    v_cvt_pk_bf16_f32 v85, v110, v111
    v_cvt_pk_bf16_f32 v86, v112, v113
    v_cvt_pk_bf16_f32 v87, v114, v115
    v_cvt_pk_bf16_f32 v88, v116, v117
    v_cvt_pk_bf16_f32 v89, v118, v119
    buffer_store_dwordx2 v[80:81], v30, s[44:47], 0 offen offset:0
    buffer_store_dwordx2 v[82:83], v30, s[44:47], 0 offen offset:32
    buffer_store_dwordx2 v[84:85], v30, s[44:47], 0 offen offset:64
    buffer_store_dwordx2 v[86:87], v30, s[44:47], 0 offen offset:96
    buffer_store_dwordx2 v[88:89], v30, s[44:47], 0 offen offset:128
    v_lshlrev_b32 v100, 16, v80
    v_and_b32 v101, 0xffff0000, v80
    v_lshlrev_b32 v102, 16, v81
    v_and_b32 v103, 0xffff0000, v81
    v_lshlrev_b32 v104, 16, v82
    v_and_b32 v105, 0xffff0000, v82
    v_lshlrev_b32 v106, 16, v83
    v_and_b32 v107, 0xffff0000, v83
    v_lshlrev_b32 v108, 16, v84
    v_and_b32 v109, 0xffff0000, v84
    v_lshlrev_b32 v110, 16, v85
    v_and_b32 v111, 0xffff0000, v85
    v_lshlrev_b32 v112, 16, v86
    v_and_b32 v113, 0xffff0000, v86
    v_lshlrev_b32 v114, 16, v87
    v_and_b32 v115, 0xffff0000, v87
    v_lshlrev_b32 v116, 16, v88
    v_and_b32 v117, 0xffff0000, v88
    v_lshlrev_b32 v118, 16, v89
    v_and_b32 v119, 0xffff0000, v89
    v_add_f32 v4, v100, v101
    v_add_f32 v4, v4, v102
    v_add_f32 v4, v4, v103
    v_add_f32 v4, v4, v104
    v_add_f32 v4, v4, v105
    v_add_f32 v4, v4, v106
    v_add_f32 v4, v4, v107
    v_add_f32 v4, v4, v108
    v_add_f32 v4, v4, v109
    v_add_f32 v4, v4, v110
    v_add_f32 v4, v4, v111
    v_add_f32 v4, v4, v112
    v_add_f32 v4, v4, v113
    v_add_f32 v4, v4, v114
    v_add_f32 v4, v4, v115
    v_add_f32 v4, v4, v116
    v_add_f32 v4, v4, v117
    v_add_f32 v4, v4, v118
    v_add_f32 v4, v4, v119
    ds_swizzle_b32 v5, v4 offset:0x401F
    s_waitcnt lgkmcnt(0)
    v_add_f32 v4, v4, v5
    v_mov_b32 v5, v4
    s_nop 1
    v_xor_b32 v6, 32, v1
    v_lshlrev_b32 v6, 2, v6
    ds_bpermute_b32 v5, v6, v4
    s_waitcnt lgkmcnt(0)
    v_add_f32 v4, v4, v5
    v_mul_f32 v7, 1011666125, v4
    v_mov_b32 v8, 0
    v_sub_f32 v9, v100, v7
    v_fma_f32 v8, v9, v9, v8
    v_sub_f32 v9, v101, v7
    v_fma_f32 v8, v9, v9, v8
    v_sub_f32 v9, v102, v7
    v_fma_f32 v8, v9, v9, v8
    v_sub_f32 v9, v103, v7
    v_fma_f32 v8, v9, v9, v8
    v_sub_f32 v9, v104, v7
    v_fma_f32 v8, v9, v9, v8
    v_sub_f32 v9, v105, v7
    v_fma_f32 v8, v9, v9, v8
    v_sub_f32 v9, v106, v7
    v_fma_f32 v8, v9, v9, v8
    v_sub_f32 v9, v107, v7
    v_fma_f32 v8, v9, v9, v8
    v_sub_f32 v9, v108, v7
    v_fma_f32 v8, v9, v9, v8
    v_sub_f32 v9, v109, v7
    v_fma_f32 v8, v9, v9, v8
    v_sub_f32 v9, v110, v7
    v_fma_f32 v8, v9, v9, v8
    v_sub_f32 v9, v111, v7
    v_fma_f32 v8, v9, v9, v8
    v_sub_f32 v9, v112, v7
    v_fma_f32 v8, v9, v9, v8
    v_sub_f32 v9, v113, v7
    v_fma_f32 v8, v9, v9, v8
    v_sub_f32 v9, v114, v7
    v_fma_f32 v8, v9, v9, v8
    v_sub_f32 v9, v115, v7
    v_fma_f32 v8, v9, v9, v8
    v_sub_f32 v9, v116, v7
    v_fma_f32 v8, v9, v9, v8
    v_sub_f32 v9, v117, v7
    v_fma_f32 v8, v9, v9, v8
    v_sub_f32 v9, v118, v7
    v_fma_f32 v8, v9, v9, v8
    v_sub_f32 v9, v119, v7
    v_fma_f32 v8, v9, v9, v8
    ds_swizzle_b32 v5, v8 offset:0x401F
    s_waitcnt lgkmcnt(0)
    v_add_f32 v8, v8, v5
    ds_bpermute_b32 v5, v6, v8
    s_waitcnt lgkmcnt(0)
    v_add_f32 v5, v8, v5
    s_lshl_b32 s54, s52, 6
    s_lshl_b32 s58, s26, 4
    s_add_u32 s54, s54, s58
    v_add_u32 v10, s54, v2
    v_lshlrev_b32 v10, 6, v10
    s_lshl_b32 s55, s53, 3
    v_cmp_eq_u32 vcc, 0, v3
    s_and_saveexec_b64 s[56:57], vcc
    buffer_store_dwordx2 v[4:5], v10, s[48:51], s55 offen
    s_mov_b64 exec, s[56:57]
    s_waitcnt vmcnt(0)
K4_end:
    s_endpgm
.section .rodata,"a"
.p2align 6
.amdhsa_kernel k0_prep_kernel
  .amdhsa_next_free_vgpr 128
  .amdhsa_next_free_sgpr 64
  .amdhsa_accum_offset 128
  .amdhsa_group_segment_fixed_size 0
  .amdhsa_kernarg_size 88
  .amdhsa_user_sgpr_count 2
  .amdhsa_user_sgpr_kernarg_segment_ptr 1
  .amdhsa_system_sgpr_workgroup_id_x 1
.end_amdhsa_kernel
.p2align 6
.amdhsa_kernel k1_l0_kernel
  .amdhsa_next_free_vgpr 256
  .amdhsa_next_free_sgpr 102
  .amdhsa_accum_offset 256
  .amdhsa_group_segment_fixed_size 0
  .amdhsa_kernarg_size 88
  .amdhsa_user_sgpr_count 2
  .amdhsa_user_sgpr_kernarg_segment_ptr 1
  .amdhsa_system_sgpr_workgroup_id_x 1
.end_amdhsa_kernel
.p2align 6
.amdhsa_kernel k1_l1_kernel
  .amdhsa_next_free_vgpr 256
  .amdhsa_next_free_sgpr 102
  .amdhsa_accum_offset 256
  .amdhsa_group_segment_fixed_size 0
  .amdhsa_kernarg_size 88
  .amdhsa_user_sgpr_count 2
  .amdhsa_user_sgpr_kernarg_segment_ptr 1
  .amdhsa_system_sgpr_workgroup_id_x 1
.end_amdhsa_kernel
.p2align 6
.amdhsa_kernel k3_l0_kernel
  .amdhsa_next_free_vgpr 256
  .amdhsa_next_free_sgpr 102
  .amdhsa_accum_offset 256
  .amdhsa_group_segment_fixed_size 0
  .amdhsa_kernarg_size 88
  .amdhsa_user_sgpr_count 2
  .amdhsa_user_sgpr_kernarg_segment_ptr 1
  .amdhsa_system_sgpr_workgroup_id_x 1
.end_amdhsa_kernel
.p2align 6
.amdhsa_kernel k3_l1_kernel
  .amdhsa_next_free_vgpr 256
  .amdhsa_next_free_sgpr 102
  .amdhsa_accum_offset 256
  .amdhsa_group_segment_fixed_size 0
  .amdhsa_kernarg_size 88
  .amdhsa_user_sgpr_count 2
  .amdhsa_user_sgpr_kernarg_segment_ptr 1
  .amdhsa_system_sgpr_workgroup_id_x 1
.end_amdhsa_kernel
.p2align 6
.amdhsa_kernel k2_l0_kernel
  .amdhsa_next_free_vgpr 256
  .amdhsa_next_free_sgpr 102
  .amdhsa_accum_offset 256
  .amdhsa_group_segment_fixed_size 0
  .amdhsa_kernarg_size 88
  .amdhsa_user_sgpr_count 2
  .amdhsa_user_sgpr_kernarg_segment_ptr 1
  .amdhsa_system_sgpr_workgroup_id_x 1
.end_amdhsa_kernel
.p2align 6
.amdhsa_kernel k2_l1_kernel
  .amdhsa_next_free_vgpr 256
  .amdhsa_next_free_sgpr 102
  .amdhsa_accum_offset 256
  .amdhsa_group_segment_fixed_size 0
  .amdhsa_kernarg_size 88
  .amdhsa_user_sgpr_count 2
  .amdhsa_user_sgpr_kernarg_segment_ptr 1
  .amdhsa_system_sgpr_workgroup_id_x 1
.end_amdhsa_kernel
.p2align 6
.amdhsa_kernel k4_l0_kernel
  .amdhsa_next_free_vgpr 256
  .amdhsa_next_free_sgpr 102
  .amdhsa_accum_offset 256
  .amdhsa_group_segment_fixed_size 0
  .amdhsa_kernarg_size 88
  .amdhsa_user_sgpr_count 2
  .amdhsa_user_sgpr_kernarg_segment_ptr 1
  .amdhsa_system_sgpr_workgroup_id_x 1
.end_amdhsa_kernel
.p2align 6
.amdhsa_kernel k4_l1_kernel
  .amdhsa_next_free_vgpr 256
  .amdhsa_next_free_sgpr 102
  .amdhsa_accum_offset 256
  .amdhsa_group_segment_fixed_size 0
  .amdhsa_kernarg_size 88
  .amdhsa_user_sgpr_count 2
  .amdhsa_user_sgpr_kernarg_segment_ptr 1
  .amdhsa_system_sgpr_workgroup_id_x 1
.end_amdhsa_kernel
```
